```python
import torch

def _softmax(x, axis=-1):
    return torch.softmax(x, dim=axis)
def _gelu(x):
    return torch.nn.functional.gelu(x, approximate="tanh")
def _silu(x):
    return torch.nn.functional.silu(x)
def _sigmoid(x):
    return torch.sigmoid(x)
def _layernorm(x, axis=-1, eps=1e-5):
    m = x.mean(dim=axis, keepdim=True)
    v = x.var(dim=axis, keepdim=True, unbiased=False)
    return (x - m) / torch.sqrt(v + eps)
def _scatter_add(tgt, idx, src, axis=0):
    return tgt.clone().index_add_(axis, idx, src)
def _segment_sum(src, seg, n):
    out = torch.zeros((n,) + src.shape[1:], dtype=src.dtype)
    return out.index_add_(0, seg, src)
def _pad(x, pw):
    flat = tuple(v for pair in reversed(pw) for v in pair)
    return torch.nn.functional.pad(x, flat)

kernel_name = 'gated_mix__linear_kernel_hedgehog__glu_gated_swiglu__prompt'

def setup_inputs():

    _w = (lambda a: (lambda t: t.to(torch.bfloat16) if t.is_floating_point() else t)(torch.as_tensor(a)))
    def _A_setup():
        B, S, D, H = 1, 2048, 576, 32
        Dh = D // H
        return {
            "x": _w((lambda *s: torch.randn(*s, dtype=torch.bfloat16) * 0.05)(B, S, D)),
            "wqkv": _w((lambda *s: torch.randn(*s, dtype=torch.bfloat16) * 0.8)(D, 3 * D)),
            "w_phi": _w((lambda *s: torch.randn(*s, dtype=torch.bfloat16) * 0.8)(H, Dh, Dh) * (Dh ** -0.5)),
            "wo": _w((lambda *s: torch.randn(*s, dtype=torch.bfloat16) * 0.05)(D, D)),
        }
    _A_in = _A_setup()

    def _B_setup():
        B, S, D, F = 1, 2048, 576, 4608
        return {
            "x": _w((lambda *s: torch.randn(*s, dtype=torch.bfloat16) * 0.05)(B, S, D)),
            "w1": _w((lambda *s: torch.randn(*s, dtype=torch.bfloat16) * 1.6)(D, F) * (2.0 / D) ** 0.5),
            "w3": _w((lambda *s: torch.randn(*s, dtype=torch.bfloat16) * 1.6)(D, F) * (2.0 / D) ** 0.5),
            "w2": _w((lambda *s: torch.randn(*s, dtype=torch.bfloat16) * 1.6)(F, D) * (2.0 / F) ** 0.5),
        }
    _B_in = _B_setup()

    return {
        "A_x": _A_in["x"],
        "A_wqkv": _A_in["wqkv"],
        "A_w_phi": _A_in["w_phi"],
        "A_wo": _A_in["wo"],
        "B_x": _B_in["x"],
        "B_w1": _B_in["w1"],
        "B_w3": _B_in["w3"],
        "B_w2": _B_in["w2"],
        "gate_w": _w((lambda *s: torch.randn(*s, dtype=torch.bfloat16) * 0.05)(576) * 16.0),
    }

def reference(A_x, A_wqkv, A_w_phi, A_wo, B_x, B_w1, B_w3, B_w2, gate_w):
    def _A_ref(x, wqkv, w_phi, wo):
        B, S, D = x.shape
        H = 32; Dh = D // H
        qkv = (lambda x, *d: x.permute(*d))((x @ wqkv).reshape(B, S, 3, H, Dh), 2, 0, 3, 1, 4)
        q, k, v = qkv[0], qkv[1], qkv[2]
        pq = torch.einsum("bhsd,hdf->bhsf", q, w_phi)
        pk = torch.einsum("bhsd,hdf->bhsf", k, w_phi)
        phi_q = torch.concatenate([_softmax(pq, axis=-1), _softmax(-pq, axis=-1)], axis=-1)
        phi_k = torch.concatenate([_softmax(pk, axis=-1), _softmax(-pk, axis=-1)], axis=-1)
        kv = torch.einsum("bhsf,bhsd->bhfd", phi_k, v)
        z  = torch.einsum("bhsf->bhf", phi_k)
        num = torch.einsum("bhqf,bhfd->bhqd", phi_q, kv)
        den = torch.einsum("bhqf,bhf->bhq", phi_q, z)[..., None] + 1e-6
        o = num / den
        return (lambda x, *d: x.permute(*d))(o, 0, 2, 1, 3).reshape(B, S, D) @ wo

    def _B_ref(x, w1, w3, w2):
        gate = torch.einsum("bsd,df->bsf", x, w1)
        up = torch.einsum("bsd,df->bsf", x, w3)
        h = _silu(gate) * up
        out = torch.einsum("bsf,fd->bsd", h, w2)
        return out

    x = A_x
    g = _sigmoid((x * gate_w).sum(-1, keepdims=True))
    a = _A_ref(x, A_wqkv, A_w_phi, A_wo)
    b = _B_ref(x, B_w1, B_w3, B_w2)
    return g * a + (1 - g) * b
```

```asm
; @launch grid=(256,1,1) block=(256,1,1) lds=163840
.amdgcn_target "amdgcn-amd-amdhsa--gfx950"
.text
.globl gated_mix__linear_kernel_hedgehog__glu_gated_swiglu__prompt_kernel
.p2align 8
.type gated_mix__linear_kernel_hedgehog__glu_gated_swiglu__prompt_kernel,@function
gated_mix__linear_kernel_hedgehog__glu_gated_swiglu__prompt_kernel:
s_cmp_ge_u32 s2, 256
s_cbranch_scc1 L_end
s_load_dwordx16 s[4:19], s[0:1], 0
s_load_dwordx8 s[20:27], s[0:1], 64
v_lshrrev_b32 v48, 6, v0
v_and_b32 v0, 63, v0
v_readfirstlane_b32 s78, v48
s_getpc_b64 s[72:73]
L_pc:
s_lshr_b32 s85, s2, 3
s_lshl_b32 s85, s85, 2
s_nop 0
s_add_u32 s85, s85, s78
s_mul_i32 s85, s85, 4
v_min_u32 v55, 3, v0
v_add_u32 v55, s85, v55
s_lshl_b32 s86, s78, 3
v_and_b32 v51, 7, v0
v_add_u32 v51, s86, v51
v_cmp_gt_u32 vcc, 32, v0
v_add_u32 v55, 32, v55
s_nop 0
v_cndmask_b32 v55, v51, v55, vcc
v_lshlrev_b32 v55, 7, v55
v_min_u32 v55, L_end-L_pc-4, v55
v_and_b32 v55, -4, v55
v_mov_b32 v47, s73
v_add_co_u32 v46, vcc, s72, v55
s_nop 1
v_addc_co_u32 v47, vcc, 0, v47, vcc
global_load_dword v54, v[46:47], off
s_bfe_u32 s76, s2, 0x30000
s_lshl_b32 s76, s76, 1
s_bfe_u32 s85, s2, 0x10003
s_add_u32 s76, s76, s85
s_lshr_b32 s101, s2, 4
s_mov_b32 s77, s101
s_lshr_b32 s79, s78, 1
s_and_b32 s80, s78, 1
s_mov_b32 s87, 0xbfb8aa3b
s_mov_b32 s88, 0x3fb8aa3b
s_mul_i32 s85, s76, 288
s_and_b32 s86, s76, 1
s_lshl_b32 s91, s86, 5
s_add_u32 s92, s85, s91
s_lshl_b32 s91, s86, 8
s_add_u32 s93, s85, 256
s_sub_u32 s93, s93, s91
s_lshl_b32 s82, s92, 1
s_lshl_b32 s83, s93, 1
s_lshl_b32 s84, s78, 11
s_add_u32 s84, s84, 73728
s_lshl_b32 s90, s78, 12
v_lshrrev_b32 v48, 3, v0
s_lshl_b32 s85, s78, 3
v_add_u32 v48, s85, v48
v_mul_u32_u24 v48, 9216, v48
v_bfe_u32 v49, v0, 4, 1
s_lshl_b32 s86, s80, 1
v_or_b32 v49, s86, v49
v_bfe_u32 v50, v0, 1, 2
v_xor_b32 v49, v49, v50
v_lshlrev_b32 v49, 5, v49
v_and_b32 v50, 1, v0
v_lshlrev_b32 v50, 4, v50
v_add3_u32 v1, v48, v49, v50
s_lshl_b32 s85, s77, 7
s_lshl_b32 s86, s78, 5
s_add_u32 s85, s85, s86
v_lshrrev_b32 v48, 3, v0
v_add_u32 v48, s85, v48
v_mul_u32_u24 v48, 1152, v48
v_lshrrev_b32 v49, 4, v0
v_and_b32 v50, 7, v0
v_xor_b32 v49, v49, v50
v_lshlrev_b32 v49, 4, v49
v_add_u32 v32, v48, v49
v_xor_b32 v49, 64, v49
v_add_u32 v33, v48, v49
s_waitcnt lgkmcnt(0)
s_and_b32 s100, s76, 1
s_mul_i32 s0, s100, 512
s_mul_i32 s1, s100, -640
s_mul_i32 s85, s100, 2359296
s_add_u32 s12, s82, s85
s_mul_i32 s86, s100, -2949120
s_add_u32 s13, s82, s86
s_add_u32 s28, s4, 0
s_addc_u32 s29, s5, 0
s_mov_b32 s30, 2359296
s_mov_b32 s31, 0x20000
s_add_u32 s40, s14, 0
s_addc_u32 s41, s15, 0
s_mov_b32 s42, 5308416
s_mov_b32 s43, 0x20000
s_sub_u32 s44, s16, 1024
s_subb_u32 s45, s17, 0
s_mov_b32 s46, 5309440
s_mov_b32 s47, 0x20000
s_add_u32 m0, s90, 0
s_add_u32 s89, s0, 0
buffer_load_dwordx4 v32, s[28:31], s89 offen lds
s_add_u32 s89, s0, 8192
buffer_load_dwordx4 v33, s[28:31], s89 offen offset:1024 lds
s_add_u32 s89, s0, 16384
buffer_load_dwordx4 v32, s[28:31], s89 offen offset:2048 lds
s_add_u32 s89, s0, 24576
buffer_load_dwordx4 v33, s[28:31], s89 offen offset:3072 lds
s_add_u32 m0, s84, 57344
s_add_u32 s81, s12, 0
buffer_load_dwordx4 v1, s[40:43], s81 offen lds
buffer_load_dwordx4 v1, s[44:47], s81 offen offset:1024 lds
s_add_u32 m0, s84, 0
s_add_u32 s81, s12, 128
buffer_load_dwordx4 v1, s[40:43], s81 offen lds
buffer_load_dwordx4 v1, s[44:47], s81 offen offset:1024 lds
s_mul_i32 s85, s101, 36
s_mul_i32 s86, s78, 9
s_add_u32 s85, s85, s86
v_min_u32 v53, 8, v0
v_add_u32 v53, s85, v53
v_mul_u32_u24 v53, 9216, v53
s_add_u32 s85, s82, 0
buffer_load_dword v54, v53, s[40:43], s85 offen
buffer_load_dword v54, v53, s[44:47], s85 offen offset:1024
s_add_u32 s85, s82, 128
buffer_load_dword v54, v53, s[40:43], s85 offen
buffer_load_dword v54, v53, s[44:47], s85 offen offset:1024
s_add_u32 s32, s6, 0
s_addc_u32 s33, s7, 0
s_mov_b32 s34, 1990656
s_mov_b32 s35, 0x20000
s_add_u32 s36, s6, 12800
s_addc_u32 s37, s7, 0
s_mov_b32 s38, 1977856
s_mov_b32 s39, 0x20000
s_add_u32 s52, s18, 0
s_addc_u32 s53, s19, 0
s_mov_b32 s54, 5308416
s_mov_b32 s55, 0x20000
s_sub_u32 s56, s10, 2048
s_subb_u32 s57, s11, 0
s_mov_b32 s58, 665600
s_mov_b32 s59, 0x20000
s_add_u32 s64, s26, 37756928
s_addc_u32 s65, s27, 0
s_mov_b32 s66, 786432
s_mov_b32 s67, 0x20000
s_add_u32 s60, s26, 0
s_addc_u32 s61, s27, 0
s_mov_b32 s62, 67108864
s_mov_b32 s63, 0x20000
s_add_u32 s68, s24, 0
s_addc_u32 s69, s25, 0
s_mov_b32 s70, 256
s_mov_b32 s71, 0x20000
s_add_u32 s72, s20, 0
s_addc_u32 s73, s21, 0
s_mov_b32 s74, 1152
s_mov_b32 s75, 0x20000
s_cmp_ge_u32 s78, 2
s_cselect_b32 s48, s16, s14
s_cselect_b32 s49, s17, s15
s_mov_b32 s50, 5308416
s_mov_b32 s51, 0x20000
s_mul_i32 s6, s100, 884736
s_mul_i32 s7, s100, -1105920
s_mul_i32 s85, s100, 2359296
s_add_u32 s10, s83, s85
s_mul_i32 s85, s100, -2949120
s_add_u32 s11, s83, s85
s_lshl_b32 s85, s77, 8
s_lshl_b32 s86, s76, 2
s_add_u32 s85, s85, s86
s_add_u32 s85, s85, 41943040
s_mov_b32 s86, 2146435072
s_cmp_eq_u32 s78, 0
s_cselect_b32 s27, s85, s86
s_cselect_b32 s3, 0xffff, 0
v_mov_b32 v48, s86
v_mov_b32 v49, s27
v_cmp_eq_u32 vcc, 0, v0
v_mov_b32 v50, 0
s_nop 0
v_cndmask_b32 v48, v48, v49, vcc
buffer_store_dword v50, v48, s[60:63], 0 offen sc1
s_lshl_b32 s85, s78, 7
v_lshlrev_b32 v48, 1, v0
v_add_u32 v48, s85, v48
s_lshl_b32 s86, s100, 9
v_add_u32 v49, 0, v48
v_add_u32 v50, s86, v49
v_subrev_u32 v51, 1152, v50
v_min_u32 v50, v50, v51
buffer_load_ushort v40, v50, s[72:75], 0 offen
v_add_u32 v49, 512, v48
v_add_u32 v50, s86, v49
v_subrev_u32 v51, 1152, v50
v_min_u32 v50, v50, v51
buffer_load_ushort v41, v50, s[72:75], 0 offen
v_add_u32 v49, 1024, v48
v_add_u32 v50, s86, v49
v_subrev_u32 v51, 1152, v50
v_min_u32 v50, v50, v51
v_cmp_gt_u32 vcc, 1152, v49
s_nop 1
v_cndmask_b32 v50, v49, v50, vcc
buffer_load_ushort v42, v50, s[72:75], 0 offen
s_add_u32 m0, s90, 16384
s_add_u32 s89, s0, 128
buffer_load_dwordx4 v32, s[28:31], s89 offen lds
s_add_u32 s89, s0, 8320
buffer_load_dwordx4 v33, s[28:31], s89 offen offset:1024 lds
s_add_u32 s89, s0, 16512
buffer_load_dwordx4 v32, s[28:31], s89 offen offset:2048 lds
s_add_u32 s89, s0, 24704
buffer_load_dwordx4 v33, s[28:31], s89 offen offset:3072 lds
s_add_u32 m0, s84, 8192
s_add_u32 s81, s12, 294912
buffer_load_dwordx4 v1, s[40:43], s81 offen lds
buffer_load_dwordx4 v1, s[44:47], s81 offen offset:1024 lds
s_add_u32 m0, s84, 16384
s_add_u32 s81, s12, 589824
buffer_load_dwordx4 v1, s[40:43], s81 offen lds
buffer_load_dwordx4 v1, s[44:47], s81 offen offset:1024 lds
v_lshrrev_b32 v48, 4, v0
v_bfe_u32 v49, v0, 2, 2
v_lshlrev_b32 v50, 11, v48
v_lshl_add_u32 v50, v49, 7, v50
v_and_b32 v51, 3, v0
v_lshl_add_u32 v50, v51, 3, v50
v_lshrrev_b32 v49, 1, v49
v_and_b32 v48, 1, v48
v_lshl_or_b32 v49, v48, 1, v49
s_lshl_b32 s86, s80, 1
v_xor_b32 v49, s86, v49
v_lshlrev_b32 v49, 5, v49
v_add_u32 v50, 73728, v50
v_add_u32 v2, v50, v49
v_xor_b32 v49, 32, v49
v_add_u32 v3, v50, v49
v_and_b32 v48, 15, v0
v_lshrrev_b32 v49, 1, v48
v_lshrrev_b32 v50, 4, v0
v_xor_b32 v49, v49, v50
v_lshlrev_b32 v49, 4, v49
s_lshl_b32 s85, s79, 13
v_lshlrev_b32 v48, 7, v48
v_add_u32 v48, s85, v48
v_add_u32 v34, v48, v49
v_xor_b32 v49, 64, v49
v_add_u32 v35, v48, v49
s_lshl_b32 s85, s79, 12
s_lshl_b32 s86, s80, 13
s_add_u32 s85, s85, s86
v_lshlrev_b32 v48, 4, v0
v_add_u32 v4, s85, v48
s_waitcnt vmcnt(16)
s_barrier
s_add_u32 m0, s84, 24576
s_add_u32 s81, s12, 884736
ds_read_b64_tr_b16 v[64:65], v2 offset:57344
ds_read_b64_tr_b16 v[66:67], v2 offset:57856
ds_read_b64_tr_b16 v[68:69], v2 offset:58368
ds_read_b64_tr_b16 v[70:71], v2 offset:58880
ds_read_b64_tr_b16 v[72:73], v3 offset:57344
ds_read_b64_tr_b16 v[74:75], v3 offset:57856
ds_read_b64_tr_b16 v[76:77], v3 offset:58368
ds_read_b64_tr_b16 v[78:79], v3 offset:58880
ds_read_b64_tr_b16 v[80:81], v2
ds_read_b64_tr_b16 v[82:83], v2 offset:512
ds_read_b64_tr_b16 v[84:85], v2 offset:1024
ds_read_b128 a[0:3], v34
ds_read_b128 a[4:7], v34 offset:2048
ds_read_b128 a[8:11], v34 offset:4096
ds_read_b128 a[12:15], v34 offset:6144
s_waitcnt lgkmcnt(3)
v_mfma_f32_16x16x32_bf16 v[128:131], v[64:67], a[0:3], 0
buffer_load_dwordx4 v1, s[40:43], s81 offen lds
s_waitcnt lgkmcnt(2)
v_mfma_f32_16x16x32_bf16 v[132:135], v[64:67], a[4:7], 0
buffer_load_dwordx4 v1, s[44:47], s81 offen offset:1024 lds
ds_read_b64_tr_b16 v[86:87], v2 offset:1536
s_waitcnt lgkmcnt(2)
v_mfma_f32_16x16x32_bf16 v[136:139], v[64:67], a[8:11], 0
s_add_u32 m0, s84, 32768
s_add_u32 s81, s12, 295040
v_mov_b32 v63, 1
v_lshrrev_b32 v48, 4, v0
s_waitcnt lgkmcnt(1)
v_mfma_f32_16x16x32_bf16 v[140:143], v[64:67], a[12:15], 0
buffer_load_dwordx4 v1, s[40:43], s81 offen lds
ds_read_b64_tr_b16 v[88:89], v3
v_mfma_f32_16x16x32_bf16 v[156:159], v[68:71], a[12:15], 0
buffer_load_dwordx4 v1, s[44:47], s81 offen offset:1024 lds
v_mfma_f32_16x16x32_bf16 v[152:155], v[68:71], a[8:11], 0
s_add_u32 m0, s84, 40960
s_add_u32 s81, s12, 1179648
ds_read_b64_tr_b16 v[90:91], v3 offset:512
v_and_b32 v50, 15, v0
v_mfma_f32_16x16x32_bf16 v[148:151], v[68:71], a[4:7], 0
buffer_load_dwordx4 v1, s[40:43], s81 offen lds
v_mfma_f32_16x16x32_bf16 v[144:147], v[68:71], a[0:3], 0
buffer_load_dwordx4 v1, s[44:47], s81 offen offset:1024 lds
ds_read_b64_tr_b16 v[92:93], v3 offset:1024
v_mfma_f32_16x16x32_bf16 v[160:163], v[72:75], a[0:3], 0
s_lshl_b32 s86, s80, 2
v_or_b32 v49, s86, v48
v_lshlrev_b32 v49, 1, v49
v_mfma_f32_16x16x32_bf16 v[164:167], v[72:75], a[4:7], 0
s_waitcnt vmcnt(6)
ds_read_b64_tr_b16 v[94:95], v3 offset:1536
v_xor_b32 v49, v49, v50
v_mfma_f32_16x16x32_bf16 v[168:171], v[72:75], a[8:11], 0
s_barrier
v_mfma_f32_16x16x32_bf16 v[172:175], v[72:75], a[12:15], 0
s_add_u32 m0, s84, 49152
s_add_u32 s81, s12, 1474560
ds_read_b64_tr_b16 v[64:65], v2 offset:8192
v_cmp_le_u32 vcc, 6, v49
v_mfma_f32_16x16x32_bf16 v[188:191], v[76:79], a[12:15], 0
buffer_load_dwordx4 v1, s[40:43], s81 offen lds
v_mfma_f32_16x16x32_bf16 v[184:187], v[76:79], a[8:11], 0
s_lshl_b32 s85, s78, 3
ds_read_b64_tr_b16 v[66:67], v2 offset:8704
v_add_u32 v48, s85, v48
v_mfma_f32_16x16x32_bf16 v[180:183], v[76:79], a[4:7], 0
buffer_load_dwordx4 v1, s[44:47], s81 offen offset:1024 lds
v_mfma_f32_16x16x32_bf16 v[176:179], v[76:79], a[0:3], 0
ds_read_b64_tr_b16 v[68:69], v2 offset:9216
v_mul_u32_u24 v48, 3456, v48
v_mfma_f32_16x16x32_bf16 v[192:195], v[80:83], a[0:3], 0
ds_read_b128 a[16:19], v35
v_cndmask_b32 v50, 0, v63, vcc
v_mfma_f32_16x16x32_bf16 v[196:199], v[80:83], a[4:7], 0
s_add_u32 m0, s84, 57344
ds_read_b64_tr_b16 v[70:71], v2 offset:9728
v_cmp_le_u32 vcc, 11, v49
v_mfma_f32_16x16x32_bf16 v[200:203], v[80:83], a[8:11], 0
s_mul_i32 s85, s76, 72
ds_read_b128 a[20:23], v35 offset:2048
v_mul_u32_u24 v52, 6, v50
v_mfma_f32_16x16x32_bf16 v[204:207], v[80:83], a[12:15], 0
s_add_u32 s81, s12, 1769472
ds_read_b64_tr_b16 v[72:73], v3 offset:8192
v_cndmask_b32 v51, 0, v63, vcc
s_waitcnt lgkmcnt(5)
v_mfma_f32_16x16x32_bf16 v[220:223], v[84:87], a[12:15], 0
ds_read_b128 a[24:27], v35 offset:4096
v_sub_u32 v49, v49, v52
v_mfma_f32_16x16x32_bf16 v[216:219], v[84:87], a[8:11], 0
ds_read_b64_tr_b16 v[74:75], v3 offset:8704
v_mul_u32_u24 v52, 5, v51
v_mfma_f32_16x16x32_bf16 v[212:215], v[84:87], a[4:7], 0
ds_read_b128 a[28:31], v35 offset:6144
v_sub_u32 v49, v49, v52
v_mfma_f32_16x16x32_bf16 v[208:211], v[84:87], a[0:3], 0
ds_read_b64_tr_b16 v[76:77], v3 offset:9216
v_min_u32 v49, 4, v49
v_mfma_f32_16x16x32_bf16 v[224:227], v[88:91], a[0:3], 0
buffer_load_dwordx4 v1, s[40:43], s81 offen lds
v_mfma_f32_16x16x32_bf16 v[228:231], v[88:91], a[4:7], 0
ds_read_b64_tr_b16 v[78:79], v3 offset:9728
v_add_u32 v50, v50, v51
v_mfma_f32_16x16x32_bf16 v[232:235], v[88:91], a[8:11], 0
buffer_load_dwordx4 v1, s[44:47], s81 offen offset:1024 lds
v_mfma_f32_16x16x32_bf16 v[236:239], v[88:91], a[12:15], 0
s_add_u32 m0, s90, 32768
s_add_u32 s89, s0, 256
ds_read_b64_tr_b16 v[80:81], v2 offset:16384
v_mul_u32_u24 v50, 1152, v50
v_mfma_f32_16x16x32_bf16 v[252:255], v[92:95], a[12:15], 0
buffer_load_dwordx4 v32, s[28:31], s89 offen lds
v_mfma_f32_16x16x32_bf16 v[248:251], v[92:95], a[8:11], 0
s_add_u32 s89, s0, 8448
ds_read_b64_tr_b16 v[82:83], v2 offset:16896
v_add_u32 v48, v48, v50
v_mfma_f32_16x16x32_bf16 v[244:247], v[92:95], a[4:7], 0
buffer_load_dwordx4 v33, s[28:31], s89 offen offset:1024 lds
v_mfma_f32_16x16x32_bf16 v[240:243], v[92:95], a[0:3], 0
s_add_u32 s89, s0, 16640
ds_read_b64_tr_b16 v[84:85], v2 offset:17408
v_lshrrev_b32 v51, 2, v49
s_waitcnt lgkmcnt(3)
v_mfma_f32_16x16x32_bf16 v[128:131], v[64:67], a[16:19], v[128:131]
buffer_load_dwordx4 v32, s[28:31], s89 offen offset:2048 lds
ds_read_b128 a[32:35], v34 offset:16384
v_mfma_f32_16x16x32_bf16 v[132:135], v[64:67], a[20:23], v[132:135]
ds_read_b64_tr_b16 v[86:87], v2 offset:17920
v_lshlrev_b32 v49, 4, v49
v_mfma_f32_16x16x32_bf16 v[136:139], v[64:67], a[24:27], v[136:139]
ds_read_b128 a[36:39], v34 offset:18432
v_lshlrev_b32 v51, 3, v51
v_mfma_f32_16x16x32_bf16 v[140:143], v[64:67], a[28:31], v[140:143]
ds_read_b64_tr_b16 v[88:89], v3 offset:16384
v_sub_u32 v49, v49, v51
v_mfma_f32_16x16x32_bf16 v[156:159], v[68:71], a[28:31], v[156:159]
ds_read_b128 a[40:43], v34 offset:20480
v_add3_u32 v56, v48, v49, s85
v_mfma_f32_16x16x32_bf16 v[152:155], v[68:71], a[24:27], v[152:155]
s_mov_b32 s85, 0x38302820
ds_read_b64_tr_b16 v[90:91], v3 offset:16896
v_lshrrev_b32 v48, 4, v0
v_mfma_f32_16x16x32_bf16 v[148:151], v[68:71], a[20:23], v[148:151]
s_cmp_eq_u32 s80, 0
s_cselect_b32 s85, 0x18100800, s85
ds_read_b128 a[44:47], v34 offset:22528
v_bfe_u32 v49, v0, 2, 2
v_mfma_f32_16x16x32_bf16 v[144:147], v[68:71], a[16:19], v[144:147]
s_add_u32 s89, s0, 24832
ds_read_b64_tr_b16 v[92:93], v3 offset:17408
v_lshlrev_b32 v50, 11, v48
v_mfma_f32_16x16x32_bf16 v[160:163], v[72:75], a[16:19], v[160:163]
buffer_load_dwordx4 v33, s[28:31], s89 offen offset:3072 lds
v_mfma_f32_16x16x32_bf16 v[164:167], v[72:75], a[20:23], v[164:167]
s_waitcnt vmcnt(10) lgkmcnt(1)
ds_read_b64_tr_b16 v[94:95], v3 offset:17920
v_lshl_add_u32 v50, v49, 8, v50
v_mfma_f32_16x16x32_bf16 v[168:171], v[72:75], a[24:27], v[168:171]
s_barrier
v_mfma_f32_16x16x32_bf16 v[172:175], v[72:75], a[28:31], v[172:175]
s_add_u32 m0, s84, 0
s_add_u32 s81, s12, 589952
ds_read_b64_tr_b16 v[64:65], v2 offset:24576
v_add_u32 v50, 73728, v50
v_mfma_f32_16x16x32_bf16 v[188:191], v[76:79], a[28:31], v[188:191]
buffer_load_dwordx4 v1, s[40:43], s81 offen lds
v_mfma_f32_16x16x32_bf16 v[184:187], v[76:79], a[24:27], v[184:187]
ds_read_b64_tr_b16 v[66:67], v2 offset:25088
v_and_b32 v48, 1, v48
v_mfma_f32_16x16x32_bf16 v[180:183], v[76:79], a[20:23], v[180:183]
buffer_load_dwordx4 v1, s[44:47], s81 offen offset:1024 lds
v_mfma_f32_16x16x32_bf16 v[176:179], v[76:79], a[16:19], v[176:179]
ds_read_b64_tr_b16 v[68:69], v2 offset:25600
v_lshl_or_b32 v48, v48, 2, v49
v_mfma_f32_16x16x32_bf16 v[128:131], v[80:83], a[32:35], v[128:131]
ds_read_b128 a[48:51], v35 offset:16384
v_lshlrev_b32 v48, 5, v48
v_mfma_f32_16x16x32_bf16 v[132:135], v[80:83], a[36:39], v[132:135]
s_add_u32 m0, s84, 8192
ds_read_b64_tr_b16 v[70:71], v2 offset:26112
v_and_b32 v49, 3, v0
v_mfma_f32_16x16x32_bf16 v[136:139], v[80:83], a[40:43], v[136:139]
ds_read_b128 a[52:55], v35 offset:18432
v_lshlrev_b32 v49, 3, v49
v_mfma_f32_16x16x32_bf16 v[140:143], v[80:83], a[44:47], v[140:143]
s_add_u32 s81, s12, 2064384
ds_read_b64_tr_b16 v[72:73], v3 offset:24576
v_bfe_u32 v51, s85, v49, 8
v_mfma_f32_16x16x32_bf16 v[156:159], v[84:87], a[44:47], v[156:159]
s_mov_b32 s85, 0xe0d8d048
ds_read_b128 a[56:59], v35 offset:20480
v_xor_b32 v51, v51, v48
v_mfma_f32_16x16x32_bf16 v[152:155], v[84:87], a[40:43], v[152:155]
s_cmp_eq_u32 s80, 0
s_cselect_b32 s85, 0xc0b8b020, s85
ds_read_b64_tr_b16 v[74:75], v3 offset:25088
v_add_u32 v57, v50, v51
v_mfma_f32_16x16x32_bf16 v[148:151], v[84:87], a[36:39], v[148:151]
ds_read_b128 a[60:63], v35 offset:22528
v_bfe_u32 v51, s85, v49, 8
v_mfma_f32_16x16x32_bf16 v[144:147], v[84:87], a[32:35], v[144:147]
s_mov_b32 s85, 0x98908880
ds_read_b64_tr_b16 v[76:77], v3 offset:25600
v_xor_b32 v51, v51, v48
v_mfma_f32_16x16x32_bf16 v[160:163], v[88:91], a[32:35], v[160:163]
buffer_load_dwordx4 v1, s[40:43], s81 offen lds
v_mfma_f32_16x16x32_bf16 v[164:167], v[88:91], a[36:39], v[164:167]
s_cmp_eq_u32 s80, 0
s_cselect_b32 s85, 0x78706860, s85
ds_read_b64_tr_b16 v[78:79], v3 offset:26112
v_add_u32 v58, v50, v51
v_mfma_f32_16x16x32_bf16 v[168:171], v[88:91], a[40:43], v[168:171]
buffer_load_dwordx4 v1, s[44:47], s81 offen offset:1024 lds
v_mfma_f32_16x16x32_bf16 v[172:175], v[88:91], a[44:47], v[172:175]
s_add_u32 m0, s90, 49152
s_add_u32 s89, s0, 384
ds_read_b64_tr_b16 v[80:81], v2 offset:32768
v_bfe_u32 v51, s85, v49, 8
s_waitcnt lgkmcnt(4)
v_mfma_f32_16x16x32_bf16 v[188:191], v[92:95], a[44:47], v[188:191]
buffer_load_dwordx4 v32, s[28:31], s89 offen lds
v_mfma_f32_16x16x32_bf16 v[184:187], v[92:95], a[40:43], v[184:187]
s_add_u32 s89, s0, 8576
ds_read_b64_tr_b16 v[82:83], v2 offset:33280
v_xor_b32 v51, v51, v48
v_mfma_f32_16x16x32_bf16 v[180:183], v[92:95], a[36:39], v[180:183]
buffer_load_dwordx4 v33, s[28:31], s89 offen offset:1024 lds
v_mfma_f32_16x16x32_bf16 v[176:179], v[92:95], a[32:35], v[176:179]
s_add_u32 s89, s0, 16768
ds_read_b64_tr_b16 v[84:85], v2 offset:33792
v_add_u32 v59, v50, v51
v_mfma_f32_16x16x32_bf16 v[128:131], v[64:67], a[48:51], v[128:131]
buffer_load_dwordx4 v32, s[28:31], s89 offen offset:2048 lds
v_mfma_f32_16x16x32_bf16 v[132:135], v[64:67], a[52:55], v[132:135]
s_mov_b32 s85, 0xf8f8e8a8
ds_read_b64_tr_b16 v[86:87], v2 offset:34304
v_mfma_f32_16x16x32_bf16 v[136:139], v[64:67], a[56:59], v[136:139]
s_cmp_eq_u32 s80, 0
s_cselect_b32 s85, 0xd0d0c880, s85
v_bfe_u32 v51, s85, v49, 8
v_xor_b32 v51, v51, v48
s_waitcnt lgkmcnt(3)
v_mfma_f32_16x16x32_bf16 v[140:143], v[64:67], a[60:63], v[140:143]
s_lshl_b32 s85, s78, 8
ds_read_b64_tr_b16 v[88:89], v3 offset:32768
v_add_u32 v60, v50, v51
v_mfma_f32_16x16x32_bf16 v[156:159], v[68:71], a[60:63], v[156:159]
s_add_u32 s85, s85, 139264
v_and_b32 v49, 3, v0
v_cmp_eq_u32 vcc, 3, v49
v_mfma_f32_16x16x32_bf16 v[152:155], v[68:71], a[56:59], v[152:155]
ds_read_b64_tr_b16 v[90:91], v3 offset:33280
v_lshrrev_b32 v51, 2, v0
v_mfma_f32_16x16x32_bf16 v[148:151], v[68:71], a[52:55], v[148:151]
v_lshlrev_b32 v51, 3, v51
v_add_u32 v51, 139264, v51
v_mfma_f32_16x16x32_bf16 v[144:147], v[68:71], a[48:51], v[144:147]
s_add_u32 s89, s0, 24960
ds_read_b64_tr_b16 v[92:93], v3 offset:33792
v_cndmask_b32 v60, v60, v51, vcc
v_mfma_f32_16x16x32_bf16 v[160:163], v[72:75], a[48:51], v[160:163]
buffer_load_dwordx4 v33, s[28:31], s89 offen offset:3072 lds
v_mfma_f32_16x16x32_bf16 v[164:167], v[72:75], a[52:55], v[164:167]
s_waitcnt vmcnt(8)
ds_read_b64_tr_b16 v[94:95], v3 offset:34304
v_cndmask_b32 v61, 0, v63, vcc
v_mfma_f32_16x16x32_bf16 v[168:171], v[72:75], a[56:59], v[168:171]
s_barrier
v_mfma_f32_16x16x32_bf16 v[172:175], v[72:75], a[60:63], v[172:175]
s_add_u32 m0, s84, 16384
s_add_u32 s81, s12, 2359296
ds_read_b64_tr_b16 v[64:65], v2 offset:40960
v_lshrrev_b32 v48, 5, v0
v_mfma_f32_16x16x32_bf16 v[188:191], v[76:79], a[60:63], v[188:191]
buffer_load_dwordx4 v1, s[40:43], s81 offen lds
v_mfma_f32_16x16x32_bf16 v[184:187], v[76:79], a[56:59], v[184:187]
ds_read_b64_tr_b16 v[66:67], v2 offset:41472
v_lshlrev_b32 v48, 7, v48
v_mfma_f32_16x16x32_bf16 v[180:183], v[76:79], a[52:55], v[180:183]
buffer_load_dwordx4 v1, s[44:47], s81 offen offset:1024 lds
v_mfma_f32_16x16x32_bf16 v[176:179], v[76:79], a[48:51], v[176:179]
s_waitcnt lgkmcnt(2)
ds_read_b64_tr_b16 v[68:69], v2 offset:41984
v_bfe_u32 v49, v0, 3, 2
v_mfma_f32_16x16x32_bf16 v[192:195], v[80:83], a[16:19], v[192:195]
ds_read_b128 a[64:67], v34 offset:32768
v_lshl_add_u32 v48, v49, 5, v48
v_mfma_f32_16x16x32_bf16 v[196:199], v[80:83], a[20:23], v[196:199]
s_add_u32 m0, s84, 24576
ds_read_b64_tr_b16 v[70:71], v2 offset:42496
v_bfe_u32 v49, v0, 2, 1
v_mfma_f32_16x16x32_bf16 v[200:203], v[80:83], a[24:27], v[200:203]
ds_read_b128 a[68:71], v34 offset:34816
v_lshl_add_u32 v48, v49, 10, v48
v_mfma_f32_16x16x32_bf16 v[204:207], v[80:83], a[28:31], v[204:207]
s_add_u32 s81, s12, 2654208
ds_read_b64_tr_b16 v[72:73], v3 offset:40960
v_and_b32 v49, 3, v0
v_mfma_f32_16x16x32_bf16 v[220:223], v[84:87], a[28:31], v[220:223]
s_mul_i32 s86, s78, 9
ds_read_b128 a[72:75], v34 offset:36864
v_lshl_add_u32 v48, v49, 3, v48
v_mfma_f32_16x16x32_bf16 v[216:219], v[84:87], a[24:27], v[216:219]
ds_read_b64_tr_b16 v[74:75], v3 offset:41472
v_add_u32 v48, s85, v48
v_mfma_f32_16x16x32_bf16 v[212:215], v[84:87], a[20:23], v[212:215]
s_mul_i32 s85, s101, 36
ds_read_b128 a[76:79], v34 offset:38912
v_lshl_or_b32 v44, v40, 16, v40
v_mfma_f32_16x16x32_bf16 v[208:211], v[84:87], a[16:19], v[208:211]
s_add_u32 s85, s85, s86
ds_read_b64_tr_b16 v[76:77], v3 offset:41984
v_mov_b32 v45, v44
v_mfma_f32_16x16x32_bf16 v[224:227], v[88:91], a[16:19], v[224:227]
buffer_load_dwordx4 v1, s[40:43], s81 offen lds
v_mfma_f32_16x16x32_bf16 v[228:231], v[88:91], a[20:23], v[228:231]
ds_read_b64_tr_b16 v[78:79], v3 offset:42496
v_min_u32 v53, 17, v0
v_mfma_f32_16x16x32_bf16 v[232:235], v[88:91], a[24:27], v[232:235]
buffer_load_dwordx4 v1, s[44:47], s81 offen offset:1024 lds
v_mfma_f32_16x16x32_bf16 v[236:239], v[88:91], a[28:31], v[236:239]
s_add_u32 m0, s90, 0
s_add_u32 s89, s0, 512
ds_read_b64_tr_b16 v[80:81], v2 offset:49152
v_mul_u32_u24 v55, 43, v53
v_mfma_f32_16x16x32_bf16 v[252:255], v[92:95], a[28:31], v[252:255]
buffer_load_dwordx4 v32, s[28:31], s89 offen lds
v_mfma_f32_16x16x32_bf16 v[248:251], v[92:95], a[24:27], v[248:251]
s_add_u32 s89, s0, 8704
ds_read_b64_tr_b16 v[82:83], v2 offset:49664
v_lshrrev_b32 v55, 8, v55
v_mfma_f32_16x16x32_bf16 v[244:247], v[92:95], a[20:23], v[244:247]
buffer_load_dwordx4 v33, s[28:31], s89 offen offset:1024 lds
v_mfma_f32_16x16x32_bf16 v[240:243], v[92:95], a[16:19], v[240:243]
s_add_u32 s89, s0, 16896
ds_read_b64_tr_b16 v[84:85], v2 offset:50176
v_mul_u32_u24 v52, 6, v55
s_waitcnt lgkmcnt(3)
v_mfma_f32_16x16x32_bf16 v[128:131], v[64:67], a[64:67], v[128:131]
buffer_load_dwordx4 v32, s[28:31], s89 offen offset:2048 lds
ds_read_b128 a[80:83], v35 offset:32768
v_mfma_f32_16x16x32_bf16 v[132:135], v[64:67], a[68:71], v[132:135]
ds_read_b64_tr_b16 v[86:87], v2 offset:50688
v_sub_u32 v53, v53, v52
v_mfma_f32_16x16x32_bf16 v[136:139], v[64:67], a[72:75], v[136:139]
ds_read_b128 a[84:87], v35 offset:34816
v_add_u32 v55, s85, v55
v_mfma_f32_16x16x32_bf16 v[140:143], v[64:67], a[76:79], v[140:143]
ds_read_b64_tr_b16 v[88:89], v3 offset:49152
v_mul_u32_u24 v55, 3456, v55
v_mfma_f32_16x16x32_bf16 v[156:159], v[68:71], a[76:79], v[156:159]
s_mul_i32 s14, s76, 72
ds_read_b128 a[88:91], v35 offset:36864
v_lshrrev_b32 v52, 1, v53
v_mfma_f32_16x16x32_bf16 v[152:155], v[68:71], a[72:75], v[152:155]
ds_read_b64_tr_b16 v[90:91], v3 offset:49664
v_mul_u32_u24 v52, 1152, v52
v_mfma_f32_16x16x32_bf16 v[148:151], v[68:71], a[68:71], v[148:151]
ds_read_b128 a[92:95], v35 offset:38912
v_add_u32 v55, v55, v52
v_mfma_f32_16x16x32_bf16 v[144:147], v[68:71], a[64:67], v[144:147]
s_add_u32 s89, s0, 25088
ds_read_b64_tr_b16 v[92:93], v3 offset:50176
v_and_b32 v53, 1, v53
v_mfma_f32_16x16x32_bf16 v[160:163], v[72:75], a[64:67], v[160:163]
buffer_load_dwordx4 v33, s[28:31], s89 offen offset:3072 lds
v_mfma_f32_16x16x32_bf16 v[164:167], v[72:75], a[68:71], v[164:167]
s_waitcnt vmcnt(8) lgkmcnt(1)
ds_read_b64_tr_b16 v[94:95], v3 offset:50688
v_mul_u32_u24 v53, 68, v53
v_mfma_f32_16x16x32_bf16 v[168:171], v[72:75], a[72:75], v[168:171]
s_barrier
v_mfma_f32_16x16x32_bf16 v[172:175], v[72:75], a[76:79], v[172:175]
s_add_u32 m0, s84, 32768
s_add_u32 s81, s12, 884864
ds_read_b64_tr_b16 v[64:65], v2 offset:57344
v_add_u32 v55, v55, v53
v_mfma_f32_16x16x32_bf16 v[188:191], v[76:79], a[76:79], v[188:191]
buffer_load_dwordx4 v1, s[40:43], s81 offen lds
v_mfma_f32_16x16x32_bf16 v[184:187], v[76:79], a[72:75], v[184:187]
ds_read_b64_tr_b16 v[66:67], v2 offset:57856
v_mfma_f32_16x16x32_bf16 v[180:183], v[76:79], a[68:71], v[180:183]
buffer_load_dwordx4 v1, s[44:47], s81 offen offset:1024 lds
v_mfma_f32_16x16x32_bf16 v[176:179], v[76:79], a[64:67], v[176:179]
ds_read_b64_tr_b16 v[68:69], v2 offset:58368
v_mfma_f32_16x16x32_bf16 v[128:131], v[80:83], a[80:83], v[128:131]
ds_read_b128 a[96:99], v34 offset:49152
v_mfma_f32_16x16x32_bf16 v[132:135], v[80:83], a[84:87], v[132:135]
s_add_u32 m0, s84, 40960
ds_read_b64_tr_b16 v[70:71], v2 offset:58880
v_mfma_f32_16x16x32_bf16 v[136:139], v[80:83], a[88:91], v[136:139]
ds_read_b128 a[100:103], v34 offset:51200
v_mfma_f32_16x16x32_bf16 v[140:143], v[80:83], a[92:95], v[140:143]
s_add_u32 s81, s13, 2949120
ds_read_b64_tr_b16 v[72:73], v3 offset:57344
v_mfma_f32_16x16x32_bf16 v[156:159], v[84:87], a[92:95], v[156:159]
ds_read_b128 a[104:107], v34 offset:53248
v_mfma_f32_16x16x32_bf16 v[152:155], v[84:87], a[88:91], v[152:155]
ds_read_b64_tr_b16 v[74:75], v3 offset:57856
v_mfma_f32_16x16x32_bf16 v[148:151], v[84:87], a[84:87], v[148:151]
ds_read_b128 a[108:111], v34 offset:55296
v_mfma_f32_16x16x32_bf16 v[144:147], v[84:87], a[80:83], v[144:147]
ds_read_b64_tr_b16 v[76:77], v3 offset:58368
v_mfma_f32_16x16x32_bf16 v[160:163], v[88:91], a[80:83], v[160:163]
buffer_load_dwordx4 v1, s[40:43], s81 offen lds
v_mfma_f32_16x16x32_bf16 v[164:167], v[88:91], a[84:87], v[164:167]
s_waitcnt lgkmcnt(2)
ds_read_b64_tr_b16 v[78:79], v3 offset:58880
v_mfma_f32_16x16x32_bf16 v[168:171], v[88:91], a[88:91], v[168:171]
buffer_load_dwordx4 v1, s[44:47], s81 offen offset:1024 lds
v_mfma_f32_16x16x32_bf16 v[172:175], v[88:91], a[92:95], v[172:175]
s_add_u32 m0, s90, 16384
s_add_u32 s89, s1, 640
ds_read_b64_tr_b16 v[80:81], v2
v_mfma_f32_16x16x32_bf16 v[188:191], v[92:95], a[92:95], v[188:191]
buffer_load_dwordx4 v32, s[28:31], s89 offen lds
v_mfma_f32_16x16x32_bf16 v[184:187], v[92:95], a[88:91], v[184:187]
s_add_u32 s89, s1, 8832
ds_read_b64_tr_b16 v[82:83], v2 offset:512
v_mfma_f32_16x16x32_bf16 v[180:183], v[92:95], a[84:87], v[180:183]
buffer_load_dwordx4 v33, s[28:31], s89 offen offset:1024 lds
v_mfma_f32_16x16x32_bf16 v[176:179], v[92:95], a[80:83], v[176:179]
s_add_u32 s89, s1, 17024
ds_read_b64_tr_b16 v[84:85], v2 offset:1024
v_mfma_f32_16x16x32_bf16 v[128:131], v[64:67], a[96:99], v[128:131]
buffer_load_dwordx4 v32, s[28:31], s89 offen offset:2048 lds
v_mfma_f32_16x16x32_bf16 v[132:135], v[64:67], a[100:103], v[132:135]
ds_read_b64_tr_b16 v[86:87], v2 offset:1536
v_mfma_f32_16x16x32_bf16 v[136:139], v[64:67], a[104:107], v[136:139]
s_waitcnt lgkmcnt(3)
ds_write_b64 v48, v[44:45]
v_mfma_f32_16x16x32_bf16 v[140:143], v[64:67], a[108:111], v[140:143]
ds_read_b64_tr_b16 v[88:89], v3
v_lshl_or_b32 v44, v41, 16, v41
v_mfma_f32_16x16x32_bf16 v[156:159], v[68:71], a[108:111], v[156:159]
buffer_load_dword v54, v55, s[32:35], s14 offen
v_mov_b32 v45, v44
v_mfma_f32_16x16x32_bf16 v[152:155], v[68:71], a[104:107], v[152:155]
s_add_u32 s14, s14, 10368
ds_read_b64_tr_b16 v[90:91], v3 offset:512
v_mfma_f32_16x16x32_bf16 v[148:151], v[68:71], a[100:103], v[148:151]
ds_write_b64 v48, v[44:45] offset:2048
v_mfma_f32_16x16x32_bf16 v[144:147], v[68:71], a[96:99], v[144:147]
s_add_u32 s89, s1, 25216
ds_read_b64_tr_b16 v[92:93], v3 offset:1024
v_lshl_or_b32 v44, v42, 16, v42
v_mfma_f32_16x16x32_bf16 v[160:163], v[72:75], a[96:99], v[160:163]
buffer_load_dwordx4 v33, s[28:31], s89 offen offset:3072 lds
v_mfma_f32_16x16x32_bf16 v[164:167], v[72:75], a[100:103], v[164:167]
s_waitcnt vmcnt(9)
ds_read_b64_tr_b16 v[94:95], v3 offset:1536
v_mov_b32 v45, v44
v_mfma_f32_16x16x32_bf16 v[168:171], v[72:75], a[104:107], v[168:171]
s_barrier
v_mfma_f32_16x16x32_bf16 v[172:175], v[72:75], a[108:111], v[172:175]
s_add_u32 m0, s84, 49152
s_add_u32 s81, s13, 3244032
ds_read_b64_tr_b16 v[64:65], v2 offset:8192
v_mfma_f32_16x16x32_bf16 v[188:191], v[76:79], a[108:111], v[188:191]
buffer_load_dwordx4 v1, s[40:43], s81 offen lds
v_mfma_f32_16x16x32_bf16 v[184:187], v[76:79], a[104:107], v[184:187]
ds_read_b64_tr_b16 v[66:67], v2 offset:8704
v_mfma_f32_16x16x32_bf16 v[180:183], v[76:79], a[100:103], v[180:183]
buffer_load_dwordx4 v1, s[44:47], s81 offen offset:1024 lds
v_mfma_f32_16x16x32_bf16 v[176:179], v[76:79], a[96:99], v[176:179]
s_waitcnt lgkmcnt(2)
ds_read_b64_tr_b16 v[68:69], v2 offset:9216
v_mfma_f32_16x16x32_bf16 v[192:195], v[80:83], a[32:35], v[192:195]
ds_read_b128 a[112:115], v35 offset:49152
v_mfma_f32_16x16x32_bf16 v[196:199], v[80:83], a[36:39], v[196:199]
s_add_u32 m0, s84, 57344
ds_read_b64_tr_b16 v[70:71], v2 offset:9728
v_mfma_f32_16x16x32_bf16 v[200:203], v[80:83], a[40:43], v[200:203]
ds_read_b128 a[116:119], v35 offset:51200
v_mfma_f32_16x16x32_bf16 v[204:207], v[80:83], a[44:47], v[204:207]
s_add_u32 s81, s13, 3538944
ds_read_b64_tr_b16 v[72:73], v3 offset:8192
v_mfma_f32_16x16x32_bf16 v[220:223], v[84:87], a[44:47], v[220:223]
ds_read_b128 a[120:123], v35 offset:53248
v_mfma_f32_16x16x32_bf16 v[216:219], v[84:87], a[40:43], v[216:219]
ds_read_b64_tr_b16 v[74:75], v3 offset:8704
v_mfma_f32_16x16x32_bf16 v[212:215], v[84:87], a[36:39], v[212:215]
ds_read_b128 a[124:127], v35 offset:55296
v_mfma_f32_16x16x32_bf16 v[208:211], v[84:87], a[32:35], v[208:211]
ds_read_b64_tr_b16 v[76:77], v3 offset:9216
v_mfma_f32_16x16x32_bf16 v[224:227], v[88:91], a[32:35], v[224:227]
buffer_load_dwordx4 v1, s[40:43], s81 offen lds
v_mfma_f32_16x16x32_bf16 v[228:231], v[88:91], a[36:39], v[228:231]
ds_read_b64_tr_b16 v[78:79], v3 offset:9728
v_mfma_f32_16x16x32_bf16 v[232:235], v[88:91], a[40:43], v[232:235]
buffer_load_dwordx4 v1, s[44:47], s81 offen offset:1024 lds
v_mfma_f32_16x16x32_bf16 v[236:239], v[88:91], a[44:47], v[236:239]
s_add_u32 m0, s90, 32768
s_add_u32 s89, s1, 768
ds_read_b64_tr_b16 v[80:81], v2 offset:16384
v_mfma_f32_16x16x32_bf16 v[252:255], v[92:95], a[44:47], v[252:255]
buffer_load_dwordx4 v32, s[28:31], s89 offen lds
v_mfma_f32_16x16x32_bf16 v[248:251], v[92:95], a[40:43], v[248:251]
s_add_u32 s89, s1, 8960
ds_read_b64_tr_b16 v[82:83], v2 offset:16896
v_mfma_f32_16x16x32_bf16 v[244:247], v[92:95], a[36:39], v[244:247]
buffer_load_dwordx4 v33, s[28:31], s89 offen offset:1024 lds
v_mfma_f32_16x16x32_bf16 v[240:243], v[92:95], a[32:35], v[240:243]
s_add_u32 s89, s1, 17152
ds_read_b64_tr_b16 v[84:85], v2 offset:17408
s_waitcnt lgkmcnt(3)
v_mfma_f32_16x16x32_bf16 v[128:131], v[64:67], a[112:115], v[128:131]
buffer_load_dwordx4 v32, s[28:31], s89 offen offset:2048 lds
ds_read_b128 a[128:131], v34
v_mfma_f32_16x16x32_bf16 v[132:135], v[64:67], a[116:119], v[132:135]
ds_read_b64_tr_b16 v[86:87], v2 offset:17920
v_mfma_f32_16x16x32_bf16 v[136:139], v[64:67], a[120:123], v[136:139]
ds_read_b128 a[132:135], v34 offset:2048
v_mfma_f32_16x16x32_bf16 v[140:143], v[64:67], a[124:127], v[140:143]
ds_read_b64_tr_b16 v[88:89], v3 offset:16384
v_mfma_f32_16x16x32_bf16 v[156:159], v[68:71], a[124:127], v[156:159]
ds_read_b128 a[136:139], v34 offset:4096
v_mfma_f32_16x16x32_bf16 v[152:155], v[68:71], a[120:123], v[152:155]
ds_read_b64_tr_b16 v[90:91], v3 offset:16896
v_mfma_f32_16x16x32_bf16 v[148:151], v[68:71], a[116:119], v[148:151]
ds_read_b128 a[140:143], v34 offset:6144
v_mfma_f32_16x16x32_bf16 v[144:147], v[68:71], a[112:115], v[144:147]
s_add_u32 s89, s1, 25344
ds_read_b64_tr_b16 v[92:93], v3 offset:17408
v_mfma_f32_16x16x32_bf16 v[160:163], v[72:75], a[112:115], v[160:163]
buffer_load_dwordx4 v33, s[28:31], s89 offen offset:3072 lds
v_mfma_f32_16x16x32_bf16 v[164:167], v[72:75], a[116:119], v[164:167]
s_waitcnt vmcnt(15) lgkmcnt(1)
ds_read_b64_tr_b16 v[94:95], v3 offset:17920
v_mfma_f32_16x16x32_bf16 v[168:171], v[72:75], a[120:123], v[168:171]
s_barrier
v_mfma_f32_16x16x32_bf16 v[172:175], v[72:75], a[124:127], v[172:175]
s_add_u32 m0, s84, 0
s_add_u32 s81, s12, 1179776
ds_read_b64_tr_b16 v[64:65], v2 offset:24576
v_mfma_f32_16x16x32_bf16 v[188:191], v[76:79], a[124:127], v[188:191]
buffer_load_dwordx4 v1, s[40:43], s81 offen lds
v_mfma_f32_16x16x32_bf16 v[184:187], v[76:79], a[120:123], v[184:187]
ds_read_b64_tr_b16 v[66:67], v2 offset:25088
v_mfma_f32_16x16x32_bf16 v[180:183], v[76:79], a[116:119], v[180:183]
buffer_load_dwordx4 v1, s[44:47], s81 offen offset:1024 lds
v_mfma_f32_16x16x32_bf16 v[176:179], v[76:79], a[112:115], v[176:179]
ds_read_b64_tr_b16 v[68:69], v2 offset:25600
v_mfma_f32_16x16x32_bf16 v[128:131], v[80:83], a[128:131], v[128:131]
ds_read_b128 a[144:147], v35
v_mfma_f32_16x16x32_bf16 v[132:135], v[80:83], a[132:135], v[132:135]
s_add_u32 m0, s84, 8192
ds_read_b64_tr_b16 v[70:71], v2 offset:26112
v_mfma_f32_16x16x32_bf16 v[136:139], v[80:83], a[136:139], v[136:139]
ds_read_b128 a[148:151], v35 offset:2048
v_mfma_f32_16x16x32_bf16 v[140:143], v[80:83], a[140:143], v[140:143]
s_add_u32 s81, s13, 3833856
ds_read_b64_tr_b16 v[72:73], v3 offset:24576
v_mfma_f32_16x16x32_bf16 v[156:159], v[84:87], a[140:143], v[156:159]
ds_read_b128 a[152:155], v35 offset:4096
v_mfma_f32_16x16x32_bf16 v[152:155], v[84:87], a[136:139], v[152:155]
ds_read_b64_tr_b16 v[74:75], v3 offset:25088
v_mfma_f32_16x16x32_bf16 v[148:151], v[84:87], a[132:135], v[148:151]
ds_read_b128 a[156:159], v35 offset:6144
v_mfma_f32_16x16x32_bf16 v[144:147], v[84:87], a[128:131], v[144:147]
ds_read_b64_tr_b16 v[76:77], v3 offset:25600
v_mfma_f32_16x16x32_bf16 v[160:163], v[88:91], a[128:131], v[160:163]
buffer_load_dwordx4 v1, s[40:43], s81 offen lds
v_mfma_f32_16x16x32_bf16 v[164:167], v[88:91], a[132:135], v[164:167]
s_waitcnt lgkmcnt(2)
ds_read_b64_tr_b16 v[78:79], v3 offset:26112
v_mfma_f32_16x16x32_bf16 v[168:171], v[88:91], a[136:139], v[168:171]
buffer_load_dwordx4 v1, s[44:47], s81 offen offset:1024 lds
v_mfma_f32_16x16x32_bf16 v[172:175], v[88:91], a[140:143], v[172:175]
s_add_u32 m0, s90, 49152
s_add_u32 s89, s1, 896
ds_read_b64_tr_b16 v[80:81], v2 offset:32768
v_mfma_f32_16x16x32_bf16 v[188:191], v[92:95], a[140:143], v[188:191]
buffer_load_dwordx4 v32, s[28:31], s89 offen lds
v_mfma_f32_16x16x32_bf16 v[184:187], v[92:95], a[136:139], v[184:187]
s_add_u32 s89, s1, 9088
ds_read_b64_tr_b16 v[82:83], v2 offset:33280
v_mfma_f32_16x16x32_bf16 v[180:183], v[92:95], a[132:135], v[180:183]
buffer_load_dwordx4 v33, s[28:31], s89 offen offset:1024 lds
v_mfma_f32_16x16x32_bf16 v[176:179], v[92:95], a[128:131], v[176:179]
s_add_u32 s89, s1, 17280
ds_read_b64_tr_b16 v[84:85], v2 offset:33792
v_mfma_f32_16x16x32_bf16 v[128:131], v[64:67], a[144:147], v[128:131]
buffer_load_dwordx4 v32, s[28:31], s89 offen offset:2048 lds
v_mfma_f32_16x16x32_bf16 v[132:135], v[64:67], a[148:151], v[132:135]
ds_read_b64_tr_b16 v[86:87], v2 offset:34304
v_mfma_f32_16x16x32_bf16 v[136:139], v[64:67], a[152:155], v[136:139]
s_waitcnt lgkmcnt(3)
ds_write_b64 v48, v[44:45] offset:4096
v_mfma_f32_16x16x32_bf16 v[140:143], v[64:67], a[156:159], v[140:143]
ds_read_b64_tr_b16 v[88:89], v3 offset:32768
v_mfma_f32_16x16x32_bf16 v[156:159], v[68:71], a[156:159], v[156:159]
buffer_load_dword v54, v55, s[32:35], s14 offen
v_mfma_f32_16x16x32_bf16 v[152:155], v[68:71], a[152:155], v[152:155]
s_add_u32 s14, s14, 10368
ds_read_b64_tr_b16 v[90:91], v3 offset:33280
v_mfma_f32_16x16x32_bf16 v[148:151], v[68:71], a[148:151], v[148:151]
s_waitcnt lgkmcnt(2)
v_mfma_f32_16x16x32_bf16 v[144:147], v[68:71], a[144:147], v[144:147]
s_add_u32 s89, s1, 25472
ds_read_b64_tr_b16 v[92:93], v3 offset:33792
v_mfma_f32_16x16x32_bf16 v[160:163], v[72:75], a[144:147], v[160:163]
buffer_load_dwordx4 v33, s[28:31], s89 offen offset:3072 lds
v_mfma_f32_16x16x32_bf16 v[164:167], v[72:75], a[148:151], v[164:167]
s_waitcnt vmcnt(15)
ds_read_b64_tr_b16 v[94:95], v3 offset:34304
v_mfma_f32_16x16x32_bf16 v[168:171], v[72:75], a[152:155], v[168:171]
s_barrier
v_mfma_f32_16x16x32_bf16 v[172:175], v[72:75], a[156:159], v[172:175]
s_add_u32 m0, s84, 16384
s_add_u32 s81, s13, 4128768
ds_read_b64_tr_b16 v[64:65], v2 offset:40960
v_mfma_f32_16x16x32_bf16 v[188:191], v[76:79], a[156:159], v[188:191]
buffer_load_dwordx4 v1, s[40:43], s81 offen lds
v_mfma_f32_16x16x32_bf16 v[184:187], v[76:79], a[152:155], v[184:187]
ds_read_b64_tr_b16 v[66:67], v2 offset:41472
v_mfma_f32_16x16x32_bf16 v[180:183], v[76:79], a[148:151], v[180:183]
buffer_load_dwordx4 v1, s[44:47], s81 offen offset:1024 lds
v_mfma_f32_16x16x32_bf16 v[176:179], v[76:79], a[144:147], v[176:179]
ds_read_b64_tr_b16 v[68:69], v2 offset:41984
v_mfma_f32_16x16x32_bf16 v[192:195], v[80:83], a[48:51], v[192:195]
ds_read_b128 a[160:163], v34 offset:16384
v_mfma_f32_16x16x32_bf16 v[196:199], v[80:83], a[52:55], v[196:199]
s_add_u32 m0, s84, 24576
ds_read_b64_tr_b16 v[70:71], v2 offset:42496
v_mfma_f32_16x16x32_bf16 v[200:203], v[80:83], a[56:59], v[200:203]
ds_read_b128 a[164:167], v34 offset:18432
v_mfma_f32_16x16x32_bf16 v[204:207], v[80:83], a[60:63], v[204:207]
s_add_u32 s81, s13, 4423680
ds_read_b64_tr_b16 v[72:73], v3 offset:40960
v_mfma_f32_16x16x32_bf16 v[220:223], v[84:87], a[60:63], v[220:223]
ds_read_b128 a[168:171], v34 offset:20480
v_mfma_f32_16x16x32_bf16 v[216:219], v[84:87], a[56:59], v[216:219]
ds_read_b64_tr_b16 v[74:75], v3 offset:41472
v_mfma_f32_16x16x32_bf16 v[212:215], v[84:87], a[52:55], v[212:215]
ds_read_b128 a[172:175], v34 offset:22528
v_mfma_f32_16x16x32_bf16 v[208:211], v[84:87], a[48:51], v[208:211]
s_waitcnt lgkmcnt(5)
ds_read_b64_tr_b16 v[76:77], v3 offset:41984
v_mfma_f32_16x16x32_bf16 v[224:227], v[88:91], a[48:51], v[224:227]
buffer_load_dwordx4 v1, s[40:43], s81 offen lds
v_mfma_f32_16x16x32_bf16 v[228:231], v[88:91], a[52:55], v[228:231]
ds_read_b64_tr_b16 v[78:79], v3 offset:42496
v_mfma_f32_16x16x32_bf16 v[232:235], v[88:91], a[56:59], v[232:235]
buffer_load_dwordx4 v1, s[44:47], s81 offen offset:1024 lds
v_mfma_f32_16x16x32_bf16 v[236:239], v[88:91], a[60:63], v[236:239]
s_add_u32 m0, s90, 0
s_add_u32 s89, s1, 1024
ds_read_b64_tr_b16 v[80:81], v2 offset:49152
v_mfma_f32_16x16x32_bf16 v[252:255], v[92:95], a[60:63], v[252:255]
buffer_load_dwordx4 v32, s[28:31], s89 offen lds
v_mfma_f32_16x16x32_bf16 v[248:251], v[92:95], a[56:59], v[248:251]
s_add_u32 s89, s1, 9216
ds_read_b64_tr_b16 v[82:83], v2 offset:49664
v_mfma_f32_16x16x32_bf16 v[244:247], v[92:95], a[52:55], v[244:247]
buffer_load_dwordx4 v33, s[28:31], s89 offen offset:1024 lds
v_mfma_f32_16x16x32_bf16 v[240:243], v[92:95], a[48:51], v[240:243]
s_add_u32 s89, s1, 17408
ds_read_b64_tr_b16 v[84:85], v2 offset:50176
v_mfma_f32_16x16x32_bf16 v[128:131], v[64:67], a[160:163], v[128:131]
buffer_load_dwordx4 v32, s[28:31], s89 offen offset:2048 lds
ds_read_b128 a[176:179], v35 offset:16384
s_waitcnt lgkmcnt(4)
v_mfma_f32_16x16x32_bf16 v[132:135], v[64:67], a[164:167], v[132:135]
ds_read_b64_tr_b16 v[86:87], v2 offset:50688
v_mfma_f32_16x16x32_bf16 v[136:139], v[64:67], a[168:171], v[136:139]
ds_read_b128 a[180:183], v35 offset:18432
v_mfma_f32_16x16x32_bf16 v[140:143], v[64:67], a[172:175], v[140:143]
ds_read_b64_tr_b16 v[88:89], v3 offset:49152
v_mfma_f32_16x16x32_bf16 v[156:159], v[68:71], a[172:175], v[156:159]
ds_read_b128 a[184:187], v35 offset:20480
v_mfma_f32_16x16x32_bf16 v[152:155], v[68:71], a[168:171], v[152:155]
ds_read_b64_tr_b16 v[90:91], v3 offset:49664
v_mfma_f32_16x16x32_bf16 v[148:151], v[68:71], a[164:167], v[148:151]
ds_read_b128 a[188:191], v35 offset:22528
v_mfma_f32_16x16x32_bf16 v[144:147], v[68:71], a[160:163], v[144:147]
s_add_u32 s89, s1, 25600
ds_read_b64_tr_b16 v[92:93], v3 offset:50176
v_mfma_f32_16x16x32_bf16 v[160:163], v[72:75], a[160:163], v[160:163]
buffer_load_dwordx4 v33, s[28:31], s89 offen offset:3072 lds
v_mfma_f32_16x16x32_bf16 v[164:167], v[72:75], a[164:167], v[164:167]
s_waitcnt vmcnt(15) lgkmcnt(1)
ds_read_b64_tr_b16 v[94:95], v3 offset:50688
v_mfma_f32_16x16x32_bf16 v[168:171], v[72:75], a[168:171], v[168:171]
s_barrier
v_mfma_f32_16x16x32_bf16 v[172:175], v[72:75], a[172:175], v[172:175]
s_add_u32 m0, s84, 32768
s_add_u32 s81, s12, 1474688
ds_read_b64_tr_b16 v[64:65], v2 offset:57344
v_mfma_f32_16x16x32_bf16 v[188:191], v[76:79], a[172:175], v[188:191]
buffer_load_dwordx4 v1, s[40:43], s81 offen lds
v_mfma_f32_16x16x32_bf16 v[184:187], v[76:79], a[168:171], v[184:187]
ds_read_b64_tr_b16 v[66:67], v2 offset:57856
v_mfma_f32_16x16x32_bf16 v[180:183], v[76:79], a[164:167], v[180:183]
buffer_load_dwordx4 v1, s[44:47], s81 offen offset:1024 lds
v_mfma_f32_16x16x32_bf16 v[176:179], v[76:79], a[160:163], v[176:179]
ds_read_b64_tr_b16 v[68:69], v2 offset:58368
v_mfma_f32_16x16x32_bf16 v[128:131], v[80:83], a[176:179], v[128:131]
ds_read_b128 a[192:195], v34 offset:32768
v_mfma_f32_16x16x32_bf16 v[132:135], v[80:83], a[180:183], v[132:135]
s_add_u32 m0, s84, 40960
ds_read_b64_tr_b16 v[70:71], v2 offset:58880
v_mfma_f32_16x16x32_bf16 v[136:139], v[80:83], a[184:187], v[136:139]
ds_read_b128 a[196:199], v34 offset:34816
v_mfma_f32_16x16x32_bf16 v[140:143], v[80:83], a[188:191], v[140:143]
s_add_u32 s81, s13, 4718592
ds_read_b64_tr_b16 v[72:73], v3 offset:57344
v_mfma_f32_16x16x32_bf16 v[156:159], v[84:87], a[188:191], v[156:159]
ds_read_b128 a[200:203], v34 offset:36864
v_mfma_f32_16x16x32_bf16 v[152:155], v[84:87], a[184:187], v[152:155]
ds_read_b64_tr_b16 v[74:75], v3 offset:57856
v_mfma_f32_16x16x32_bf16 v[148:151], v[84:87], a[180:183], v[148:151]
ds_read_b128 a[204:207], v34 offset:38912
v_mfma_f32_16x16x32_bf16 v[144:147], v[84:87], a[176:179], v[144:147]
ds_read_b64_tr_b16 v[76:77], v3 offset:58368
v_mfma_f32_16x16x32_bf16 v[160:163], v[88:91], a[176:179], v[160:163]
buffer_load_dwordx4 v1, s[40:43], s81 offen lds
v_mfma_f32_16x16x32_bf16 v[164:167], v[88:91], a[180:183], v[164:167]
ds_read_b64_tr_b16 v[78:79], v3 offset:58880
v_mfma_f32_16x16x32_bf16 v[168:171], v[88:91], a[184:187], v[168:171]
buffer_load_dwordx4 v1, s[44:47], s81 offen offset:1024 lds
v_mfma_f32_16x16x32_bf16 v[172:175], v[88:91], a[188:191], v[172:175]
s_waitcnt lgkmcnt(3)
ds_read_b64_tr_b16 v[80:81], v2
v_mfma_f32_16x16x32_bf16 v[188:191], v[92:95], a[188:191], v[188:191]
buffer_load_dword v54, v55, s[32:35], s14 offen
v_mfma_f32_16x16x32_bf16 v[184:187], v[92:95], a[184:187], v[184:187]
ds_read_b64_tr_b16 v[82:83], v2 offset:512
v_mfma_f32_16x16x32_bf16 v[180:183], v[92:95], a[180:183], v[180:183]
v_mfma_f32_16x16x32_bf16 v[176:179], v[92:95], a[176:179], v[176:179]
ds_read_b64_tr_b16 v[84:85], v2 offset:1024
v_mfma_f32_16x16x32_bf16 v[128:131], v[64:67], a[192:195], v[128:131]
v_mfma_f32_16x16x32_bf16 v[132:135], v[64:67], a[196:199], v[132:135]
ds_read_b64_tr_b16 v[86:87], v2 offset:1536
v_mfma_f32_16x16x32_bf16 v[136:139], v[64:67], a[200:203], v[136:139]
s_waitcnt lgkmcnt(3)
v_mfma_f32_16x16x32_bf16 v[140:143], v[64:67], a[204:207], v[140:143]
ds_read_b64_tr_b16 v[88:89], v3
v_mfma_f32_16x16x32_bf16 v[156:159], v[68:71], a[204:207], v[156:159]
v_mfma_f32_16x16x32_bf16 v[152:155], v[68:71], a[200:203], v[152:155]
ds_read_b64_tr_b16 v[90:91], v3 offset:512
v_mfma_f32_16x16x32_bf16 v[148:151], v[68:71], a[196:199], v[148:151]
v_mfma_f32_16x16x32_bf16 v[144:147], v[68:71], a[192:195], v[144:147]
s_add_u32 m0, s84, 49152
ds_read_b64_tr_b16 v[92:93], v3 offset:1024
v_mfma_f32_16x16x32_bf16 v[160:163], v[72:75], a[192:195], v[160:163]
v_mfma_f32_16x16x32_bf16 v[164:167], v[72:75], a[196:199], v[164:167]
s_waitcnt vmcnt(11)
ds_read_b64_tr_b16 v[94:95], v3 offset:1536
v_mfma_f32_16x16x32_bf16 v[168:171], v[72:75], a[200:203], v[168:171]
s_barrier
v_mfma_f32_16x16x32_bf16 v[172:175], v[72:75], a[204:207], v[172:175]
s_add_u32 s81, s13, 5013504
ds_read_b64_tr_b16 v[64:65], v2 offset:8192
v_mfma_f32_16x16x32_bf16 v[188:191], v[76:79], a[204:207], v[188:191]
buffer_load_dwordx4 v1, s[40:43], s81 offen lds
v_mfma_f32_16x16x32_bf16 v[184:187], v[76:79], a[200:203], v[184:187]
ds_read_b64_tr_b16 v[66:67], v2 offset:8704
v_mfma_f32_16x16x32_bf16 v[180:183], v[76:79], a[196:199], v[180:183]
buffer_load_dwordx4 v1, s[44:47], s81 offen offset:1024 lds
v_mfma_f32_16x16x32_bf16 v[176:179], v[76:79], a[192:195], v[176:179]
s_waitcnt lgkmcnt(2)
ds_read_b64_tr_b16 v[68:69], v2 offset:9216
v_mfma_f32_16x16x32_bf16 v[192:195], v[80:83], a[64:67], v[192:195]
ds_read_b128 a[208:211], v35 offset:32768
v_mfma_f32_16x16x32_bf16 v[196:199], v[80:83], a[68:71], v[196:199]
s_add_u32 m0, s84, 57344
ds_read_b64_tr_b16 v[70:71], v2 offset:9728
v_mfma_f32_16x16x32_bf16 v[200:203], v[80:83], a[72:75], v[200:203]
ds_read_b128 a[212:215], v35 offset:34816
v_mfma_f32_16x16x32_bf16 v[204:207], v[80:83], a[76:79], v[204:207]
s_add_u32 s81, s12, 1769600
ds_read_b64_tr_b16 v[72:73], v3 offset:8192
v_mfma_f32_16x16x32_bf16 v[220:223], v[84:87], a[76:79], v[220:223]
ds_read_b128 a[216:219], v35 offset:36864
v_mfma_f32_16x16x32_bf16 v[216:219], v[84:87], a[72:75], v[216:219]
ds_read_b64_tr_b16 v[74:75], v3 offset:8704
v_mfma_f32_16x16x32_bf16 v[212:215], v[84:87], a[68:71], v[212:215]
ds_read_b128 a[220:223], v35 offset:38912
v_mfma_f32_16x16x32_bf16 v[208:211], v[84:87], a[64:67], v[208:211]
ds_read_b64_tr_b16 v[76:77], v3 offset:9216
v_mfma_f32_16x16x32_bf16 v[224:227], v[88:91], a[64:67], v[224:227]
buffer_load_dwordx4 v1, s[40:43], s81 offen lds
v_mfma_f32_16x16x32_bf16 v[228:231], v[88:91], a[68:71], v[228:231]
ds_read_b64_tr_b16 v[78:79], v3 offset:9728
v_mfma_f32_16x16x32_bf16 v[232:235], v[88:91], a[72:75], v[232:235]
buffer_load_dwordx4 v1, s[44:47], s81 offen offset:1024 lds
v_mfma_f32_16x16x32_bf16 v[236:239], v[88:91], a[76:79], v[236:239]
ds_read_b64_tr_b16 v[80:81], v2 offset:16384
v_mfma_f32_16x16x32_bf16 v[252:255], v[92:95], a[76:79], v[252:255]
v_mfma_f32_16x16x32_bf16 v[248:251], v[92:95], a[72:75], v[248:251]
ds_read_b64_tr_b16 v[82:83], v2 offset:16896
v_mfma_f32_16x16x32_bf16 v[244:247], v[92:95], a[68:71], v[244:247]
v_mfma_f32_16x16x32_bf16 v[240:243], v[92:95], a[64:67], v[240:243]
s_waitcnt lgkmcnt(2)
ds_read_b64_tr_b16 v[84:85], v2 offset:17408
v_mfma_f32_16x16x32_bf16 v[128:131], v[64:67], a[208:211], v[128:131]
ds_read_b128 a[224:227], v34 offset:49152
v_mfma_f32_16x16x32_bf16 v[132:135], v[64:67], a[212:215], v[132:135]
ds_read_b64_tr_b16 v[86:87], v2 offset:17920
v_mfma_f32_16x16x32_bf16 v[136:139], v[64:67], a[216:219], v[136:139]
ds_read_b128 a[228:231], v34 offset:51200
v_mfma_f32_16x16x32_bf16 v[140:143], v[64:67], a[220:223], v[140:143]
ds_read_b64_tr_b16 v[88:89], v3 offset:16384
v_mfma_f32_16x16x32_bf16 v[156:159], v[68:71], a[220:223], v[156:159]
ds_read_b128 a[232:235], v34 offset:53248
v_mfma_f32_16x16x32_bf16 v[152:155], v[68:71], a[216:219], v[152:155]
ds_read_b64_tr_b16 v[90:91], v3 offset:16896
v_mfma_f32_16x16x32_bf16 v[148:151], v[68:71], a[212:215], v[148:151]
ds_read_b128 a[236:239], v34 offset:55296
v_mfma_f32_16x16x32_bf16 v[144:147], v[68:71], a[208:211], v[144:147]
s_add_u32 m0, s84, 0
ds_read_b64_tr_b16 v[92:93], v3 offset:17408
v_mfma_f32_16x16x32_bf16 v[160:163], v[72:75], a[208:211], v[160:163]
v_mfma_f32_16x16x32_bf16 v[164:167], v[72:75], a[212:215], v[164:167]
s_waitcnt vmcnt(7) lgkmcnt(1)
ds_read_b64_tr_b16 v[94:95], v3 offset:17920
v_mfma_f32_16x16x32_bf16 v[168:171], v[72:75], a[216:219], v[168:171]
s_barrier
v_mfma_f32_16x16x32_bf16 v[172:175], v[72:75], a[220:223], v[172:175]
s_add_u32 s81, s12, 2064512
ds_read_b64_tr_b16 v[64:65], v2 offset:24576
v_mfma_f32_16x16x32_bf16 v[188:191], v[76:79], a[220:223], v[188:191]
buffer_load_dwordx4 v1, s[40:43], s81 offen lds
v_mfma_f32_16x16x32_bf16 v[184:187], v[76:79], a[216:219], v[184:187]
ds_read_b64_tr_b16 v[66:67], v2 offset:25088
v_mfma_f32_16x16x32_bf16 v[180:183], v[76:79], a[212:215], v[180:183]
buffer_load_dwordx4 v1, s[44:47], s81 offen offset:1024 lds
v_mfma_f32_16x16x32_bf16 v[176:179], v[76:79], a[208:211], v[176:179]
ds_read_b64_tr_b16 v[68:69], v2 offset:25600
v_mfma_f32_16x16x32_bf16 v[128:131], v[80:83], a[224:227], v[128:131]
ds_read_b128 a[240:243], v35 offset:49152
v_mfma_f32_16x16x32_bf16 v[132:135], v[80:83], a[228:231], v[132:135]
s_add_u32 m0, s84, 8192
ds_read_b64_tr_b16 v[70:71], v2 offset:26112
v_mfma_f32_16x16x32_bf16 v[136:139], v[80:83], a[232:235], v[136:139]
ds_read_b128 a[244:247], v35 offset:51200
v_mfma_f32_16x16x32_bf16 v[140:143], v[80:83], a[236:239], v[140:143]
s_add_u32 s81, s12, 2359424
ds_read_b64_tr_b16 v[72:73], v3 offset:24576
v_mfma_f32_16x16x32_bf16 v[156:159], v[84:87], a[236:239], v[156:159]
ds_read_b128 a[248:251], v35 offset:53248
v_mfma_f32_16x16x32_bf16 v[152:155], v[84:87], a[232:235], v[152:155]
ds_read_b64_tr_b16 v[74:75], v3 offset:25088
v_mfma_f32_16x16x32_bf16 v[148:151], v[84:87], a[228:231], v[148:151]
ds_read_b128 a[252:255], v35 offset:55296
v_mfma_f32_16x16x32_bf16 v[144:147], v[84:87], a[224:227], v[144:147]
ds_read_b64_tr_b16 v[76:77], v3 offset:25600
v_mfma_f32_16x16x32_bf16 v[160:163], v[88:91], a[224:227], v[160:163]
buffer_load_dwordx4 v1, s[40:43], s81 offen lds
v_mfma_f32_16x16x32_bf16 v[164:167], v[88:91], a[228:231], v[164:167]
ds_read_b64_tr_b16 v[78:79], v3 offset:26112
v_mfma_f32_16x16x32_bf16 v[168:171], v[88:91], a[232:235], v[168:171]
buffer_load_dwordx4 v1, s[44:47], s81 offen offset:1024 lds
v_mfma_f32_16x16x32_bf16 v[172:175], v[88:91], a[236:239], v[172:175]
s_waitcnt lgkmcnt(3)
ds_read_b64_tr_b16 v[80:81], v2 offset:32768
v_mfma_f32_16x16x32_bf16 v[188:191], v[92:95], a[236:239], v[188:191]
v_mfma_f32_16x16x32_bf16 v[184:187], v[92:95], a[232:235], v[184:187]
ds_read_b64_tr_b16 v[82:83], v2 offset:33280
v_mfma_f32_16x16x32_bf16 v[180:183], v[92:95], a[228:231], v[180:183]
v_mfma_f32_16x16x32_bf16 v[176:179], v[92:95], a[224:227], v[176:179]
ds_read_b64_tr_b16 v[84:85], v2 offset:33792
v_mfma_f32_16x16x32_bf16 v[128:131], v[64:67], a[240:243], v[128:131]
v_mfma_f32_16x16x32_bf16 v[132:135], v[64:67], a[244:247], v[132:135]
ds_read_b64_tr_b16 v[86:87], v2 offset:34304
v_mfma_f32_16x16x32_bf16 v[136:139], v[64:67], a[248:251], v[136:139]
s_waitcnt lgkmcnt(3)
v_mfma_f32_16x16x32_bf16 v[140:143], v[64:67], a[252:255], v[140:143]
ds_read_b64_tr_b16 v[88:89], v3 offset:32768
v_mfma_f32_16x16x32_bf16 v[156:159], v[68:71], a[252:255], v[156:159]
v_mfma_f32_16x16x32_bf16 v[152:155], v[68:71], a[248:251], v[152:155]
ds_read_b64_tr_b16 v[90:91], v3 offset:33280
v_mfma_f32_16x16x32_bf16 v[148:151], v[68:71], a[244:247], v[148:151]
v_mfma_f32_16x16x32_bf16 v[144:147], v[68:71], a[240:243], v[144:147]
s_add_u32 m0, s84, 16384
ds_read_b64_tr_b16 v[92:93], v3 offset:33792
v_mfma_f32_16x16x32_bf16 v[160:163], v[72:75], a[240:243], v[160:163]
v_mfma_f32_16x16x32_bf16 v[164:167], v[72:75], a[244:247], v[164:167]
s_waitcnt vmcnt(6)
ds_read_b64_tr_b16 v[94:95], v3 offset:34304
v_mfma_f32_16x16x32_bf16 v[168:171], v[72:75], a[248:251], v[168:171]
s_barrier
v_mfma_f32_16x16x32_bf16 v[172:175], v[72:75], a[252:255], v[172:175]
s_add_u32 s81, s12, 2654336
ds_read_b64_tr_b16 v[64:65], v2 offset:40960
v_mfma_f32_16x16x32_bf16 v[188:191], v[76:79], a[252:255], v[188:191]
buffer_load_dwordx4 v1, s[40:43], s81 offen lds
v_mfma_f32_16x16x32_bf16 v[184:187], v[76:79], a[248:251], v[184:187]
ds_read_b64_tr_b16 v[66:67], v2 offset:41472
v_mfma_f32_16x16x32_bf16 v[180:183], v[76:79], a[244:247], v[180:183]
buffer_load_dwordx4 v1, s[44:47], s81 offen offset:1024 lds
v_mfma_f32_16x16x32_bf16 v[176:179], v[76:79], a[240:243], v[176:179]
s_waitcnt lgkmcnt(2)
ds_read_b64_tr_b16 v[68:69], v2 offset:41984
v_mfma_f32_16x16x32_bf16 v[192:195], v[80:83], a[80:83], v[192:195]
ds_read_b128 v[96:99], v34
v_mfma_f32_16x16x32_bf16 v[196:199], v[80:83], a[84:87], v[196:199]
s_add_u32 m0, s84, 24576
ds_read_b64_tr_b16 v[70:71], v2 offset:42496
v_mfma_f32_16x16x32_bf16 v[200:203], v[80:83], a[88:91], v[200:203]
ds_read_b128 v[100:103], v34 offset:2048
v_mfma_f32_16x16x32_bf16 v[204:207], v[80:83], a[92:95], v[204:207]
s_add_u32 s81, s13, 2949248
ds_read_b64_tr_b16 v[72:73], v3 offset:40960
v_mfma_f32_16x16x32_bf16 v[220:223], v[84:87], a[92:95], v[220:223]
ds_read_b128 v[104:107], v34 offset:4096
v_mfma_f32_16x16x32_bf16 v[216:219], v[84:87], a[88:91], v[216:219]
ds_read_b64_tr_b16 v[74:75], v3 offset:41472
v_mfma_f32_16x16x32_bf16 v[212:215], v[84:87], a[84:87], v[212:215]
ds_read_b128 v[108:111], v34 offset:6144
v_mfma_f32_16x16x32_bf16 v[208:211], v[84:87], a[80:83], v[208:211]
ds_read_b64_tr_b16 v[76:77], v3 offset:41984
v_mfma_f32_16x16x32_bf16 v[224:227], v[88:91], a[80:83], v[224:227]
buffer_load_dwordx4 v1, s[40:43], s81 offen lds
v_mfma_f32_16x16x32_bf16 v[228:231], v[88:91], a[84:87], v[228:231]
ds_read_b64_tr_b16 v[78:79], v3 offset:42496
v_mfma_f32_16x16x32_bf16 v[232:235], v[88:91], a[88:91], v[232:235]
buffer_load_dwordx4 v1, s[44:47], s81 offen offset:1024 lds
v_mfma_f32_16x16x32_bf16 v[236:239], v[88:91], a[92:95], v[236:239]
ds_read_b64_tr_b16 v[80:81], v2 offset:49152
v_mfma_f32_16x16x32_bf16 v[252:255], v[92:95], a[92:95], v[252:255]
v_mfma_f32_16x16x32_bf16 v[248:251], v[92:95], a[88:91], v[248:251]
ds_read_b64_tr_b16 v[82:83], v2 offset:49664
v_mfma_f32_16x16x32_bf16 v[244:247], v[92:95], a[84:87], v[244:247]
v_mfma_f32_16x16x32_bf16 v[240:243], v[92:95], a[80:83], v[240:243]
s_waitcnt lgkmcnt(2)
ds_read_b64_tr_b16 v[84:85], v2 offset:50176
v_mfma_f32_16x16x32_bf16 v[128:131], v[64:67], v[96:99], v[128:131]
ds_read_b128 v[112:115], v35
v_mfma_f32_16x16x32_bf16 v[132:135], v[64:67], v[100:103], v[132:135]
ds_read_b64_tr_b16 v[86:87], v2 offset:50688
v_mfma_f32_16x16x32_bf16 v[136:139], v[64:67], v[104:107], v[136:139]
ds_read_b128 v[116:119], v35 offset:2048
v_mfma_f32_16x16x32_bf16 v[140:143], v[64:67], v[108:111], v[140:143]
ds_read_b64_tr_b16 v[88:89], v3 offset:49152
v_mfma_f32_16x16x32_bf16 v[156:159], v[68:71], v[108:111], v[156:159]
ds_read_b128 v[120:123], v35 offset:4096
v_mfma_f32_16x16x32_bf16 v[152:155], v[68:71], v[104:107], v[152:155]
ds_read_b64_tr_b16 v[90:91], v3 offset:49664
v_mfma_f32_16x16x32_bf16 v[148:151], v[68:71], v[100:103], v[148:151]
ds_read_b128 v[124:127], v35 offset:6144
v_mfma_f32_16x16x32_bf16 v[144:147], v[68:71], v[96:99], v[144:147]
s_add_u32 m0, s84, 32768
ds_read_b64_tr_b16 v[92:93], v3 offset:50176
v_mfma_f32_16x16x32_bf16 v[160:163], v[72:75], v[96:99], v[160:163]
v_mfma_f32_16x16x32_bf16 v[164:167], v[72:75], v[100:103], v[164:167]
s_waitcnt vmcnt(6) lgkmcnt(1)
ds_read_b64_tr_b16 v[94:95], v3 offset:50688
v_mfma_f32_16x16x32_bf16 v[168:171], v[72:75], v[104:107], v[168:171]
s_barrier
v_mfma_f32_16x16x32_bf16 v[172:175], v[72:75], v[108:111], v[172:175]
s_add_u32 s81, s13, 3244160
ds_read_b64_tr_b16 v[64:65], v2 offset:57344
v_min_u32 v53, 8, v0
v_mfma_f32_16x16x32_bf16 v[188:191], v[76:79], v[108:111], v[188:191]
buffer_load_dwordx4 v1, s[40:43], s81 offen lds
v_mfma_f32_16x16x32_bf16 v[184:187], v[76:79], v[104:107], v[184:187]
s_mul_i32 s85, s101, 36
ds_read_b64_tr_b16 v[66:67], v2 offset:57856
v_mfma_f32_16x16x32_bf16 v[180:183], v[76:79], v[100:103], v[180:183]
buffer_load_dwordx4 v1, s[44:47], s81 offen offset:1024 lds
v_mfma_f32_16x16x32_bf16 v[176:179], v[76:79], v[96:99], v[176:179]
s_mul_i32 s86, s78, 9
ds_read_b64_tr_b16 v[68:69], v2 offset:58368
v_mfma_f32_16x16x32_bf16 v[128:131], v[80:83], v[112:115], v[128:131]
s_add_u32 s85, s85, s86
v_add_u32 v53, s85, v53
v_mul_u32_u24 v53, 9216, v53
v_mfma_f32_16x16x32_bf16 v[132:135], v[80:83], v[116:119], v[132:135]
s_add_u32 m0, s84, 40960
ds_read_b64_tr_b16 v[70:71], v2 offset:58880
v_and_b32 v7, 15, v0
v_mfma_f32_16x16x32_bf16 v[136:139], v[80:83], v[120:123], v[136:139]
s_add_u32 s85, s82, 256
buffer_load_dword v54, v53, s[40:43], s85 offen
v_lshlrev_b32 v7, 1, v7
v_mfma_f32_16x16x32_bf16 v[140:143], v[80:83], v[124:127], v[140:143]
s_add_u32 s81, s13, 3539072
ds_read_b64_tr_b16 v[72:73], v3 offset:57344
v_lshrrev_b32 v5, 4, v0
v_mfma_f32_16x16x32_bf16 v[156:159], v[84:87], v[124:127], v[156:159]
s_add_u32 s72, s8, 0
s_addc_u32 s73, s9, 0
buffer_load_dword v54, v53, s[44:47], s85 offen offset:1024
v_cmp_eq_u32 vcc, 0, v5
v_mfma_f32_16x16x32_bf16 v[152:155], v[84:87], v[120:123], v[152:155]
s_mov_b32 s74, 20736
ds_read_b64_tr_b16 v[74:75], v3 offset:57856
v_mul_u32_u24 v5, 144, v5
v_mfma_f32_16x16x32_bf16 v[148:151], v[84:87], v[116:119], v[148:151]
s_mov_b32 s75, 0x20000
v_mfma_f32_16x16x32_bf16 v[144:147], v[84:87], v[112:115], v[144:147]
s_lshl_b32 s85, s76, 1
ds_read_b64_tr_b16 v[76:77], v3 offset:58368
v_mfma_f32_16x16x32_bf16 v[160:163], v[88:91], v[112:115], v[160:163]
buffer_load_dwordx4 v1, s[40:43], s81 offen lds
v_mfma_f32_16x16x32_bf16 v[164:167], v[88:91], v[116:119], v[164:167]
s_add_u32 s85, s85, s80
ds_read_b64_tr_b16 v[78:79], v3 offset:58880
v_mfma_f32_16x16x32_bf16 v[168:171], v[88:91], v[120:123], v[168:171]
buffer_load_dwordx4 v1, s[44:47], s81 offen offset:1024 lds
v_mfma_f32_16x16x32_bf16 v[172:175], v[88:91], v[124:127], v[172:175]
s_mul_i32 s85, s85, 648
ds_read_b64_tr_b16 v[80:81], v2
s_waitcnt lgkmcnt(3)
v_mfma_f32_16x16x32_bf16 v[188:191], v[92:95], v[124:127], v[188:191]
s_mul_i32 s86, s80, 72
v_mfma_f32_16x16x32_bf16 v[184:187], v[92:95], v[120:123], v[184:187]
s_sub_u32 s85, s85, s86
ds_read_b64_tr_b16 v[82:83], v2 offset:512
v_add_u32 v7, s85, v7
v_mfma_f32_16x16x32_bf16 v[180:183], v[92:95], v[116:119], v[180:183]
s_mov_b32 s91, 2146435072
v_add_u32 v5, v5, v7
v_mov_b32 v6, s91
v_mfma_f32_16x16x32_bf16 v[176:179], v[92:95], v[112:115], v[176:179]
s_cmp_eq_u32 s80, 1
s_cselect_b64 s[94:95], vcc, 0
ds_read_b64_tr_b16 v[84:85], v2 offset:1024
v_add_u32 v7, 576, v7
v_mfma_f32_16x16x32_bf16 v[192:195], v[64:67], a[96:99], v[192:195]
s_cmp_eq_u32 s80, 0
s_cselect_b32 s86, s91, 0
v_cndmask_b32 v6, v6, v7, vcc
v_mov_b32 v7, s91
v_mfma_f32_16x16x32_bf16 v[196:199], v[64:67], a[100:103], v[196:199]
ds_read_b64_tr_b16 v[86:87], v2 offset:1536
v_cndmask_b32 v7, v5, v7, s[94:95]
v_mfma_f32_16x16x32_bf16 v[200:203], v[64:67], a[104:107], v[200:203]
buffer_load_ushort v32, v7, s[72:75], 0 offen
v_mfma_f32_16x16x32_bf16 v[204:207], v[64:67], a[108:111], v[204:207]
ds_read_b64_tr_b16 v[88:89], v3
v_mfma_f32_16x16x32_bf16 v[220:223], v[68:71], a[108:111], v[220:223]
buffer_load_ushort v33, v7, s[72:75], 0 offen offset:36
v_and_b32 v7, 15, v0
v_mul_f32 v16, s87, v128
v_mfma_f32_16x16x32_bf16 v[216:219], v[68:71], a[104:107], v[216:219]
ds_read_b64_tr_b16 v[90:91], v3 offset:512
v_mul_f32 v17, s87, v129
v_mul_f32 v18, s87, v130
v_mfma_f32_16x16x32_bf16 v[212:215], v[68:71], a[100:103], v[212:215]
buffer_load_ushort v34, v5, s[72:75], 0 offen offset:72
v_mul_f32 v19, s87, v131
v_mfma_f32_16x16x32_bf16 v[208:211], v[68:71], a[96:99], v[208:211]
s_add_u32 m0, s84, 49152
ds_read_b64_tr_b16 v[92:93], v3 offset:1024
v_mul_f32 v128, v128, v144
v_exp_f32 v16, v16
v_mfma_f32_16x16x32_bf16 v[224:227], v[72:75], a[96:99], v[224:227]
buffer_load_ushort v35, v5, s[72:75], 0 offen offset:108
v_max_u32 v5, s86, v6
v_mfma_f32_16x16x32_bf16 v[228:231], v[72:75], a[100:103], v[228:231]
s_waitcnt vmcnt(12)
ds_read_b64_tr_b16 v[94:95], v3 offset:1536
v_mul_f32 v129, v129, v145
v_mfma_f32_16x16x32_bf16 v[232:235], v[72:75], a[104:107], v[232:235]
s_barrier
v_mfma_f32_16x16x32_bf16 v[236:239], v[72:75], a[108:111], v[236:239]
s_add_u32 s81, s13, 3833984
ds_read_b64_tr_b16 v[64:65], v2 offset:8192
v_mul_f32 v130, v130, v146
v_exp_f32 v17, v17
s_waitcnt lgkmcnt(3)
v_mfma_f32_16x16x32_bf16 v[252:255], v[76:79], a[108:111], v[252:255]
buffer_load_dwordx4 v1, s[40:43], s81 offen lds
v_mfma_f32_16x16x32_bf16 v[248:251], v[76:79], a[104:107], v[248:251]
ds_read_b64_tr_b16 v[66:67], v2 offset:8704
v_mul_f32 v131, v131, v147
v_mfma_f32_16x16x32_bf16 v[244:247], v[76:79], a[100:103], v[244:247]
buffer_load_dwordx4 v1, s[44:47], s81 offen offset:1024 lds
v_mfma_f32_16x16x32_bf16 v[240:243], v[76:79], a[96:99], v[240:243]
ds_read_b64_tr_b16 v[68:69], v2 offset:9216
v_add_f32 v16, 1.0, v16
v_exp_f32 v18, v18
v_mfma_f32_16x16x32_bf16 v[192:195], v[80:83], a[112:115], v[192:195]
buffer_load_ushort v36, v6, s[72:75], 0 offen
v_add_f32 v17, 1.0, v17
v_mfma_f32_16x16x32_bf16 v[196:199], v[80:83], a[116:119], v[196:199]
s_add_u32 m0, s84, 57344
ds_read_b64_tr_b16 v[70:71], v2 offset:9728
v_add_f32 v18, 1.0, v18
v_mfma_f32_16x16x32_bf16 v[200:203], v[80:83], a[120:123], v[200:203]
buffer_load_ushort v37, v6, s[72:75], 0 offen offset:36
v_mul_f32 v20, s87, v160
v_exp_f32 v19, v19
v_mfma_f32_16x16x32_bf16 v[204:207], v[80:83], a[124:127], v[204:207]
s_add_u32 s81, s13, 4128896
ds_read_b64_tr_b16 v[72:73], v3 offset:8192
v_add_f32 v19, 1.0, v19
v_mfma_f32_16x16x32_bf16 v[220:223], v[84:87], a[124:127], v[220:223]
buffer_load_ushort v38, v5, s[72:75], 0 offen offset:72
v_mov_b32 v6, s91
v_mfma_f32_16x16x32_bf16 v[216:219], v[84:87], a[120:123], v[216:219]
ds_read_b64_tr_b16 v[74:75], v3 offset:8704
v_mul_f32 v21, s87, v161
v_mfma_f32_16x16x32_bf16 v[212:215], v[84:87], a[116:119], v[212:215]
buffer_load_ushort v39, v5, s[72:75], 0 offen offset:108
v_and_b32 v5, 11, v7
v_rcp_f32 v16, v16
v_mfma_f32_16x16x32_bf16 v[208:211], v[84:87], a[112:115], v[208:211]
ds_read_b64_tr_b16 v[76:77], v3 offset:9216
v_cmp_eq_u32 vcc, 0, v5
v_mfma_f32_16x16x32_bf16 v[224:227], v[88:91], a[112:115], v[224:227]
buffer_load_dwordx4 v1, s[40:43], s81 offen lds
v_mfma_f32_16x16x32_bf16 v[228:231], v[88:91], a[116:119], v[228:231]
ds_read_b64_tr_b16 v[78:79], v3 offset:9728
v_lshrrev_b32 v7, 2, v7
v_mfma_f32_16x16x32_bf16 v[232:235], v[88:91], a[120:123], v[232:235]
buffer_load_dwordx4 v1, s[44:47], s81 offen offset:1024 lds
v_rcp_f32 v17, v17
v_mfma_f32_16x16x32_bf16 v[236:239], v[88:91], a[124:127], v[236:239]
s_waitcnt lgkmcnt(2)
ds_read_b64_tr_b16 v[80:81], v2 offset:16384
v_add_u32 v7, 16, v7
v_mfma_f32_16x16x32_bf16 v[252:255], v[92:95], a[124:127], v[252:255]
v_mov_b32 v5, s91
v_lshlrev_b32 v7, 1, v7
v_mfma_f32_16x16x32_bf16 v[248:251], v[92:95], a[120:123], v[248:251]
ds_read_b64_tr_b16 v[82:83], v2 offset:16896
v_cndmask_b32 v7, v5, v7, vcc
v_rcp_f32 v18, v18
v_mfma_f32_16x16x32_bf16 v[244:247], v[92:95], a[116:119], v[244:247]
s_cmp_eq_u32 s80, 0
s_cselect_b32 s86, s91, 0
v_add_u32 v7, s85, v7
v_lshrrev_b32 v5, 4, v0
v_mfma_f32_16x16x32_bf16 v[240:243], v[92:95], a[112:115], v[240:243]
ds_read_b64_tr_b16 v[84:85], v2 offset:17408
v_cmp_eq_u32 vcc, 0, v5
v_mfma_f32_16x16x32_bf16 v[192:195], v[64:67], a[128:131], v[192:195]
v_mul_u32_u24 v5, 144, v5
v_add_u32 v5, v5, v7
v_mfma_f32_16x16x32_bf16 v[196:199], v[64:67], a[132:135], v[196:199]
s_cmp_eq_u32 s80, 1
s_cselect_b64 s[94:95], vcc, 0
ds_read_b64_tr_b16 v[86:87], v2 offset:17920
v_add_u32 v7, 576, v7
v_rcp_f32 v19, v19
v_mfma_f32_16x16x32_bf16 v[200:203], v[64:67], a[136:139], v[200:203]
v_cndmask_b32 v6, v6, v7, vcc
v_mov_b32 v7, s91
v_mfma_f32_16x16x32_bf16 v[204:207], v[64:67], a[140:143], v[204:207]
ds_read_b64_tr_b16 v[88:89], v3 offset:16384
v_cndmask_b32 v7, v5, v7, s[94:95]
v_mfma_f32_16x16x32_bf16 v[220:223], v[68:71], a[140:143], v[220:223]
buffer_load_ushort v40, v7, s[72:75], 0 offen
v_mul_f32 v128, v128, v16
v_mfma_f32_16x16x32_bf16 v[216:219], v[68:71], a[136:139], v[216:219]
ds_read_b64_tr_b16 v[90:91], v3 offset:16896
v_mul_f32 v129, v129, v17
v_mul_f32 v130, v130, v18
v_mfma_f32_16x16x32_bf16 v[212:215], v[68:71], a[132:135], v[212:215]
buffer_load_ushort v41, v7, s[72:75], 0 offen offset:36
v_mul_f32 v131, v131, v19
v_mfma_f32_16x16x32_bf16 v[208:211], v[68:71], a[128:131], v[208:211]
s_add_u32 m0, s84, 0
ds_read_b64_tr_b16 v[92:93], v3 offset:17408
v_cvt_pk_bf16_f32 v24, v128, v129
v_cvt_pk_bf16_f32 v25, v130, v131
v_mfma_f32_16x16x32_bf16 v[224:227], v[72:75], a[128:131], v[224:227]
buffer_load_ushort v42, v5, s[72:75], 0 offen offset:72
v_mul_f32 v22, s87, v162
v_mul_f32 v23, s87, v163
v_mfma_f32_16x16x32_bf16 v[228:231], v[72:75], a[132:135], v[228:231]
s_waitcnt vmcnt(19)
ds_read_b64_tr_b16 v[94:95], v3 offset:17920
v_mul_f32 v160, v160, v176
v_mfma_f32_16x16x32_bf16 v[232:235], v[72:75], a[136:139], v[232:235]
s_barrier
ds_write_b64 v4, v[24:25]
v_mfma_f32_16x16x32_bf16 v[236:239], v[72:75], a[140:143], v[236:239]
s_add_u32 s81, s13, 4423808
ds_read_b64_tr_b16 v[64:65], v2 offset:24576
v_mul_f32 v161, v161, v177
s_waitcnt lgkmcnt(4)
v_mfma_f32_16x16x32_bf16 v[252:255], v[76:79], a[140:143], v[252:255]
buffer_load_dwordx4 v1, s[40:43], s81 offen lds
v_mfma_f32_16x16x32_bf16 v[248:251], v[76:79], a[136:139], v[248:251]
ds_read_b64_tr_b16 v[66:67], v2 offset:25088
v_mul_f32 v162, v162, v178
v_mfma_f32_16x16x32_bf16 v[244:247], v[76:79], a[132:135], v[244:247]
buffer_load_dwordx4 v1, s[44:47], s81 offen offset:1024 lds
v_exp_f32 v20, v20
v_mfma_f32_16x16x32_bf16 v[240:243], v[76:79], a[128:131], v[240:243]
ds_read_b64_tr_b16 v[68:69], v2 offset:25600
v_mul_f32 v163, v163, v179
v_mfma_f32_16x16x32_bf16 v[192:195], v[80:83], a[144:147], v[192:195]
buffer_load_ushort v43, v5, s[72:75], 0 offen offset:108
v_max_u32 v5, s86, v6
v_mfma_f32_16x16x32_bf16 v[196:199], v[80:83], a[148:151], v[196:199]
s_add_u32 m0, s84, 8192
ds_read_b64_tr_b16 v[70:71], v2 offset:26112
v_add_f32 v20, 1.0, v20
v_mfma_f32_16x16x32_bf16 v[200:203], v[80:83], a[152:155], v[200:203]
buffer_load_ushort v44, v6, s[72:75], 0 offen
v_exp_f32 v21, v21
v_mfma_f32_16x16x32_bf16 v[204:207], v[80:83], a[156:159], v[204:207]
s_add_u32 s81, s13, 4718720
ds_read_b64_tr_b16 v[72:73], v3 offset:24576
v_add_f32 v21, 1.0, v21
v_exp_f32 v22, v22
v_mfma_f32_16x16x32_bf16 v[220:223], v[84:87], a[156:159], v[220:223]
buffer_load_ushort v45, v6, s[72:75], 0 offen offset:36
v_add_f32 v22, 1.0, v22
v_mfma_f32_16x16x32_bf16 v[216:219], v[84:87], a[152:155], v[216:219]
ds_read_b64_tr_b16 v[74:75], v3 offset:25088
v_mul_f32 v16, s87, v132
v_mfma_f32_16x16x32_bf16 v[212:215], v[84:87], a[148:151], v[212:215]
buffer_load_ushort v46, v5, s[72:75], 0 offen offset:72
v_mul_f32 v17, s87, v133
v_mfma_f32_16x16x32_bf16 v[208:211], v[84:87], a[144:147], v[208:211]
ds_read_b64_tr_b16 v[76:77], v3 offset:25600
v_mul_f32 v18, s87, v134
v_exp_f32 v23, v23
v_mfma_f32_16x16x32_bf16 v[224:227], v[88:91], a[144:147], v[224:227]
buffer_load_dwordx4 v1, s[40:43], s81 offen lds
v_mfma_f32_16x16x32_bf16 v[228:231], v[88:91], a[148:151], v[228:231]
ds_read_b64_tr_b16 v[78:79], v3 offset:26112
v_add_f32 v23, 1.0, v23
v_mfma_f32_16x16x32_bf16 v[232:235], v[88:91], a[152:155], v[232:235]
buffer_load_dwordx4 v1, s[44:47], s81 offen offset:1024 lds
v_mfma_f32_16x16x32_bf16 v[236:239], v[88:91], a[156:159], v[236:239]
s_waitcnt lgkmcnt(2)
ds_read_b64_tr_b16 v[80:81], v2 offset:32768
v_mul_f32 v19, s87, v135
v_rcp_f32 v20, v20
v_mfma_f32_16x16x32_bf16 v[252:255], v[92:95], a[156:159], v[252:255]
buffer_load_ushort v47, v5, s[72:75], 0 offen offset:108
v_mul_f32 v160, v160, v20
v_mfma_f32_16x16x32_bf16 v[248:251], v[92:95], a[152:155], v[248:251]
ds_read_b64_tr_b16 v[82:83], v2 offset:33280
v_mul_f32 v132, v132, v148
v_mfma_f32_16x16x32_bf16 v[244:247], v[92:95], a[148:151], v[244:247]
v_rcp_f32 v21, v21
v_rcp_f32 v22, v22
v_mfma_f32_16x16x32_bf16 v[240:243], v[92:95], a[144:147], v[240:243]
ds_read_b64_tr_b16 v[84:85], v2 offset:33792
v_mul_f32 v161, v161, v21
v_mfma_f32_16x16x32_bf16 v[192:195], v[64:67], a[160:163], v[192:195]
v_rcp_f32 v23, v23
v_mfma_f32_16x16x32_bf16 v[196:199], v[64:67], a[164:167], v[196:199]
ds_read_b64_tr_b16 v[86:87], v2 offset:34304
v_mul_f32 v162, v162, v22
v_mfma_f32_16x16x32_bf16 v[200:203], v[64:67], a[168:171], v[200:203]
v_mul_f32 v163, v163, v23
v_cvt_pk_bf16_f32 v26, v160, v161
v_cvt_pk_bf16_f32 v27, v162, v163
v_mfma_f32_16x16x32_bf16 v[204:207], v[64:67], a[172:175], v[204:207]
ds_read_b64_tr_b16 v[88:89], v3 offset:32768
v_mul_f32 v133, v133, v149
v_mfma_f32_16x16x32_bf16 v[220:223], v[68:71], a[172:175], v[220:223]
ds_write_b64 v4, v[26:27] offset:8
v_exp_f32 v16, v16
v_mfma_f32_16x16x32_bf16 v[216:219], v[68:71], a[168:171], v[216:219]
ds_read_b64_tr_b16 v[90:91], v3 offset:33280
v_mul_f32 v134, v134, v150
v_mfma_f32_16x16x32_bf16 v[212:215], v[68:71], a[164:167], v[212:215]
v_exp_f32 v17, v17
v_mfma_f32_16x16x32_bf16 v[208:211], v[68:71], a[160:163], v[208:211]
s_add_u32 m0, s84, 16384
ds_read_b64_tr_b16 v[92:93], v3 offset:33792
v_mul_f32 v135, v135, v151
v_mfma_f32_16x16x32_bf16 v[224:227], v[72:75], a[160:163], v[224:227]
v_exp_f32 v18, v18
v_exp_f32 v19, v19
v_mfma_f32_16x16x32_bf16 v[228:231], v[72:75], a[164:167], v[228:231]
s_waitcnt vmcnt(18)
ds_read_b64_tr_b16 v[94:95], v3 offset:34304
v_add_f32 v16, 1.0, v16
v_mfma_f32_16x16x32_bf16 v[232:235], v[72:75], a[168:171], v[232:235]
s_barrier
v_mfma_f32_16x16x32_bf16 v[236:239], v[72:75], a[172:175], v[236:239]
s_add_u32 s81, s13, 5013632
ds_read_b64_tr_b16 v[64:65], v2 offset:40960
v_add_f32 v17, 1.0, v17
v_add_f32 v18, 1.0, v18
s_waitcnt lgkmcnt(3)
v_mfma_f32_16x16x32_bf16 v[252:255], v[76:79], a[172:175], v[252:255]
buffer_load_dwordx4 v1, s[40:43], s81 offen lds
v_mfma_f32_16x16x32_bf16 v[248:251], v[76:79], a[168:171], v[248:251]
ds_read_b64_tr_b16 v[66:67], v2 offset:41472
v_add_f32 v19, 1.0, v19
v_rcp_f32 v16, v16
v_mfma_f32_16x16x32_bf16 v[244:247], v[76:79], a[164:167], v[244:247]
buffer_load_dwordx4 v1, s[44:47], s81 offen offset:1024 lds
v_mfma_f32_16x16x32_bf16 v[240:243], v[76:79], a[160:163], v[240:243]
ds_read_b64_tr_b16 v[68:69], v2 offset:41984
v_mul_f32 v132, v132, v16
v_mfma_f32_16x16x32_bf16 v[192:195], v[80:83], a[176:179], v[192:195]
v_rcp_f32 v17, v17
v_mfma_f32_16x16x32_bf16 v[196:199], v[80:83], a[180:183], v[196:199]
s_add_u32 m0, s84, 24576
ds_read_b64_tr_b16 v[70:71], v2 offset:42496
v_mul_f32 v133, v133, v17
v_rcp_f32 v18, v18
v_mfma_f32_16x16x32_bf16 v[200:203], v[80:83], a[184:187], v[200:203]
v_rcp_f32 v19, v19
v_mfma_f32_16x16x32_bf16 v[204:207], v[80:83], a[188:191], v[204:207]
s_add_u32 s81, s6, 0
ds_read_b64_tr_b16 v[72:73], v3 offset:40960
v_mul_f32 v134, v134, v18
v_mfma_f32_16x16x32_bf16 v[220:223], v[84:87], a[188:191], v[220:223]
v_mul_f32 v135, v135, v19
v_cvt_pk_bf16_f32 v28, v132, v133
v_mfma_f32_16x16x32_bf16 v[216:219], v[84:87], a[184:187], v[216:219]
ds_read_b64_tr_b16 v[74:75], v3 offset:41472
v_cvt_pk_bf16_f32 v29, v134, v135
v_mul_f32 v20, s87, v164
v_mfma_f32_16x16x32_bf16 v[212:215], v[84:87], a[180:183], v[212:215]
ds_write_b64 v4, v[28:29] offset:1024
v_mul_f32 v21, s87, v165
v_mfma_f32_16x16x32_bf16 v[208:211], v[84:87], a[176:179], v[208:211]
ds_read_b64_tr_b16 v[76:77], v3 offset:41984
v_mul_f32 v22, s87, v166
v_mfma_f32_16x16x32_bf16 v[224:227], v[88:91], a[176:179], v[224:227]
buffer_load_dwordx4 v56, s[32:35], s81 offen lds
v_mul_f32 v23, s87, v167
v_mfma_f32_16x16x32_bf16 v[228:231], v[88:91], a[180:183], v[228:231]
ds_read_b64_tr_b16 v[78:79], v3 offset:42496
v_mul_f32 v164, v164, v180
v_mfma_f32_16x16x32_bf16 v[232:235], v[88:91], a[184:187], v[232:235]
buffer_load_dwordx4 v56, s[36:39], s81 offen offset:1024 lds
v_exp_f32 v20, v20
v_mfma_f32_16x16x32_bf16 v[236:239], v[88:91], a[188:191], v[236:239]
s_waitcnt lgkmcnt(3)
ds_read_b64_tr_b16 v[80:81], v2 offset:49152
v_mul_f32 v165, v165, v181
v_mfma_f32_16x16x32_bf16 v[252:255], v[92:95], a[188:191], v[252:255]
v_exp_f32 v21, v21
v_mfma_f32_16x16x32_bf16 v[248:251], v[92:95], a[184:187], v[248:251]
ds_read_b64_tr_b16 v[82:83], v2 offset:49664
v_mul_f32 v166, v166, v182
v_mfma_f32_16x16x32_bf16 v[244:247], v[92:95], a[180:183], v[244:247]
v_exp_f32 v22, v22
v_exp_f32 v23, v23
v_mfma_f32_16x16x32_bf16 v[240:243], v[92:95], a[176:179], v[240:243]
ds_read_b64_tr_b16 v[84:85], v2 offset:50176
v_mul_f32 v167, v167, v183
v_mfma_f32_16x16x32_bf16 v[192:195], v[64:67], a[192:195], v[192:195]
v_add_f32 v20, 1.0, v20
v_add_f32 v21, 1.0, v21
v_mfma_f32_16x16x32_bf16 v[196:199], v[64:67], a[196:199], v[196:199]
ds_read_b64_tr_b16 v[86:87], v2 offset:50688
v_add_f32 v22, 1.0, v22
v_mfma_f32_16x16x32_bf16 v[200:203], v[64:67], a[200:203], v[200:203]
v_add_f32 v23, 1.0, v23
v_mul_f32 v16, s87, v136
v_rcp_f32 v20, v20
v_mfma_f32_16x16x32_bf16 v[204:207], v[64:67], a[204:207], v[204:207]
ds_read_b64_tr_b16 v[88:89], v3 offset:49152
v_mul_f32 v164, v164, v20
v_mfma_f32_16x16x32_bf16 v[220:223], v[68:71], a[204:207], v[220:223]
v_rcp_f32 v21, v21
v_mfma_f32_16x16x32_bf16 v[216:219], v[68:71], a[200:203], v[216:219]
ds_read_b64_tr_b16 v[90:91], v3 offset:49664
v_mul_f32 v165, v165, v21
v_rcp_f32 v22, v22
v_mfma_f32_16x16x32_bf16 v[212:215], v[68:71], a[196:199], v[212:215]
v_rcp_f32 v23, v23
v_mfma_f32_16x16x32_bf16 v[208:211], v[68:71], a[192:195], v[208:211]
s_add_u32 m0, s84, 32768
ds_read_b64_tr_b16 v[92:93], v3 offset:50176
v_mul_f32 v166, v166, v22
v_mfma_f32_16x16x32_bf16 v[224:227], v[72:75], a[192:195], v[224:227]
v_mul_f32 v167, v167, v23
v_cvt_pk_bf16_f32 v30, v164, v165
v_mfma_f32_16x16x32_bf16 v[228:231], v[72:75], a[196:199], v[228:231]
s_waitcnt vmcnt(11)
ds_read_b64_tr_b16 v[94:95], v3 offset:50688
v_cvt_pk_bf16_f32 v31, v166, v167
v_mul_f32 v17, s87, v137
v_mfma_f32_16x16x32_bf16 v[232:235], v[72:75], a[200:203], v[232:235]
s_barrier
v_mfma_f32_16x16x32_bf16 v[236:239], v[72:75], a[204:207], v[236:239]
s_add_u32 s81, s6, 110592
ds_read_b64_tr_b16 v[64:65], v2 offset:57344
v_mul_f32 v18, s87, v138
v_mul_f32 v19, s87, v139
s_waitcnt lgkmcnt(3)
v_mfma_f32_16x16x32_bf16 v[252:255], v[76:79], a[204:207], v[252:255]
buffer_load_dwordx4 v56, s[32:35], s81 offen lds
v_mfma_f32_16x16x32_bf16 v[248:251], v[76:79], a[200:203], v[248:251]
ds_read_b64_tr_b16 v[66:67], v2 offset:57856
v_mul_f32 v136, v136, v152
v_exp_f32 v16, v16
v_mfma_f32_16x16x32_bf16 v[244:247], v[76:79], a[196:199], v[244:247]
buffer_load_dwordx4 v56, s[36:39], s81 offen offset:1024 lds
v_mfma_f32_16x16x32_bf16 v[240:243], v[76:79], a[192:195], v[240:243]
ds_read_b64_tr_b16 v[68:69], v2 offset:58368
v_mul_f32 v137, v137, v153
v_mfma_f32_16x16x32_bf16 v[192:195], v[80:83], a[208:211], v[192:195]
ds_write_b64 v4, v[30:31] offset:1032
v_exp_f32 v17, v17
v_mfma_f32_16x16x32_bf16 v[196:199], v[80:83], a[212:215], v[196:199]
s_add_u32 m0, s84, 40960
ds_read_b64_tr_b16 v[70:71], v2 offset:58880
v_mul_f32 v138, v138, v154
v_mfma_f32_16x16x32_bf16 v[200:203], v[80:83], a[216:219], v[200:203]
v_exp_f32 v18, v18
v_mfma_f32_16x16x32_bf16 v[204:207], v[80:83], a[220:223], v[204:207]
s_add_u32 s81, s6, 221184
ds_read_b64_tr_b16 v[72:73], v3 offset:57344
v_mul_f32 v139, v139, v155
v_mfma_f32_16x16x32_bf16 v[220:223], v[84:87], a[220:223], v[220:223]
v_exp_f32 v19, v19
v_add_f32 v16, 1.0, v16
v_mfma_f32_16x16x32_bf16 v[216:219], v[84:87], a[216:219], v[216:219]
ds_read_b64_tr_b16 v[74:75], v3 offset:57856
v_add_f32 v17, 1.0, v17
v_mfma_f32_16x16x32_bf16 v[212:215], v[84:87], a[212:215], v[212:215]
v_add_f32 v18, 1.0, v18
v_add_f32 v19, 1.0, v19
v_rcp_f32 v16, v16
v_mfma_f32_16x16x32_bf16 v[208:211], v[84:87], a[208:211], v[208:211]
ds_read_b64_tr_b16 v[76:77], v3 offset:58368
v_mul_f32 v136, v136, v16
v_mfma_f32_16x16x32_bf16 v[224:227], v[88:91], a[208:211], v[224:227]
buffer_load_dwordx4 v56, s[32:35], s81 offen lds
v_mfma_f32_16x16x32_bf16 v[228:231], v[88:91], a[212:215], v[228:231]
ds_read_b64_tr_b16 v[78:79], v3 offset:58880
v_mul_f32 v20, s87, v168
v_rcp_f32 v17, v17
v_mfma_f32_16x16x32_bf16 v[232:235], v[88:91], a[216:219], v[232:235]
buffer_load_dwordx4 v56, s[36:39], s81 offen offset:1024 lds
v_mfma_f32_16x16x32_bf16 v[236:239], v[88:91], a[220:223], v[236:239]
s_waitcnt lgkmcnt(2)
ds_read_b64_tr_b16 v[80:81], v2
v_mul_f32 v137, v137, v17
v_mfma_f32_16x16x32_bf16 v[252:255], v[92:95], a[220:223], v[252:255]
v_rcp_f32 v18, v18
v_mfma_f32_16x16x32_bf16 v[248:251], v[92:95], a[216:219], v[248:251]
ds_read_b64_tr_b16 v[82:83], v2 offset:512
v_mul_f32 v138, v138, v18
v_rcp_f32 v19, v19
v_mfma_f32_16x16x32_bf16 v[244:247], v[92:95], a[212:215], v[244:247]
v_mul_f32 v139, v139, v19
v_cvt_pk_bf16_f32 v24, v136, v137
v_mfma_f32_16x16x32_bf16 v[240:243], v[92:95], a[208:211], v[240:243]
ds_read_b64_tr_b16 v[84:85], v2 offset:1024
v_cvt_pk_bf16_f32 v25, v138, v139
v_mfma_f32_16x16x32_bf16 v[192:195], v[64:67], a[224:227], v[192:195]
ds_write_b64 v4, v[24:25] offset:2048
v_mfma_f32_16x16x32_bf16 v[196:199], v[64:67], a[228:231], v[196:199]
ds_read_b64_tr_b16 v[86:87], v2 offset:1536
v_mul_f32 v21, s87, v169
v_mul_f32 v22, s87, v170
v_mfma_f32_16x16x32_bf16 v[200:203], v[64:67], a[232:235], v[200:203]
v_mul_f32 v23, s87, v171
v_mul_f32 v168, v168, v184
v_mfma_f32_16x16x32_bf16 v[204:207], v[64:67], a[236:239], v[204:207]
ds_read_b64_tr_b16 v[88:89], v3
v_mul_f32 v169, v169, v185
v_exp_f32 v20, v20
v_mfma_f32_16x16x32_bf16 v[220:223], v[68:71], a[236:239], v[220:223]
v_exp_f32 v21, v21
v_mfma_f32_16x16x32_bf16 v[216:219], v[68:71], a[232:235], v[216:219]
ds_read_b64_tr_b16 v[90:91], v3 offset:512
v_mul_f32 v170, v170, v186
v_mfma_f32_16x16x32_bf16 v[212:215], v[68:71], a[228:231], v[212:215]
v_exp_f32 v22, v22
v_exp_f32 v23, v23
v_mfma_f32_16x16x32_bf16 v[208:211], v[68:71], a[224:227], v[208:211]
s_add_u32 m0, s84, 49152
ds_read_b64_tr_b16 v[92:93], v3 offset:1024
v_mul_f32 v171, v171, v187
v_mfma_f32_16x16x32_bf16 v[224:227], v[72:75], a[224:227], v[224:227]
v_add_f32 v20, 1.0, v20
v_add_f32 v21, 1.0, v21
v_mfma_f32_16x16x32_bf16 v[228:231], v[72:75], a[228:231], v[228:231]
s_waitcnt vmcnt(6)
ds_read_b64_tr_b16 v[94:95], v3 offset:1536
v_add_f32 v22, 1.0, v22
v_mfma_f32_16x16x32_bf16 v[232:235], v[72:75], a[232:235], v[232:235]
s_barrier
v_add_f32 v23, 1.0, v23
v_mfma_f32_16x16x32_bf16 v[236:239], v[72:75], a[236:239], v[236:239]
s_add_u32 s81, s6, 331776
ds_read_b64_tr_b16 v[64:65], v2 offset:8192
v_mul_f32 v16, s87, v140
s_waitcnt lgkmcnt(3)
v_mfma_f32_16x16x32_bf16 v[252:255], v[76:79], a[236:239], v[252:255]
buffer_load_dwordx4 v56, s[32:35], s81 offen lds
v_rcp_f32 v20, v20
v_mfma_f32_16x16x32_bf16 v[248:251], v[76:79], a[232:235], v[248:251]
ds_read_b64_tr_b16 v[66:67], v2 offset:8704
v_mul_f32 v168, v168, v20
v_mfma_f32_16x16x32_bf16 v[244:247], v[76:79], a[228:231], v[244:247]
buffer_load_dwordx4 v56, s[36:39], s81 offen offset:1024 lds
v_mfma_f32_16x16x32_bf16 v[240:243], v[76:79], a[224:227], v[240:243]
ds_read_b64_tr_b16 v[68:69], v2 offset:9216
v_mul_f32 v17, s87, v141
v_mfma_f32_16x16x32_bf16 v[192:195], v[80:83], a[240:243], v[192:195]
v_rcp_f32 v21, v21
v_rcp_f32 v22, v22
v_mfma_f32_16x16x32_bf16 v[196:199], v[80:83], a[244:247], v[196:199]
s_add_u32 m0, s84, 57344
ds_read_b64_tr_b16 v[70:71], v2 offset:9728
v_mul_f32 v169, v169, v21
v_mfma_f32_16x16x32_bf16 v[200:203], v[80:83], a[248:251], v[200:203]
v_rcp_f32 v23, v23
v_mfma_f32_16x16x32_bf16 v[204:207], v[80:83], a[252:255], v[204:207]
s_add_u32 s81, s6, 442368
ds_read_b64_tr_b16 v[72:73], v3 offset:8192
v_mul_f32 v170, v170, v22
v_mul_f32 v171, v171, v23
v_mfma_f32_16x16x32_bf16 v[220:223], v[84:87], a[252:255], v[220:223]
v_cvt_pk_bf16_f32 v26, v168, v169
v_cvt_pk_bf16_f32 v27, v170, v171
v_mfma_f32_16x16x32_bf16 v[216:219], v[84:87], a[248:251], v[216:219]
ds_read_b64_tr_b16 v[74:75], v3 offset:8704
v_mul_f32 v18, s87, v142
v_mul_f32 v19, s87, v143
v_mfma_f32_16x16x32_bf16 v[212:215], v[84:87], a[244:247], v[212:215]
ds_write_b64 v4, v[26:27] offset:2056
v_mfma_f32_16x16x32_bf16 v[208:211], v[84:87], a[240:243], v[208:211]
ds_read_b64_tr_b16 v[76:77], v3 offset:9216
v_mul_f32 v140, v140, v156
v_exp_f32 v16, v16
v_mfma_f32_16x16x32_bf16 v[224:227], v[88:91], a[240:243], v[224:227]
buffer_load_dwordx4 v56, s[32:35], s81 offen lds
v_mfma_f32_16x16x32_bf16 v[228:231], v[88:91], a[244:247], v[228:231]
ds_read_b64_tr_b16 v[78:79], v3 offset:9728
v_mul_f32 v141, v141, v157
v_mfma_f32_16x16x32_bf16 v[232:235], v[88:91], a[248:251], v[232:235]
buffer_load_dwordx4 v56, s[36:39], s81 offen offset:1024 lds
v_mfma_f32_16x16x32_bf16 v[236:239], v[88:91], a[252:255], v[236:239]
s_waitcnt lgkmcnt(3)
ds_read_b64_tr_b16 v[80:81], v2 offset:16384
v_mul_f32 v142, v142, v158
v_exp_f32 v17, v17
v_mfma_f32_16x16x32_bf16 v[252:255], v[92:95], a[252:255], v[252:255]
v_exp_f32 v18, v18
v_mfma_f32_16x16x32_bf16 v[248:251], v[92:95], a[248:251], v[248:251]
ds_read_b64_tr_b16 v[82:83], v2 offset:16896
v_mul_f32 v143, v143, v159
v_mfma_f32_16x16x32_bf16 v[244:247], v[92:95], a[244:247], v[244:247]
v_exp_f32 v19, v19
v_add_f32 v16, 1.0, v16
v_mfma_f32_16x16x32_bf16 v[240:243], v[92:95], a[240:243], v[240:243]
ds_read_b64_tr_b16 v[84:85], v2 offset:17408
v_add_f32 v17, 1.0, v17
v_mfma_f32_16x16x32_bf16 v[192:195], v[64:67], v[96:99], v[192:195]
v_add_f32 v18, 1.0, v18
v_add_f32 v19, 1.0, v19
v_rcp_f32 v16, v16
v_mfma_f32_16x16x32_bf16 v[196:199], v[64:67], v[100:103], v[196:199]
ds_read_b64_tr_b16 v[86:87], v2 offset:17920
v_mul_f32 v140, v140, v16
v_mfma_f32_16x16x32_bf16 v[200:203], v[64:67], v[104:107], v[200:203]
v_rcp_f32 v17, v17
v_mfma_f32_16x16x32_bf16 v[204:207], v[64:67], v[108:111], v[204:207]
ds_read_b64_tr_b16 v[88:89], v3 offset:16384
v_mul_f32 v141, v141, v17
v_mfma_f32_16x16x32_bf16 v[220:223], v[68:71], v[108:111], v[220:223]
v_rcp_f32 v18, v18
v_rcp_f32 v19, v19
v_mfma_f32_16x16x32_bf16 v[216:219], v[68:71], v[104:107], v[216:219]
ds_read_b64_tr_b16 v[90:91], v3 offset:16896
v_mul_f32 v142, v142, v18
v_mfma_f32_16x16x32_bf16 v[212:215], v[68:71], v[100:103], v[212:215]
v_mul_f32 v143, v143, v19
v_cvt_pk_bf16_f32 v28, v140, v141
v_mfma_f32_16x16x32_bf16 v[208:211], v[68:71], v[96:99], v[208:211]
s_add_u32 m0, s84, 0
ds_read_b64_tr_b16 v[92:93], v3 offset:17408
v_cvt_pk_bf16_f32 v29, v142, v143
v_mfma_f32_16x16x32_bf16 v[224:227], v[72:75], v[96:99], v[224:227]
ds_write_b64 v4, v[28:29] offset:3072
v_mul_f32 v20, s87, v172
v_mfma_f32_16x16x32_bf16 v[228:231], v[72:75], v[100:103], v[228:231]
s_waitcnt vmcnt(6)
ds_read_b64_tr_b16 v[94:95], v3 offset:17920
v_mul_f32 v21, s87, v173
v_mul_f32 v22, s87, v174
v_mfma_f32_16x16x32_bf16 v[232:235], v[72:75], v[104:107], v[232:235]
s_barrier
v_mfma_f32_16x16x32_bf16 v[236:239], v[72:75], v[108:111], v[236:239]
s_add_u32 s81, s6, 552960
ds_read_b64_tr_b16 v[64:65], v57 offset:24576
v_mul_f32 v23, s87, v175
v_exp_f32 v20, v20
s_waitcnt lgkmcnt(4)
v_mfma_f32_16x16x32_bf16 v[252:255], v[76:79], v[108:111], v[252:255]
buffer_load_dwordx4 v56, s[32:35], s81 offen lds
v_mfma_f32_16x16x32_bf16 v[248:251], v[76:79], v[104:107], v[248:251]
ds_read_b64_tr_b16 v[66:67], v57 offset:25600
v_mul_f32 v172, v172, v188
v_mfma_f32_16x16x32_bf16 v[244:247], v[76:79], v[100:103], v[244:247]
buffer_load_dwordx4 v56, s[36:39], s81 offen offset:1024 lds
v_mfma_f32_16x16x32_bf16 v[240:243], v[76:79], v[96:99], v[240:243]
ds_read_b64_tr_b16 v[68:69], v58 offset:24576
v_mul_f32 v173, v173, v189
v_exp_f32 v21, v21
v_mfma_f32_16x16x32_bf16 v[192:195], v[80:83], v[112:115], v[192:195]
v_exp_f32 v22, v22
v_mfma_f32_16x16x32_bf16 v[196:199], v[80:83], v[116:119], v[196:199]
s_add_u32 m0, s84, 8192
ds_read_b64_tr_b16 v[70:71], v58 offset:25600
v_mul_f32 v174, v174, v190
v_mfma_f32_16x16x32_bf16 v[200:203], v[80:83], v[120:123], v[200:203]
v_exp_f32 v23, v23
v_mfma_f32_16x16x32_bf16 v[204:207], v[80:83], v[124:127], v[204:207]
s_add_u32 s81, s6, 663552
ds_read_b64_tr_b16 v[72:73], v59 offset:24576
v_mul_f32 v175, v175, v191
v_add_f32 v20, 1.0, v20
v_mfma_f32_16x16x32_bf16 v[220:223], v[84:87], v[124:127], v[220:223]
v_add_f32 v21, 1.0, v21
v_add_f32 v22, 1.0, v22
v_add_f32 v23, 1.0, v23
v_mfma_f32_16x16x32_bf16 v[216:219], v[84:87], v[120:123], v[216:219]
s_mov_b32 s98, -24576
ds_read_b64_tr_b16 v[74:75], v59 offset:25600
v_mad_i32_i24 v62, v61, s98, v60
v_mfma_f32_16x16x32_bf16 v[212:215], v[84:87], v[116:119], v[212:215]
v_rcp_f32 v20, v20
v_rcp_f32 v21, v21
v_mfma_f32_16x16x32_bf16 v[208:211], v[84:87], v[112:115], v[208:211]
ds_read_b64_tr_b16 v[76:77], v62 offset:24576
v_mul_f32 v172, v172, v20
v_mfma_f32_16x16x32_bf16 v[224:227], v[88:91], v[112:115], v[224:227]
buffer_load_dwordx4 v56, s[32:35], s81 offen lds
v_mfma_f32_16x16x32_bf16 v[228:231], v[88:91], v[116:119], v[228:231]
ds_read_b64_tr_b16 v[78:79], v62 offset:25600
v_mul_f32 v173, v173, v21
v_mfma_f32_16x16x32_bf16 v[232:235], v[88:91], v[120:123], v[232:235]
buffer_load_dwordx4 v56, s[36:39], s81 offen offset:1024 lds
v_rcp_f32 v22, v22
v_mfma_f32_16x16x32_bf16 v[236:239], v[88:91], v[124:127], v[236:239]
s_waitcnt lgkmcnt(2)
ds_read_b64_tr_b16 v[80:81], v57 offset:32768
v_mul_f32 v174, v174, v22
v_mfma_f32_16x16x32_bf16 v[252:255], v[92:95], v[124:127], v[252:255]
v_rcp_f32 v23, v23
v_mfma_f32_16x16x32_bf16 v[248:251], v[92:95], v[120:123], v[248:251]
ds_read_b64_tr_b16 v[82:83], v57 offset:33792
v_mul_f32 v175, v175, v23
v_mfma_f32_16x16x32_bf16 v[244:247], v[92:95], v[116:119], v[244:247]
v_cvt_pk_bf16_f32 v30, v172, v173
v_cvt_pk_bf16_f32 v31, v174, v175
v_mfma_f32_16x16x32_bf16 v[240:243], v[92:95], v[112:115], v[240:243]
ds_read_b64_tr_b16 v[84:85], v58 offset:32768
ds_write_b64 v4, v[30:31] offset:3080
v_mfma_f32_16x16x32_bf16 v[128:131], v[64:67], a[0:3], 0
v_mfma_f32_16x16x32_bf16 v[132:135], v[64:67], a[4:7], 0
ds_read_b64_tr_b16 v[86:87], v58 offset:33792
v_mfma_f32_16x16x32_bf16 v[136:139], v[64:67], a[8:11], 0
v_mfma_f32_16x16x32_bf16 v[140:143], v[64:67], a[12:15], 0
ds_read_b64_tr_b16 v[88:89], v59 offset:32768
v_mfma_f32_16x16x32_bf16 v[156:159], v[68:71], a[12:15], 0
v_mul_f32 v16, s87, v192
v_mul_f32 v17, s87, v193
v_mfma_f32_16x16x32_bf16 v[152:155], v[68:71], a[8:11], 0
s_mov_b32 s98, -32640
ds_read_b64_tr_b16 v[90:91], v59 offset:33792
v_mad_i32_i24 v62, v61, s98, v60
v_mfma_f32_16x16x32_bf16 v[148:151], v[68:71], a[4:7], 0
v_mul_f32 v18, s87, v194
v_mul_f32 v19, s87, v195
v_mfma_f32_16x16x32_bf16 v[144:147], v[68:71], a[0:3], 0
s_add_u32 m0, s84, 16384
ds_read_b64_tr_b16 v[92:93], v62 offset:32768
v_mul_f32 v192, v192, v208
v_mfma_f32_16x16x32_bf16 v[160:163], v[72:75], a[0:3], 0
v_exp_f32 v16, v16
v_mfma_f32_16x16x32_bf16 v[164:167], v[72:75], a[4:7], 0
s_waitcnt vmcnt(6)
ds_read_b64_tr_b16 v[94:95], v62 offset:33792
v_mul_f32 v193, v193, v209
v_mfma_f32_16x16x32_bf16 v[168:171], v[72:75], a[8:11], 0
s_barrier
v_mfma_f32_16x16x32_bf16 v[172:175], v[72:75], a[12:15], 0
s_add_u32 s81, s6, 774144
ds_read_b64_tr_b16 v[64:65], v57 offset:40960
v_mul_f32 v194, v194, v210
s_waitcnt lgkmcnt(3)
v_mfma_f32_16x16x32_bf16 v[188:191], v[76:79], a[12:15], 0
buffer_load_dwordx4 v56, s[32:35], s81 offen lds
v_mfma_f32_16x16x32_bf16 v[184:187], v[76:79], a[8:11], 0
ds_read_b64_tr_b16 v[66:67], v57 offset:41984
v_mul_f32 v195, v195, v211
v_mfma_f32_16x16x32_bf16 v[180:183], v[76:79], a[4:7], 0
buffer_load_dwordx4 v56, s[36:39], s81 offen offset:1024 lds
v_mfma_f32_16x16x32_bf16 v[176:179], v[76:79], a[0:3], 0
ds_read_b64_tr_b16 v[68:69], v58 offset:40960
v_add_f32 v16, 1.0, v16
v_mfma_f32_16x16x32_bf16 v[128:131], v[80:83], a[16:19], v[128:131]
v_exp_f32 v17, v17
v_mfma_f32_16x16x32_bf16 v[132:135], v[80:83], a[20:23], v[132:135]
s_add_u32 m0, s84, 24576
ds_read_b64_tr_b16 v[70:71], v58 offset:41984
v_add_f32 v17, 1.0, v17
v_mfma_f32_16x16x32_bf16 v[136:139], v[80:83], a[24:27], v[136:139]
v_exp_f32 v18, v18
v_mfma_f32_16x16x32_bf16 v[140:143], v[80:83], a[28:31], v[140:143]
s_add_u32 s81, s6, 884736
ds_read_b64_tr_b16 v[72:73], v59 offset:40960
v_add_f32 v18, 1.0, v18
v_mfma_f32_16x16x32_bf16 v[156:159], v[84:87], a[28:31], v[156:159]
buffer_load_dwordx4 v56, s[32:35], s81 offen lds
v_mfma_f32_16x16x32_bf16 v[152:155], v[84:87], a[24:27], v[152:155]
s_mov_b32 s98, -40704
ds_read_b64_tr_b16 v[74:75], v59 offset:41984
v_mad_i32_i24 v62, v61, s98, v60
v_mfma_f32_16x16x32_bf16 v[148:151], v[84:87], a[20:23], v[148:151]
v_exp_f32 v19, v19
v_mfma_f32_16x16x32_bf16 v[144:147], v[84:87], a[16:19], v[144:147]
ds_read_b64_tr_b16 v[76:77], v62 offset:40960
v_add_f32 v19, 1.0, v19
v_mfma_f32_16x16x32_bf16 v[160:163], v[88:91], a[16:19], v[160:163]
buffer_load_dwordx4 v56, s[36:39], s81 offen offset:1024 lds
v_mfma_f32_16x16x32_bf16 v[164:167], v[88:91], a[20:23], v[164:167]
ds_read_b64_tr_b16 v[78:79], v62 offset:41984
v_mul_f32 v20, s87, v224
v_mfma_f32_16x16x32_bf16 v[168:171], v[88:91], a[24:27], v[168:171]
v_rcp_f32 v16, v16
v_mfma_f32_16x16x32_bf16 v[172:175], v[88:91], a[28:31], v[172:175]
s_waitcnt lgkmcnt(2)
ds_read_b64_tr_b16 v[80:81], v57 offset:49152
v_mul_f32 v192, v192, v16
v_mfma_f32_16x16x32_bf16 v[188:191], v[92:95], a[28:31], v[188:191]
v_rcp_f32 v17, v17
v_mfma_f32_16x16x32_bf16 v[184:187], v[92:95], a[24:27], v[184:187]
ds_read_b64_tr_b16 v[82:83], v57 offset:50176
v_mul_f32 v193, v193, v17
v_mfma_f32_16x16x32_bf16 v[180:183], v[92:95], a[20:23], v[180:183]
v_rcp_f32 v18, v18
v_mfma_f32_16x16x32_bf16 v[176:179], v[92:95], a[16:19], v[176:179]
ds_read_b64_tr_b16 v[84:85], v58 offset:49152
v_mul_f32 v194, v194, v18
v_mfma_f32_16x16x32_bf16 v[128:131], v[64:67], a[32:35], v[128:131]
v_rcp_f32 v19, v19
v_mfma_f32_16x16x32_bf16 v[132:135], v[64:67], a[36:39], v[132:135]
ds_read_b64_tr_b16 v[86:87], v58 offset:50176
v_mul_f32 v195, v195, v19
v_mfma_f32_16x16x32_bf16 v[136:139], v[64:67], a[40:43], v[136:139]
v_cvt_pk_bf16_f32 v24, v192, v193
v_cvt_pk_bf16_f32 v25, v194, v195
v_mfma_f32_16x16x32_bf16 v[140:143], v[64:67], a[44:47], v[140:143]
ds_read_b64_tr_b16 v[88:89], v59 offset:49152
v_mul_f32 v21, s87, v225
v_mfma_f32_16x16x32_bf16 v[156:159], v[68:71], a[44:47], v[156:159]
ds_write_b64 v4, v[24:25] offset:16384
v_mfma_f32_16x16x32_bf16 v[152:155], v[68:71], a[40:43], v[152:155]
s_mov_b32 s98, -48768
ds_read_b64_tr_b16 v[90:91], v59 offset:50176
v_mad_i32_i24 v62, v61, s98, v60
v_mfma_f32_16x16x32_bf16 v[148:151], v[68:71], a[36:39], v[148:151]
v_mul_f32 v22, s87, v226
v_mul_f32 v23, s87, v227
v_mfma_f32_16x16x32_bf16 v[144:147], v[68:71], a[32:35], v[144:147]
s_add_u32 m0, s84, 32768
ds_read_b64_tr_b16 v[92:93], v62 offset:49152
v_mul_f32 v224, v224, v240
v_mfma_f32_16x16x32_bf16 v[160:163], v[72:75], a[32:35], v[160:163]
v_exp_f32 v20, v20
v_mfma_f32_16x16x32_bf16 v[164:167], v[72:75], a[36:39], v[164:167]
s_waitcnt vmcnt(6)
ds_read_b64_tr_b16 v[94:95], v62 offset:50176
v_mul_f32 v225, v225, v241
v_mfma_f32_16x16x32_bf16 v[168:171], v[72:75], a[40:43], v[168:171]
s_barrier
v_mfma_f32_16x16x32_bf16 v[172:175], v[72:75], a[44:47], v[172:175]
s_add_u32 s81, s6, 995328
ds_read_b64_tr_b16 v[64:65], v57 offset:57344
v_mul_f32 v226, v226, v242
s_waitcnt lgkmcnt(3)
v_mfma_f32_16x16x32_bf16 v[188:191], v[76:79], a[44:47], v[188:191]
buffer_load_dwordx4 v56, s[32:35], s81 offen lds
v_mfma_f32_16x16x32_bf16 v[184:187], v[76:79], a[40:43], v[184:187]
ds_read_b64_tr_b16 v[66:67], v57 offset:58368
v_mul_f32 v227, v227, v243
v_mfma_f32_16x16x32_bf16 v[180:183], v[76:79], a[36:39], v[180:183]
buffer_load_dwordx4 v56, s[36:39], s81 offen offset:1024 lds
v_mfma_f32_16x16x32_bf16 v[176:179], v[76:79], a[32:35], v[176:179]
ds_read_b64_tr_b16 v[68:69], v58 offset:57344
v_add_f32 v20, 1.0, v20
v_mfma_f32_16x16x32_bf16 v[128:131], v[80:83], a[48:51], v[128:131]
v_exp_f32 v21, v21
v_mfma_f32_16x16x32_bf16 v[132:135], v[80:83], a[52:55], v[132:135]
s_add_u32 m0, s84, 40960
ds_read_b64_tr_b16 v[70:71], v58 offset:58368
v_add_f32 v21, 1.0, v21
v_mfma_f32_16x16x32_bf16 v[136:139], v[80:83], a[56:59], v[136:139]
v_exp_f32 v22, v22
v_mfma_f32_16x16x32_bf16 v[140:143], v[80:83], a[60:63], v[140:143]
s_add_u32 s81, s7, 1105920
ds_read_b64_tr_b16 v[72:73], v59 offset:57344
v_add_f32 v22, 1.0, v22
v_mfma_f32_16x16x32_bf16 v[156:159], v[84:87], a[60:63], v[156:159]
buffer_load_dwordx4 v56, s[32:35], s81 offen lds
v_mfma_f32_16x16x32_bf16 v[152:155], v[84:87], a[56:59], v[152:155]
s_mov_b32 s98, -56832
ds_read_b64_tr_b16 v[74:75], v59 offset:58368
v_mad_i32_i24 v62, v61, s98, v60
v_mfma_f32_16x16x32_bf16 v[148:151], v[84:87], a[52:55], v[148:151]
v_exp_f32 v23, v23
v_mfma_f32_16x16x32_bf16 v[144:147], v[84:87], a[48:51], v[144:147]
ds_read_b64_tr_b16 v[76:77], v62 offset:57344
v_add_f32 v23, 1.0, v23
v_mfma_f32_16x16x32_bf16 v[160:163], v[88:91], a[48:51], v[160:163]
buffer_load_dwordx4 v56, s[36:39], s81 offen offset:1024 lds
v_mfma_f32_16x16x32_bf16 v[164:167], v[88:91], a[52:55], v[164:167]
ds_read_b64_tr_b16 v[78:79], v62 offset:58368
v_mul_f32 v16, s87, v196
v_mfma_f32_16x16x32_bf16 v[168:171], v[88:91], a[56:59], v[168:171]
v_rcp_f32 v20, v20
v_mfma_f32_16x16x32_bf16 v[172:175], v[88:91], a[60:63], v[172:175]
s_waitcnt lgkmcnt(2)
ds_read_b64_tr_b16 v[80:81], v57
v_mul_f32 v224, v224, v20
v_mfma_f32_16x16x32_bf16 v[188:191], v[92:95], a[60:63], v[188:191]
v_lshl_or_b32 v8, v33, 16, v32
v_lshl_or_b32 v9, v35, 16, v34
v_mfma_f32_16x16x32_bf16 v[184:187], v[92:95], a[56:59], v[184:187]
ds_read_b64_tr_b16 v[82:83], v57 offset:1024
v_lshl_or_b32 v10, v37, 16, v36
v_mfma_f32_16x16x32_bf16 v[180:183], v[92:95], a[52:55], v[180:183]
v_lshl_or_b32 v11, v39, 16, v38
v_lshl_or_b32 v12, v41, 16, v40
v_mfma_f32_16x16x32_bf16 v[176:179], v[92:95], a[48:51], v[176:179]
ds_read_b64_tr_b16 v[84:85], v58
v_lshl_or_b32 v13, v43, 16, v42
v_mfma_f32_16x16x32_bf16 v[128:131], v[64:67], a[64:67], v[128:131]
v_lshl_or_b32 v14, v45, 16, v44
v_lshl_or_b32 v15, v47, 16, v46
v_mfma_f32_16x16x32_bf16 v[132:135], v[64:67], a[68:71], v[132:135]
ds_read_b64_tr_b16 v[86:87], v58 offset:1024
v_mul_f32 v17, s87, v197
v_mfma_f32_16x16x32_bf16 v[136:139], v[64:67], a[72:75], v[136:139]
v_rcp_f32 v21, v21
v_mfma_f32_16x16x32_bf16 v[140:143], v[64:67], a[76:79], v[140:143]
ds_read_b64_tr_b16 v[88:89], v59
v_mul_f32 v225, v225, v21
v_mfma_f32_16x16x32_bf16 v[156:159], v[68:71], a[76:79], v[156:159]
v_rcp_f32 v22, v22
v_mfma_f32_16x16x32_bf16 v[152:155], v[68:71], a[72:75], v[152:155]
s_mov_b32 s98, 640
ds_read_b64_tr_b16 v[90:91], v59 offset:1024
v_mad_i32_i24 v62, v61, s98, v60
v_mfma_f32_16x16x32_bf16 v[148:151], v[68:71], a[68:71], v[148:151]
v_rcp_f32 v23, v23
v_mfma_f32_16x16x32_bf16 v[144:147], v[68:71], a[64:67], v[144:147]
s_add_u32 m0, s84, 49152
ds_read_b64_tr_b16 v[92:93], v62
v_mul_f32 v226, v226, v22
v_mfma_f32_16x16x32_bf16 v[160:163], v[72:75], a[64:67], v[160:163]
v_mul_f32 v227, v227, v23
v_cvt_pk_bf16_f32 v26, v224, v225
v_mfma_f32_16x16x32_bf16 v[164:167], v[72:75], a[68:71], v[164:167]
s_waitcnt vmcnt(6)
ds_read_b64_tr_b16 v[94:95], v62 offset:1024
v_cvt_pk_bf16_f32 v27, v226, v227
v_mfma_f32_16x16x32_bf16 v[168:171], v[72:75], a[72:75], v[168:171]
s_barrier
v_mfma_f32_16x16x32_bf16 v[172:175], v[72:75], a[76:79], v[172:175]
s_add_u32 s81, s7, 1216512
ds_read_b64_tr_b16 v[64:65], v57 offset:8192
v_mul_f32 v18, s87, v198
s_waitcnt lgkmcnt(3)
v_mfma_f32_16x16x32_bf16 v[188:191], v[76:79], a[76:79], v[188:191]
buffer_load_dwordx4 v56, s[32:35], s81 offen lds
v_mfma_f32_16x16x32_bf16 v[184:187], v[76:79], a[72:75], v[184:187]
ds_read_b64_tr_b16 v[66:67], v57 offset:9216
v_mul_f32 v19, s87, v199
v_mfma_f32_16x16x32_bf16 v[180:183], v[76:79], a[68:71], v[180:183]
buffer_load_dwordx4 v56, s[36:39], s81 offen offset:1024 lds
v_mfma_f32_16x16x32_bf16 v[176:179], v[76:79], a[64:67], v[176:179]
ds_read_b64_tr_b16 v[68:69], v58 offset:8192
v_mul_f32 v196, v196, v212
v_mfma_f32_16x16x32_bf16 v[128:131], v[80:83], a[80:83], v[128:131]
ds_write_b64 v4, v[26:27] offset:16392
v_mfma_f32_16x16x32_bf16 v[132:135], v[80:83], a[84:87], v[132:135]
s_add_u32 m0, s84, 57344
ds_read_b64_tr_b16 v[70:71], v58 offset:9216
v_mul_f32 v197, v197, v213
v_mfma_f32_16x16x32_bf16 v[136:139], v[80:83], a[88:91], v[136:139]
v_exp_f32 v16, v16
v_mfma_f32_16x16x32_bf16 v[140:143], v[80:83], a[92:95], v[140:143]
s_add_u32 s81, s7, 1327104
ds_read_b64_tr_b16 v[72:73], v59 offset:8192
v_mul_f32 v198, v198, v214
v_mfma_f32_16x16x32_bf16 v[156:159], v[84:87], a[92:95], v[156:159]
buffer_load_dwordx4 v56, s[32:35], s81 offen lds
v_mfma_f32_16x16x32_bf16 v[152:155], v[84:87], a[88:91], v[152:155]
s_mov_b32 s98, -7424
ds_read_b64_tr_b16 v[74:75], v59 offset:9216
v_mad_i32_i24 v62, v61, s98, v60
v_mfma_f32_16x16x32_bf16 v[148:151], v[84:87], a[84:87], v[148:151]
v_exp_f32 v17, v17
v_mfma_f32_16x16x32_bf16 v[144:147], v[84:87], a[80:83], v[144:147]
ds_read_b64_tr_b16 v[76:77], v62 offset:8192
v_mul_f32 v199, v199, v215
v_mfma_f32_16x16x32_bf16 v[160:163], v[88:91], a[80:83], v[160:163]
buffer_load_dwordx4 v56, s[36:39], s81 offen offset:1024 lds
v_mfma_f32_16x16x32_bf16 v[164:167], v[88:91], a[84:87], v[164:167]
ds_read_b64_tr_b16 v[78:79], v62 offset:9216
v_add_f32 v16, 1.0, v16
v_mfma_f32_16x16x32_bf16 v[168:171], v[88:91], a[88:91], v[168:171]
v_exp_f32 v18, v18
v_mfma_f32_16x16x32_bf16 v[172:175], v[88:91], a[92:95], v[172:175]
s_waitcnt lgkmcnt(2)
ds_read_b64_tr_b16 v[80:81], v57 offset:16384
v_add_f32 v17, 1.0, v17
v_mfma_f32_16x16x32_bf16 v[188:191], v[92:95], a[92:95], v[188:191]
v_exp_f32 v19, v19
v_mfma_f32_16x16x32_bf16 v[184:187], v[92:95], a[88:91], v[184:187]
ds_read_b64_tr_b16 v[82:83], v57 offset:17408
v_add_f32 v18, 1.0, v18
v_mfma_f32_16x16x32_bf16 v[180:183], v[92:95], a[84:87], v[180:183]
v_add_f32 v19, 1.0, v19
v_mul_f32 v20, s87, v228
v_mfma_f32_16x16x32_bf16 v[176:179], v[92:95], a[80:83], v[176:179]
ds_read_b64_tr_b16 v[84:85], v58 offset:16384
v_mul_f32 v21, s87, v229
v_mfma_f32_16x16x32_bf16 v[128:131], v[64:67], a[96:99], v[128:131]
v_rcp_f32 v16, v16
v_mfma_f32_16x16x32_bf16 v[132:135], v[64:67], a[100:103], v[132:135]
ds_read_b64_tr_b16 v[86:87], v58 offset:17408
v_mul_f32 v196, v196, v16
v_mfma_f32_16x16x32_bf16 v[136:139], v[64:67], a[104:107], v[136:139]
v_rcp_f32 v17, v17
v_mfma_f32_16x16x32_bf16 v[140:143], v[64:67], a[108:111], v[140:143]
ds_read_b64_tr_b16 v[88:89], v59 offset:16384
v_mul_f32 v197, v197, v17
v_mfma_f32_16x16x32_bf16 v[156:159], v[68:71], a[108:111], v[156:159]
v_rcp_f32 v18, v18
v_mfma_f32_16x16x32_bf16 v[152:155], v[68:71], a[104:107], v[152:155]
s_mov_b32 s98, -15488
ds_read_b64_tr_b16 v[90:91], v59 offset:17408
v_mad_i32_i24 v62, v61, s98, v60
v_mfma_f32_16x16x32_bf16 v[148:151], v[68:71], a[100:103], v[148:151]
v_rcp_f32 v19, v19
v_mfma_f32_16x16x32_bf16 v[144:147], v[68:71], a[96:99], v[144:147]
s_add_u32 m0, s84, 0
ds_read_b64_tr_b16 v[92:93], v62 offset:16384
v_mul_f32 v198, v198, v18
v_mfma_f32_16x16x32_bf16 v[160:163], v[72:75], a[96:99], v[160:163]
v_mul_f32 v199, v199, v19
v_cvt_pk_bf16_f32 v28, v196, v197
v_mfma_f32_16x16x32_bf16 v[164:167], v[72:75], a[100:103], v[164:167]
s_waitcnt vmcnt(6)
ds_read_b64_tr_b16 v[94:95], v62 offset:17408
v_cvt_pk_bf16_f32 v29, v198, v199
v_mfma_f32_16x16x32_bf16 v[168:171], v[72:75], a[104:107], v[168:171]
s_barrier
v_mfma_f32_16x16x32_bf16 v[172:175], v[72:75], a[108:111], v[172:175]
s_add_u32 s81, s7, 1437696
ds_read_b64_tr_b16 v[64:65], v57 offset:24576
v_mul_f32 v22, s87, v230
s_waitcnt lgkmcnt(3)
v_mfma_f32_16x16x32_bf16 v[188:191], v[76:79], a[108:111], v[188:191]
buffer_load_dwordx4 v56, s[32:35], s81 offen lds
v_mfma_f32_16x16x32_bf16 v[184:187], v[76:79], a[104:107], v[184:187]
ds_read_b64_tr_b16 v[66:67], v57 offset:25600
v_mul_f32 v23, s87, v231
v_mfma_f32_16x16x32_bf16 v[180:183], v[76:79], a[100:103], v[180:183]
buffer_load_dwordx4 v56, s[36:39], s81 offen offset:1024 lds
v_mfma_f32_16x16x32_bf16 v[176:179], v[76:79], a[96:99], v[176:179]
ds_read_b64_tr_b16 v[68:69], v58 offset:24576
v_mul_f32 v228, v228, v244
v_mfma_f32_16x16x32_bf16 v[128:131], v[80:83], a[112:115], v[128:131]
ds_write_b64 v4, v[28:29] offset:17408
v_mfma_f32_16x16x32_bf16 v[132:135], v[80:83], a[116:119], v[132:135]
s_add_u32 m0, s84, 8192
ds_read_b64_tr_b16 v[70:71], v58 offset:25600
v_mul_f32 v229, v229, v245
v_mfma_f32_16x16x32_bf16 v[136:139], v[80:83], a[120:123], v[136:139]
v_exp_f32 v20, v20
v_mfma_f32_16x16x32_bf16 v[140:143], v[80:83], a[124:127], v[140:143]
s_add_u32 s81, s7, 1548288
ds_read_b64_tr_b16 v[72:73], v59 offset:24576
v_mul_f32 v230, v230, v246
v_mfma_f32_16x16x32_bf16 v[156:159], v[84:87], a[124:127], v[156:159]
buffer_load_dwordx4 v56, s[32:35], s81 offen lds
v_mfma_f32_16x16x32_bf16 v[152:155], v[84:87], a[120:123], v[152:155]
s_mov_b32 s98, -22528
ds_read_b64_tr_b16 v[74:75], v59 offset:25600
v_mad_i32_i24 v62, v61, s98, v60
v_mfma_f32_16x16x32_bf16 v[148:151], v[84:87], a[116:119], v[148:151]
v_exp_f32 v21, v21
v_mfma_f32_16x16x32_bf16 v[144:147], v[84:87], a[112:115], v[144:147]
ds_read_b64_tr_b16 v[76:77], v62 offset:24576
v_mul_f32 v231, v231, v247
v_mfma_f32_16x16x32_bf16 v[160:163], v[88:91], a[112:115], v[160:163]
buffer_load_dwordx4 v56, s[36:39], s81 offen offset:1024 lds
v_mfma_f32_16x16x32_bf16 v[164:167], v[88:91], a[116:119], v[164:167]
ds_read_b64_tr_b16 v[78:79], v62 offset:25600
v_add_f32 v20, 1.0, v20
v_mfma_f32_16x16x32_bf16 v[168:171], v[88:91], a[120:123], v[168:171]
v_exp_f32 v22, v22
v_mfma_f32_16x16x32_bf16 v[172:175], v[88:91], a[124:127], v[172:175]
s_waitcnt lgkmcnt(2)
ds_read_b64_tr_b16 v[80:81], v57 offset:32768
v_add_f32 v21, 1.0, v21
v_mfma_f32_16x16x32_bf16 v[188:191], v[92:95], a[124:127], v[188:191]
v_exp_f32 v23, v23
v_mfma_f32_16x16x32_bf16 v[184:187], v[92:95], a[120:123], v[184:187]
ds_read_b64_tr_b16 v[82:83], v57 offset:33792
v_add_f32 v22, 1.0, v22
v_mfma_f32_16x16x32_bf16 v[180:183], v[92:95], a[116:119], v[180:183]
v_add_f32 v23, 1.0, v23
v_mul_f32 v16, s87, v200
v_mfma_f32_16x16x32_bf16 v[176:179], v[92:95], a[112:115], v[176:179]
ds_read_b64_tr_b16 v[84:85], v58 offset:32768
v_mul_f32 v17, s87, v201
v_mfma_f32_16x16x32_bf16 v[128:131], v[64:67], a[128:131], v[128:131]
v_rcp_f32 v20, v20
v_mfma_f32_16x16x32_bf16 v[132:135], v[64:67], a[132:135], v[132:135]
ds_read_b64_tr_b16 v[86:87], v58 offset:33792
v_mul_f32 v228, v228, v20
v_mfma_f32_16x16x32_bf16 v[136:139], v[64:67], a[136:139], v[136:139]
v_rcp_f32 v21, v21
v_mfma_f32_16x16x32_bf16 v[140:143], v[64:67], a[140:143], v[140:143]
ds_read_b64_tr_b16 v[88:89], v59 offset:32768
v_mul_f32 v229, v229, v21
v_mfma_f32_16x16x32_bf16 v[156:159], v[68:71], a[140:143], v[156:159]
v_rcp_f32 v22, v22
v_mfma_f32_16x16x32_bf16 v[152:155], v[68:71], a[136:139], v[152:155]
s_mov_b32 s98, -30592
ds_read_b64_tr_b16 v[90:91], v59 offset:33792
v_mad_i32_i24 v62, v61, s98, v60
v_mfma_f32_16x16x32_bf16 v[148:151], v[68:71], a[132:135], v[148:151]
v_rcp_f32 v23, v23
v_mfma_f32_16x16x32_bf16 v[144:147], v[68:71], a[128:131], v[144:147]
s_add_u32 m0, s84, 16384
ds_read_b64_tr_b16 v[92:93], v62 offset:32768
v_mul_f32 v230, v230, v22
v_mfma_f32_16x16x32_bf16 v[160:163], v[72:75], a[128:131], v[160:163]
v_mul_f32 v231, v231, v23
v_cvt_pk_bf16_f32 v30, v228, v229
v_mfma_f32_16x16x32_bf16 v[164:167], v[72:75], a[132:135], v[164:167]
s_waitcnt vmcnt(6)
ds_read_b64_tr_b16 v[94:95], v62 offset:33792
v_cvt_pk_bf16_f32 v31, v230, v231
v_mfma_f32_16x16x32_bf16 v[168:171], v[72:75], a[136:139], v[168:171]
s_barrier
v_mfma_f32_16x16x32_bf16 v[172:175], v[72:75], a[140:143], v[172:175]
s_add_u32 s81, s7, 1658880
ds_read_b64_tr_b16 v[64:65], v57 offset:40960
v_mul_f32 v18, s87, v202
s_waitcnt lgkmcnt(3)
v_mfma_f32_16x16x32_bf16 v[188:191], v[76:79], a[140:143], v[188:191]
buffer_load_dwordx4 v56, s[32:35], s81 offen lds
v_mfma_f32_16x16x32_bf16 v[184:187], v[76:79], a[136:139], v[184:187]
ds_read_b64_tr_b16 v[66:67], v57 offset:41984
v_mul_f32 v19, s87, v203
v_mfma_f32_16x16x32_bf16 v[180:183], v[76:79], a[132:135], v[180:183]
buffer_load_dwordx4 v56, s[36:39], s81 offen offset:1024 lds
v_mfma_f32_16x16x32_bf16 v[176:179], v[76:79], a[128:131], v[176:179]
ds_read_b64_tr_b16 v[68:69], v58 offset:40960
v_mul_f32 v200, v200, v216
v_mfma_f32_16x16x32_bf16 v[128:131], v[80:83], a[144:147], v[128:131]
ds_write_b64 v4, v[30:31] offset:17416
v_mfma_f32_16x16x32_bf16 v[132:135], v[80:83], a[148:151], v[132:135]
s_add_u32 m0, s84, 24576
ds_read_b64_tr_b16 v[70:71], v58 offset:41984
v_mul_f32 v201, v201, v217
v_mfma_f32_16x16x32_bf16 v[136:139], v[80:83], a[152:155], v[136:139]
v_exp_f32 v16, v16
v_mfma_f32_16x16x32_bf16 v[140:143], v[80:83], a[156:159], v[140:143]
s_add_u32 s81, s7, 1769472
ds_read_b64_tr_b16 v[72:73], v59 offset:40960
v_mul_f32 v202, v202, v218
v_mfma_f32_16x16x32_bf16 v[156:159], v[84:87], a[156:159], v[156:159]
buffer_load_dwordx4 v56, s[32:35], s81 offen lds
v_mfma_f32_16x16x32_bf16 v[152:155], v[84:87], a[152:155], v[152:155]
s_mov_b32 s98, -38656
ds_read_b64_tr_b16 v[74:75], v59 offset:41984
v_mad_i32_i24 v62, v61, s98, v60
v_mfma_f32_16x16x32_bf16 v[148:151], v[84:87], a[148:151], v[148:151]
v_exp_f32 v17, v17
v_mfma_f32_16x16x32_bf16 v[144:147], v[84:87], a[144:147], v[144:147]
ds_read_b64_tr_b16 v[76:77], v62 offset:40960
v_mul_f32 v203, v203, v219
v_mfma_f32_16x16x32_bf16 v[160:163], v[88:91], a[144:147], v[160:163]
buffer_load_dwordx4 v56, s[36:39], s81 offen offset:1024 lds
v_mfma_f32_16x16x32_bf16 v[164:167], v[88:91], a[148:151], v[164:167]
ds_read_b64_tr_b16 v[78:79], v62 offset:41984
v_add_f32 v16, 1.0, v16
v_mfma_f32_16x16x32_bf16 v[168:171], v[88:91], a[152:155], v[168:171]
v_exp_f32 v18, v18
v_mfma_f32_16x16x32_bf16 v[172:175], v[88:91], a[156:159], v[172:175]
s_waitcnt lgkmcnt(2)
ds_read_b64_tr_b16 v[80:81], v57 offset:49152
v_add_f32 v17, 1.0, v17
v_mfma_f32_16x16x32_bf16 v[188:191], v[92:95], a[156:159], v[188:191]
v_exp_f32 v19, v19
v_mfma_f32_16x16x32_bf16 v[184:187], v[92:95], a[152:155], v[184:187]
ds_read_b64_tr_b16 v[82:83], v57 offset:50176
v_add_f32 v18, 1.0, v18
v_mfma_f32_16x16x32_bf16 v[180:183], v[92:95], a[148:151], v[180:183]
v_add_f32 v19, 1.0, v19
v_mul_f32 v20, s87, v232
v_mfma_f32_16x16x32_bf16 v[176:179], v[92:95], a[144:147], v[176:179]
ds_read_b64_tr_b16 v[84:85], v58 offset:49152
v_mul_f32 v21, s87, v233
v_mfma_f32_16x16x32_bf16 v[128:131], v[64:67], a[160:163], v[128:131]
v_rcp_f32 v16, v16
v_mfma_f32_16x16x32_bf16 v[132:135], v[64:67], a[164:167], v[132:135]
ds_read_b64_tr_b16 v[86:87], v58 offset:50176
v_mul_f32 v200, v200, v16
v_mfma_f32_16x16x32_bf16 v[136:139], v[64:67], a[168:171], v[136:139]
v_rcp_f32 v17, v17
v_mfma_f32_16x16x32_bf16 v[140:143], v[64:67], a[172:175], v[140:143]
ds_read_b64_tr_b16 v[88:89], v59 offset:49152
v_mul_f32 v201, v201, v17
v_mfma_f32_16x16x32_bf16 v[156:159], v[68:71], a[172:175], v[156:159]
v_rcp_f32 v18, v18
v_mfma_f32_16x16x32_bf16 v[152:155], v[68:71], a[168:171], v[152:155]
s_mov_b32 s98, -46720
ds_read_b64_tr_b16 v[90:91], v59 offset:50176
v_mad_i32_i24 v62, v61, s98, v60
v_mfma_f32_16x16x32_bf16 v[148:151], v[68:71], a[164:167], v[148:151]
v_rcp_f32 v19, v19
v_mfma_f32_16x16x32_bf16 v[144:147], v[68:71], a[160:163], v[144:147]
s_add_u32 m0, s84, 32768
ds_read_b64_tr_b16 v[92:93], v62 offset:49152
v_mul_f32 v202, v202, v18
v_mfma_f32_16x16x32_bf16 v[160:163], v[72:75], a[160:163], v[160:163]
v_mul_f32 v203, v203, v19
v_cvt_pk_bf16_f32 v24, v200, v201
v_mfma_f32_16x16x32_bf16 v[164:167], v[72:75], a[164:167], v[164:167]
s_waitcnt vmcnt(6)
ds_read_b64_tr_b16 v[94:95], v62 offset:50176
v_cvt_pk_bf16_f32 v25, v202, v203
v_mfma_f32_16x16x32_bf16 v[168:171], v[72:75], a[168:171], v[168:171]
s_barrier
v_mfma_f32_16x16x32_bf16 v[172:175], v[72:75], a[172:175], v[172:175]
s_add_u32 s81, s7, 1880064
ds_read_b64_tr_b16 v[64:65], v57 offset:57344
v_mul_f32 v22, s87, v234
s_waitcnt lgkmcnt(3)
v_mfma_f32_16x16x32_bf16 v[188:191], v[76:79], a[172:175], v[188:191]
buffer_load_dwordx4 v56, s[32:35], s81 offen lds
v_mfma_f32_16x16x32_bf16 v[184:187], v[76:79], a[168:171], v[184:187]
ds_read_b64_tr_b16 v[66:67], v57 offset:58368
v_mul_f32 v23, s87, v235
v_mfma_f32_16x16x32_bf16 v[180:183], v[76:79], a[164:167], v[180:183]
buffer_load_dwordx4 v56, s[36:39], s81 offen offset:1024 lds
v_mfma_f32_16x16x32_bf16 v[176:179], v[76:79], a[160:163], v[176:179]
ds_read_b64_tr_b16 v[68:69], v58 offset:57344
v_mul_f32 v232, v232, v248
v_mfma_f32_16x16x32_bf16 v[128:131], v[80:83], a[176:179], v[128:131]
ds_write_b64 v4, v[24:25] offset:18432
v_mfma_f32_16x16x32_bf16 v[132:135], v[80:83], a[180:183], v[132:135]
s_add_u32 m0, s84, 40960
ds_read_b64_tr_b16 v[70:71], v58 offset:58368
v_mul_f32 v233, v233, v249
v_mfma_f32_16x16x32_bf16 v[136:139], v[80:83], a[184:187], v[136:139]
v_exp_f32 v20, v20
v_mfma_f32_16x16x32_bf16 v[140:143], v[80:83], a[188:191], v[140:143]
s_add_u32 s81, s12, 256
ds_read_b64_tr_b16 v[72:73], v59 offset:57344
v_mul_f32 v234, v234, v250
v_mfma_f32_16x16x32_bf16 v[156:159], v[84:87], a[188:191], v[156:159]
buffer_load_dwordx4 v1, s[40:43], s81 offen lds
v_mfma_f32_16x16x32_bf16 v[152:155], v[84:87], a[184:187], v[152:155]
s_mov_b32 s98, -54784
ds_read_b64_tr_b16 v[74:75], v59 offset:58368
v_mad_i32_i24 v62, v61, s98, v60
v_mfma_f32_16x16x32_bf16 v[148:151], v[84:87], a[180:183], v[148:151]
v_exp_f32 v21, v21
v_mfma_f32_16x16x32_bf16 v[144:147], v[84:87], a[176:179], v[144:147]
ds_read_b64_tr_b16 v[76:77], v62 offset:57344
v_mul_f32 v235, v235, v251
v_mfma_f32_16x16x32_bf16 v[160:163], v[88:91], a[176:179], v[160:163]
buffer_load_dwordx4 v1, s[44:47], s81 offen offset:1024 lds
v_mfma_f32_16x16x32_bf16 v[164:167], v[88:91], a[180:183], v[164:167]
ds_read_b64_tr_b16 v[78:79], v62 offset:58368
v_add_f32 v20, 1.0, v20
v_mfma_f32_16x16x32_bf16 v[168:171], v[88:91], a[184:187], v[168:171]
v_exp_f32 v22, v22
v_mfma_f32_16x16x32_bf16 v[172:175], v[88:91], a[188:191], v[172:175]
s_waitcnt lgkmcnt(2)
ds_read_b64_tr_b16 v[80:81], v57
v_add_f32 v21, 1.0, v21
v_mfma_f32_16x16x32_bf16 v[188:191], v[92:95], a[188:191], v[188:191]
v_exp_f32 v23, v23
v_mfma_f32_16x16x32_bf16 v[184:187], v[92:95], a[184:187], v[184:187]
ds_read_b64_tr_b16 v[82:83], v57 offset:1024
v_add_f32 v22, 1.0, v22
v_mfma_f32_16x16x32_bf16 v[180:183], v[92:95], a[180:183], v[180:183]
v_add_f32 v23, 1.0, v23
v_mul_f32 v16, s87, v204
v_mfma_f32_16x16x32_bf16 v[176:179], v[92:95], a[176:179], v[176:179]
ds_read_b64_tr_b16 v[84:85], v58
v_mul_f32 v17, s87, v205
v_mfma_f32_16x16x32_bf16 v[128:131], v[64:67], a[192:195], v[128:131]
v_rcp_f32 v20, v20
v_mfma_f32_16x16x32_bf16 v[132:135], v[64:67], a[196:199], v[132:135]
ds_read_b64_tr_b16 v[86:87], v58 offset:1024
v_mul_f32 v232, v232, v20
v_mfma_f32_16x16x32_bf16 v[136:139], v[64:67], a[200:203], v[136:139]
v_rcp_f32 v21, v21
v_mfma_f32_16x16x32_bf16 v[140:143], v[64:67], a[204:207], v[140:143]
ds_read_b64_tr_b16 v[88:89], v59
v_mul_f32 v233, v233, v21
v_mfma_f32_16x16x32_bf16 v[156:159], v[68:71], a[204:207], v[156:159]
v_rcp_f32 v22, v22
v_mfma_f32_16x16x32_bf16 v[152:155], v[68:71], a[200:203], v[152:155]
s_mov_b32 s98, 2688
ds_read_b64_tr_b16 v[90:91], v59 offset:1024
v_mad_i32_i24 v62, v61, s98, v60
v_mfma_f32_16x16x32_bf16 v[148:151], v[68:71], a[196:199], v[148:151]
v_rcp_f32 v23, v23
v_mfma_f32_16x16x32_bf16 v[144:147], v[68:71], a[192:195], v[144:147]
s_add_u32 m0, s84, 49152
ds_read_b64_tr_b16 v[92:93], v62
v_mul_f32 v234, v234, v22
v_mfma_f32_16x16x32_bf16 v[160:163], v[72:75], a[192:195], v[160:163]
v_mul_f32 v235, v235, v23
v_cvt_pk_bf16_f32 v26, v232, v233
v_mfma_f32_16x16x32_bf16 v[164:167], v[72:75], a[196:199], v[164:167]
s_waitcnt vmcnt(6)
ds_read_b64_tr_b16 v[94:95], v62 offset:1024
v_cvt_pk_bf16_f32 v27, v234, v235
v_mfma_f32_16x16x32_bf16 v[168:171], v[72:75], a[200:203], v[168:171]
s_barrier
v_mfma_f32_16x16x32_bf16 v[172:175], v[72:75], a[204:207], v[172:175]
s_add_u32 s81, s12, 295168
ds_read_b64_tr_b16 v[64:65], v57 offset:8192
v_mul_f32 v18, s87, v206
s_waitcnt lgkmcnt(3)
v_mfma_f32_16x16x32_bf16 v[188:191], v[76:79], a[204:207], v[188:191]
buffer_load_dwordx4 v1, s[40:43], s81 offen lds
v_mfma_f32_16x16x32_bf16 v[184:187], v[76:79], a[200:203], v[184:187]
ds_read_b64_tr_b16 v[66:67], v57 offset:9216
v_mul_f32 v19, s87, v207
v_mfma_f32_16x16x32_bf16 v[180:183], v[76:79], a[196:199], v[180:183]
buffer_load_dwordx4 v1, s[44:47], s81 offen offset:1024 lds
v_mfma_f32_16x16x32_bf16 v[176:179], v[76:79], a[192:195], v[176:179]
ds_read_b64_tr_b16 v[68:69], v58 offset:8192
v_mul_f32 v204, v204, v220
v_mfma_f32_16x16x32_bf16 v[128:131], v[80:83], a[208:211], v[128:131]
ds_write_b64 v4, v[26:27] offset:18440
v_mfma_f32_16x16x32_bf16 v[132:135], v[80:83], a[212:215], v[132:135]
s_add_u32 m0, s84, 57344
ds_read_b64_tr_b16 v[70:71], v58 offset:9216
v_mul_f32 v205, v205, v221
v_mfma_f32_16x16x32_bf16 v[136:139], v[80:83], a[216:219], v[136:139]
v_exp_f32 v16, v16
v_mfma_f32_16x16x32_bf16 v[140:143], v[80:83], a[220:223], v[140:143]
s_add_u32 s81, s12, 590080
ds_read_b64_tr_b16 v[72:73], v59 offset:8192
v_mul_f32 v206, v206, v222
v_mfma_f32_16x16x32_bf16 v[156:159], v[84:87], a[220:223], v[156:159]
buffer_load_dwordx4 v1, s[40:43], s81 offen lds
v_mfma_f32_16x16x32_bf16 v[152:155], v[84:87], a[216:219], v[152:155]
s_mov_b32 s98, -5376
ds_read_b64_tr_b16 v[74:75], v59 offset:9216
v_mad_i32_i24 v62, v61, s98, v60
v_mfma_f32_16x16x32_bf16 v[148:151], v[84:87], a[212:215], v[148:151]
v_exp_f32 v17, v17
v_mfma_f32_16x16x32_bf16 v[144:147], v[84:87], a[208:211], v[144:147]
ds_read_b64_tr_b16 v[76:77], v62 offset:8192
v_mul_f32 v207, v207, v223
v_mfma_f32_16x16x32_bf16 v[160:163], v[88:91], a[208:211], v[160:163]
buffer_load_dwordx4 v1, s[44:47], s81 offen offset:1024 lds
v_mfma_f32_16x16x32_bf16 v[164:167], v[88:91], a[212:215], v[164:167]
ds_read_b64_tr_b16 v[78:79], v62 offset:9216
v_add_f32 v16, 1.0, v16
v_mfma_f32_16x16x32_bf16 v[168:171], v[88:91], a[216:219], v[168:171]
v_exp_f32 v18, v18
v_mfma_f32_16x16x32_bf16 v[172:175], v[88:91], a[220:223], v[172:175]
s_waitcnt lgkmcnt(2)
ds_read_b64_tr_b16 v[80:81], v57 offset:16384
v_add_f32 v17, 1.0, v17
v_mfma_f32_16x16x32_bf16 v[188:191], v[92:95], a[220:223], v[188:191]
v_exp_f32 v19, v19
v_mfma_f32_16x16x32_bf16 v[184:187], v[92:95], a[216:219], v[184:187]
ds_read_b64_tr_b16 v[82:83], v57 offset:17408
v_add_f32 v18, 1.0, v18
v_mfma_f32_16x16x32_bf16 v[180:183], v[92:95], a[212:215], v[180:183]
v_add_f32 v19, 1.0, v19
v_mul_f32 v20, s87, v236
v_mfma_f32_16x16x32_bf16 v[176:179], v[92:95], a[208:211], v[176:179]
ds_read_b64_tr_b16 v[84:85], v58 offset:16384
v_mul_f32 v21, s87, v237
v_mfma_f32_16x16x32_bf16 v[128:131], v[64:67], a[224:227], v[128:131]
v_rcp_f32 v16, v16
v_mfma_f32_16x16x32_bf16 v[132:135], v[64:67], a[228:231], v[132:135]
ds_read_b64_tr_b16 v[86:87], v58 offset:17408
v_mul_f32 v204, v204, v16
v_mfma_f32_16x16x32_bf16 v[136:139], v[64:67], a[232:235], v[136:139]
v_rcp_f32 v17, v17
v_mfma_f32_16x16x32_bf16 v[140:143], v[64:67], a[236:239], v[140:143]
ds_read_b64_tr_b16 v[88:89], v59 offset:16384
v_mul_f32 v205, v205, v17
v_mfma_f32_16x16x32_bf16 v[156:159], v[68:71], a[236:239], v[156:159]
v_rcp_f32 v18, v18
v_mfma_f32_16x16x32_bf16 v[152:155], v[68:71], a[232:235], v[152:155]
s_mov_b32 s98, -13440
ds_read_b64_tr_b16 v[90:91], v59 offset:17408
v_mad_i32_i24 v62, v61, s98, v60
v_mfma_f32_16x16x32_bf16 v[148:151], v[68:71], a[228:231], v[148:151]
v_rcp_f32 v19, v19
v_mfma_f32_16x16x32_bf16 v[144:147], v[68:71], a[224:227], v[144:147]
s_add_u32 m0, s84, 0
ds_read_b64_tr_b16 v[92:93], v62 offset:16384
v_mul_f32 v206, v206, v18
v_mfma_f32_16x16x32_bf16 v[160:163], v[72:75], a[224:227], v[160:163]
v_mul_f32 v207, v207, v19
v_cvt_pk_bf16_f32 v28, v204, v205
v_mfma_f32_16x16x32_bf16 v[164:167], v[72:75], a[228:231], v[164:167]
s_waitcnt vmcnt(6)
ds_read_b64_tr_b16 v[94:95], v62 offset:17408
v_cvt_pk_bf16_f32 v29, v206, v207
v_mfma_f32_16x16x32_bf16 v[168:171], v[72:75], a[232:235], v[168:171]
s_barrier
v_mfma_f32_16x16x32_bf16 v[172:175], v[72:75], a[236:239], v[172:175]
s_add_u32 s81, s12, 884992
ds_read_b64_tr_b16 v[64:65], v57 offset:24576
v_mul_f32 v22, s87, v238
s_waitcnt lgkmcnt(3)
v_mfma_f32_16x16x32_bf16 v[188:191], v[76:79], a[236:239], v[188:191]
buffer_load_dwordx4 v1, s[40:43], s81 offen lds
v_mfma_f32_16x16x32_bf16 v[184:187], v[76:79], a[232:235], v[184:187]
ds_read_b64_tr_b16 v[66:67], v57 offset:25600
v_mul_f32 v23, s87, v239
v_mfma_f32_16x16x32_bf16 v[180:183], v[76:79], a[228:231], v[180:183]
buffer_load_dwordx4 v1, s[44:47], s81 offen offset:1024 lds
v_mfma_f32_16x16x32_bf16 v[176:179], v[76:79], a[224:227], v[176:179]
ds_read_b64_tr_b16 v[68:69], v58 offset:24576
v_mul_f32 v236, v236, v252
v_mfma_f32_16x16x32_bf16 v[128:131], v[80:83], a[240:243], v[128:131]
ds_write_b64 v4, v[28:29] offset:19456
v_mfma_f32_16x16x32_bf16 v[132:135], v[80:83], a[244:247], v[132:135]
s_add_u32 m0, s84, 8192
ds_read_b64_tr_b16 v[70:71], v58 offset:25600
v_mul_f32 v237, v237, v253
v_mfma_f32_16x16x32_bf16 v[136:139], v[80:83], a[248:251], v[136:139]
v_exp_f32 v20, v20
v_mfma_f32_16x16x32_bf16 v[140:143], v[80:83], a[252:255], v[140:143]
s_add_u32 s81, s12, 1179904
ds_read_b64_tr_b16 v[72:73], v59 offset:24576
v_mul_f32 v238, v238, v254
v_mfma_f32_16x16x32_bf16 v[156:159], v[84:87], a[252:255], v[156:159]
buffer_load_dwordx4 v1, s[40:43], s81 offen lds
v_mfma_f32_16x16x32_bf16 v[152:155], v[84:87], a[248:251], v[152:155]
s_mov_b32 s98, -20480
ds_read_b64_tr_b16 v[74:75], v59 offset:25600
v_mad_i32_i24 v62, v61, s98, v60
v_mfma_f32_16x16x32_bf16 v[148:151], v[84:87], a[244:247], v[148:151]
v_exp_f32 v21, v21
v_mfma_f32_16x16x32_bf16 v[144:147], v[84:87], a[240:243], v[144:147]
ds_read_b64_tr_b16 v[76:77], v62 offset:24576
v_mul_f32 v239, v239, v255
v_mfma_f32_16x16x32_bf16 v[160:163], v[88:91], a[240:243], v[160:163]
buffer_load_dwordx4 v1, s[44:47], s81 offen offset:1024 lds
v_mfma_f32_16x16x32_bf16 v[164:167], v[88:91], a[244:247], v[164:167]
ds_read_b64_tr_b16 v[78:79], v62 offset:25600
v_add_f32 v20, 1.0, v20
v_mfma_f32_16x16x32_bf16 v[168:171], v[88:91], a[248:251], v[168:171]
v_exp_f32 v22, v22
v_mfma_f32_16x16x32_bf16 v[172:175], v[88:91], a[252:255], v[172:175]
s_waitcnt lgkmcnt(2)
ds_read_b64_tr_b16 v[80:81], v57 offset:32768
v_add_f32 v21, 1.0, v21
v_mfma_f32_16x16x32_bf16 v[188:191], v[92:95], a[252:255], v[188:191]
v_exp_f32 v23, v23
v_mfma_f32_16x16x32_bf16 v[184:187], v[92:95], a[248:251], v[184:187]
ds_read_b64_tr_b16 v[82:83], v57 offset:33792
v_add_f32 v22, 1.0, v22
v_mfma_f32_16x16x32_bf16 v[180:183], v[92:95], a[244:247], v[180:183]
v_add_f32 v23, 1.0, v23
v_mfma_f32_16x16x32_bf16 v[176:179], v[92:95], a[240:243], v[176:179]
ds_read_b64_tr_b16 v[84:85], v58 offset:32768
v_mfma_f32_16x16x32_bf16 v[128:131], v[64:67], v[96:99], v[128:131]
v_rcp_f32 v20, v20
v_mfma_f32_16x16x32_bf16 v[132:135], v[64:67], v[100:103], v[132:135]
ds_read_b64_tr_b16 v[86:87], v58 offset:33792
v_mul_f32 v236, v236, v20
v_mfma_f32_16x16x32_bf16 v[136:139], v[64:67], v[104:107], v[136:139]
v_rcp_f32 v21, v21
v_mfma_f32_16x16x32_bf16 v[140:143], v[64:67], v[108:111], v[140:143]
ds_read_b64_tr_b16 v[88:89], v59 offset:32768
v_mul_f32 v237, v237, v21
v_mfma_f32_16x16x32_bf16 v[156:159], v[68:71], v[108:111], v[156:159]
v_rcp_f32 v22, v22
v_mfma_f32_16x16x32_bf16 v[152:155], v[68:71], v[104:107], v[152:155]
s_mov_b32 s98, -28544
ds_read_b64_tr_b16 v[90:91], v59 offset:33792
v_mad_i32_i24 v62, v61, s98, v60
v_mfma_f32_16x16x32_bf16 v[148:151], v[68:71], v[100:103], v[148:151]
v_rcp_f32 v23, v23
v_mfma_f32_16x16x32_bf16 v[144:147], v[68:71], v[96:99], v[144:147]
s_add_u32 m0, s84, 16384
ds_read_b64_tr_b16 v[92:93], v62 offset:32768
v_mul_f32 v238, v238, v22
v_mfma_f32_16x16x32_bf16 v[160:163], v[72:75], v[96:99], v[160:163]
v_mul_f32 v239, v239, v23
v_cvt_pk_bf16_f32 v30, v236, v237
v_mfma_f32_16x16x32_bf16 v[164:167], v[72:75], v[100:103], v[164:167]
s_waitcnt vmcnt(6)
ds_read_b64_tr_b16 v[94:95], v62 offset:33792
v_cvt_pk_bf16_f32 v31, v238, v239
v_mfma_f32_16x16x32_bf16 v[168:171], v[72:75], v[104:107], v[168:171]
s_barrier
v_mfma_f32_16x16x32_bf16 v[172:175], v[72:75], v[108:111], v[172:175]
s_add_u32 s81, s12, 1474816
ds_read_b64_tr_b16 v[64:65], v2 offset:40960
s_waitcnt lgkmcnt(3)
v_mfma_f32_16x16x32_bf16 v[188:191], v[76:79], v[108:111], v[188:191]
buffer_load_dwordx4 v1, s[40:43], s81 offen lds
v_mfma_f32_16x16x32_bf16 v[184:187], v[76:79], v[104:107], v[184:187]
ds_read_b64_tr_b16 v[66:67], v2 offset:41472
v_mfma_f32_16x16x32_bf16 v[180:183], v[76:79], v[100:103], v[180:183]
buffer_load_dwordx4 v1, s[44:47], s81 offen offset:1024 lds
v_mfma_f32_16x16x32_bf16 v[176:179], v[76:79], v[96:99], v[176:179]
ds_read_b64_tr_b16 v[68:69], v2 offset:41984
v_mfma_f32_16x16x32_bf16 v[128:131], v[80:83], v[112:115], v[128:131]
ds_write_b64 v4, v[30:31] offset:19464
v_mfma_f32_16x16x32_bf16 v[132:135], v[80:83], v[116:119], v[132:135]
s_add_u32 m0, s84, 24576
ds_read_b64_tr_b16 v[70:71], v2 offset:42496
v_mfma_f32_16x16x32_bf16 v[136:139], v[80:83], v[120:123], v[136:139]
v_mfma_f32_16x16x32_bf16 v[140:143], v[80:83], v[124:127], v[140:143]
s_add_u32 s81, s12, 1769728
ds_read_b64_tr_b16 v[72:73], v3 offset:40960
v_mfma_f32_16x16x32_bf16 v[156:159], v[84:87], v[124:127], v[156:159]
buffer_load_dwordx4 v1, s[40:43], s81 offen lds
v_mfma_f32_16x16x32_bf16 v[152:155], v[84:87], v[120:123], v[152:155]
ds_read_b64_tr_b16 v[74:75], v3 offset:41472
v_mfma_f32_16x16x32_bf16 v[148:151], v[84:87], v[116:119], v[148:151]
v_mfma_f32_16x16x32_bf16 v[144:147], v[84:87], v[112:115], v[144:147]
ds_read_b64_tr_b16 v[76:77], v3 offset:41984
v_mfma_f32_16x16x32_bf16 v[160:163], v[88:91], v[112:115], v[160:163]
buffer_load_dwordx4 v1, s[44:47], s81 offen offset:1024 lds
v_mfma_f32_16x16x32_bf16 v[164:167], v[88:91], v[116:119], v[164:167]
ds_read_b64_tr_b16 v[78:79], v3 offset:42496
v_mfma_f32_16x16x32_bf16 v[168:171], v[88:91], v[120:123], v[168:171]
v_mfma_f32_16x16x32_bf16 v[172:175], v[88:91], v[124:127], v[172:175]
s_waitcnt lgkmcnt(2)
ds_read_b64_tr_b16 v[80:81], v2 offset:49152
v_mfma_f32_16x16x32_bf16 v[188:191], v[92:95], v[124:127], v[188:191]
v_mfma_f32_16x16x32_bf16 v[184:187], v[92:95], v[120:123], v[184:187]
ds_read_b64_tr_b16 v[82:83], v2 offset:49664
v_mfma_f32_16x16x32_bf16 v[180:183], v[92:95], v[116:119], v[180:183]
v_mfma_f32_16x16x32_bf16 v[176:179], v[92:95], v[112:115], v[176:179]
ds_read_b64_tr_b16 v[84:85], v2 offset:50176
v_mfma_f32_16x16x32_bf16 v[192:195], v[64:67], a[0:3], 0
v_mfma_f32_16x16x32_bf16 v[196:199], v[64:67], a[4:7], 0
s_mul_i32 s85, s101, 36
s_mul_i32 s86, s78, 9
s_add_u32 s85, s85, s86
ds_read_b64_tr_b16 v[86:87], v2 offset:50688
v_min_u32 v24, 8, v0
v_add_u32 v24, s85, v24
v_mul_u32_u24 v24, 9216, v24
v_mfma_f32_16x16x32_bf16 v[200:203], v[64:67], a[8:11], 0
s_add_u32 s85, s82, 384
buffer_load_dword v25, v24, s[40:43], s85 offen
v_lshlrev_b32 v6, 2, v0
v_cmp_le_u32 vcc, 48, v0
v_mfma_f32_16x16x32_bf16 v[204:207], v[64:67], a[12:15], 0
ds_read_b64_tr_b16 v[88:89], v3 offset:49152
v_mfma_f32_16x16x32_bf16 v[220:223], v[68:71], a[12:15], 0
s_mul_i32 s86, s79, 4608
buffer_load_dword v25, v24, s[44:47], s85 offen offset:1024
v_mfma_f32_16x16x32_bf16 v[216:219], v[68:71], a[8:11], 0
s_mov_b32 s85, s83
ds_read_b64_tr_b16 v[90:91], v3 offset:49664
v_mfma_f32_16x16x32_bf16 v[212:215], v[68:71], a[4:7], 0
buffer_load_dword v25, v24, s[40:43], s85 offen
v_mfma_f32_16x16x32_bf16 v[208:211], v[68:71], a[0:3], 0
s_add_u32 m0, s84, 32768
ds_read_b64_tr_b16 v[92:93], v3 offset:50176
v_mfma_f32_16x16x32_bf16 v[224:227], v[72:75], a[0:3], 0
buffer_load_dword v25, v24, s[44:47], s85 offen offset:1024
v_mfma_f32_16x16x32_bf16 v[228:231], v[72:75], a[4:7], 0
s_waitcnt vmcnt(10)
s_lshl_b32 s85, s79, 8
s_add_u32 s85, s85, 159552
ds_read_b64_tr_b16 v[94:95], v3 offset:50688
v_add_u32 v5, s85, v6
v_add_u32 v6, 160256, v6
v_cndmask_b32 v5, v6, v5, vcc
v_lshrrev_b32 v6, 4, v0
v_mfma_f32_16x16x32_bf16 v[232:235], v[72:75], a[8:11], 0
s_barrier
s_mul_i32 s85, s80, 9216
s_add_u32 s85, s85, s86
s_add_u32 s85, s85, 53248
s_lshl_b32 s86, s80, 2
s_sub_u32 s86, s85, s86
ds_write_b32 v5, v176
v_cmp_gt_u32 vcc, 16, v0
v_mov_b32 v17, 0x3f80
v_mfma_f32_16x16x32_bf16 v[236:239], v[72:75], a[12:15], 0
s_add_u32 s81, s12, 2064640
ds_read_b64_tr_b16 v[64:65], v2 offset:57344
s_waitcnt lgkmcnt(4)
v_mfma_f32_16x16x32_bf16 v[252:255], v[76:79], a[12:15], 0
buffer_load_dwordx4 v1, s[40:43], s81 offen lds
v_mfma_f32_16x16x32_bf16 v[248:251], v[76:79], a[8:11], 0
ds_read_b64_tr_b16 v[66:67], v2 offset:57856
v_mfma_f32_16x16x32_bf16 v[244:247], v[76:79], a[4:7], 0
buffer_load_dwordx4 v1, s[44:47], s81 offen offset:1024 lds
v_mfma_f32_16x16x32_bf16 v[240:243], v[76:79], a[0:3], 0
ds_read_b64_tr_b16 v[68:69], v2 offset:58368
v_mfma_f32_16x16x32_bf16 v[192:195], v[80:83], a[16:19], v[192:195]
ds_write_b32 v5, v180 offset:64
v_cvt_pk_bf16_f32 v32, v128, v129
v_cvt_pk_bf16_f32 v33, v130, v131
v_cvt_pk_bf16_f32 v34, v144, v145
v_cvt_pk_bf16_f32 v35, v146, v147
v_cvt_pk_bf16_f32 v36, v160, v161
v_cvt_pk_bf16_f32 v37, v162, v163
v_cvt_pk_bf16_f32 v38, v176, v177
v_cvt_pk_bf16_f32 v39, v178, v179
v_mfma_f32_16x16x32_bf16 v[196:199], v[80:83], a[20:23], v[196:199]
s_add_u32 m0, s84, 40960
ds_read_b64_tr_b16 v[70:71], v2 offset:58880
v_mfma_f32_16x16x32_bf16 v[200:203], v[80:83], a[24:27], v[200:203]
ds_write_b32 v5, v184 offset:128
v_mfma_f32_16x16x32_bf16 v[204:207], v[80:83], a[28:31], v[204:207]
s_add_u32 s81, s12, 2359552
ds_read_b64_tr_b16 v[72:73], v3 offset:57344
v_mfma_f32_16x16x32_bf16 v[220:223], v[84:87], a[28:31], v[220:223]
buffer_load_dwordx4 v1, s[40:43], s81 offen lds
v_mfma_f32_16x16x32_bf16 v[216:219], v[84:87], a[24:27], v[216:219]
ds_read_b64_tr_b16 v[74:75], v3 offset:57856
v_mfma_f32_16x16x32_bf16 v[212:215], v[84:87], a[20:23], v[212:215]
ds_write_b32 v5, v188 offset:192
v_and_b32 v5, 15, v0
v_mul_u32_u24 v5, 72, v5
v_lshl_add_u32 v6, v6, 3, v5
v_add_u32 v6, s86, v6
v_add_u32 v5, s85, v5
v_add_u32 v7, 24, v6
v_add_u32 v16, 48, v5
v_cndmask_b32 v6, v6, v16, vcc
v_cndmask_b32 v7, v7, v16, vcc
v_cmp_le_u32 vcc, 48, v0
v_cvt_pk_bf16_f32 v40, v132, v133
v_cvt_pk_bf16_f32 v41, v134, v135
v_cvt_pk_bf16_f32 v42, v148, v149
v_cvt_pk_bf16_f32 v43, v150, v151
v_cvt_pk_bf16_f32 v44, v164, v165
v_cvt_pk_bf16_f32 v45, v166, v167
v_cvt_pk_bf16_f32 v46, v180, v181
v_mfma_f32_16x16x32_bf16 v[160:163], v[8:11], v[36:39], 0
ds_write2_b32 v6, v34, v35 offset0:0 offset1:1
v_mfma_f32_16x16x32_bf16 v[176:179], v[12:15], v[36:39], 0
v_cndmask_b32 v7, v7, v16, vcc
v_cvt_pk_bf16_f32 v47, v182, v183
v_mfma_f32_16x16x32_bf16 v[128:131], v[8:11], v[32:35], 0
ds_write2_b32 v7, v38, v39 offset0:0 offset1:1
v_mfma_f32_16x16x32_bf16 v[144:147], v[12:15], v[32:35], 0
ds_write_b32 v5, v17 offset:44
v_mfma_f32_16x16x32_bf16 v[164:167], v[8:11], v[44:47], 0
v_add_u32 v6, 1152, v6
v_add_u32 v7, 1152, v7
v_mfma_f32_16x16x32_bf16 v[180:183], v[12:15], v[44:47], 0
ds_write2_b32 v6, v42, v43 offset0:0 offset1:1
v_mfma_f32_16x16x32_bf16 v[132:135], v[8:11], v[40:43], 0
ds_write2_b32 v7, v46, v47 offset0:0 offset1:1
v_mfma_f32_16x16x32_bf16 v[148:151], v[12:15], v[40:43], 0
ds_write_b32 v5, v17 offset:1196
v_mfma_f32_16x16x32_bf16 v[208:211], v[84:87], a[16:19], v[208:211]
ds_read_b64_tr_b16 v[76:77], v3 offset:58368
v_cvt_pk_bf16_f32 v48, v136, v137
v_mfma_f32_16x16x32_bf16 v[224:227], v[88:91], a[16:19], v[224:227]
buffer_load_dwordx4 v1, s[44:47], s81 offen offset:1024 lds
v_mfma_f32_16x16x32_bf16 v[228:231], v[88:91], a[20:23], v[228:231]
ds_read_b64_tr_b16 v[78:79], v3 offset:58880
v_cvt_pk_bf16_f32 v49, v138, v139
v_mfma_f32_16x16x32_bf16 v[232:235], v[88:91], a[24:27], v[232:235]
v_cvt_pk_bf16_f32 v50, v152, v153
v_cvt_pk_bf16_f32 v51, v154, v155
s_nop 1
v_mfma_f32_16x16x32_bf16 v[136:139], v[8:11], v[48:51], 0
v_cvt_pk_bf16_f32 v52, v168, v169
v_cvt_pk_bf16_f32 v53, v170, v171
v_mfma_f32_16x16x32_bf16 v[152:155], v[12:15], v[48:51], 0
v_cvt_pk_bf16_f32 v54, v184, v185
v_cvt_pk_bf16_f32 v55, v186, v187
s_nop 1
v_mfma_f32_16x16x32_bf16 v[168:171], v[8:11], v[52:55], 0
v_add_u32 v6, 1152, v6
v_add_u32 v7, 1152, v7
v_mfma_f32_16x16x32_bf16 v[184:187], v[12:15], v[52:55], 0
ds_write2_b32 v6, v50, v51 offset0:0 offset1:1
v_mfma_f32_16x16x32_bf16 v[236:239], v[88:91], a[28:31], v[236:239]
s_waitcnt lgkmcnt(1)
ds_read_b64_tr_b16 v[80:81], v2
v_cvt_pk_bf16_f32 v56, v140, v141
v_mfma_f32_16x16x32_bf16 v[252:255], v[92:95], a[28:31], v[252:255]
ds_write2_b32 v7, v54, v55 offset0:0 offset1:1
v_mfma_f32_16x16x32_bf16 v[248:251], v[92:95], a[24:27], v[248:251]
ds_read_b64_tr_b16 v[82:83], v2 offset:512
v_cvt_pk_bf16_f32 v57, v142, v143
v_mfma_f32_16x16x32_bf16 v[244:247], v[92:95], a[20:23], v[244:247]
ds_write_b32 v5, v17 offset:2348
v_mfma_f32_16x16x32_bf16 v[240:243], v[92:95], a[16:19], v[240:243]
ds_read_b64_tr_b16 v[84:85], v2 offset:1024
v_cvt_pk_bf16_f32 v58, v156, v157
v_mfma_f32_16x16x32_bf16 v[192:195], v[64:67], a[32:35], v[192:195]
v_cvt_pk_bf16_f32 v59, v158, v159
v_cvt_pk_bf16_f32 v60, v172, v173
s_nop 0
v_mfma_f32_16x16x32_bf16 v[140:143], v[8:11], v[56:59], 0
v_cvt_pk_bf16_f32 v61, v174, v175
v_cvt_pk_bf16_f32 v62, v188, v189
v_mfma_f32_16x16x32_bf16 v[156:159], v[12:15], v[56:59], 0
v_cvt_pk_bf16_f32 v63, v190, v191
v_add_u32 v6, 1152, v6
s_nop 0
v_mfma_f32_16x16x32_bf16 v[172:175], v[8:11], v[60:63], 0
v_add_u32 v7, 1152, v7
v_mfma_f32_16x16x32_bf16 v[188:191], v[12:15], v[60:63], 0
ds_write2_b32 v6, v58, v59 offset0:0 offset1:1
v_mfma_f32_16x16x32_bf16 v[196:199], v[64:67], a[36:39], v[196:199]
ds_read_b64_tr_b16 v[86:87], v2 offset:1536
v_mfma_f32_16x16x32_bf16 v[200:203], v[64:67], a[40:43], v[200:203]
ds_write2_b32 v7, v62, v63 offset0:0 offset1:1
v_mfma_f32_16x16x32_bf16 v[204:207], v[64:67], a[44:47], v[204:207]
ds_read_b64_tr_b16 v[88:89], v3
v_mfma_f32_16x16x32_bf16 v[220:223], v[68:71], a[44:47], v[220:223]
ds_write_b32 v5, v17 offset:3500
v_mfma_f32_16x16x32_bf16 v[216:219], v[68:71], a[40:43], v[216:219]
ds_read_b64_tr_b16 v[90:91], v3 offset:512
v_mfma_f32_16x16x32_bf16 v[212:215], v[68:71], a[36:39], v[212:215]
v_permlane32_swap_b32 v160, v168
v_mfma_f32_16x16x32_bf16 v[208:211], v[68:71], a[32:35], v[208:211]
s_add_u32 m0, s84, 49152
ds_read_b64_tr_b16 v[92:93], v3 offset:1024
v_mfma_f32_16x16x32_bf16 v[224:227], v[72:75], a[32:35], v[224:227]
v_permlane32_swap_b32 v161, v169
v_mfma_f32_16x16x32_bf16 v[228:231], v[72:75], a[36:39], v[228:231]
s_waitcnt vmcnt(10)
ds_read_b64_tr_b16 v[94:95], v3 offset:1536
v_mfma_f32_16x16x32_bf16 v[232:235], v[72:75], a[40:43], v[232:235]
s_barrier
v_mfma_f32_16x16x32_bf16 v[236:239], v[72:75], a[44:47], v[236:239]
s_add_u32 s81, s12, 2654464
ds_read_b64_tr_b16 v[64:65], v2 offset:8192
v_mfma_f32_16x16x32_bf16 v[252:255], v[76:79], a[44:47], v[252:255]
buffer_load_dwordx4 v1, s[40:43], s81 offen lds
v_mfma_f32_16x16x32_bf16 v[248:251], v[76:79], a[40:43], v[248:251]
ds_read_b64_tr_b16 v[66:67], v2 offset:8704
v_mfma_f32_16x16x32_bf16 v[244:247], v[76:79], a[36:39], v[244:247]
buffer_load_dwordx4 v1, s[44:47], s81 offen offset:1024 lds
v_permlane32_swap_b32 v162, v170
v_mfma_f32_16x16x32_bf16 v[240:243], v[76:79], a[32:35], v[240:243]
s_waitcnt lgkmcnt(2)
ds_read_b64_tr_b16 v[68:69], v2 offset:9216
v_permlane32_swap_b32 v163, v171
v_mfma_f32_16x16x32_bf16 v[192:195], v[80:83], a[48:51], v[192:195]
v_permlane32_swap_b32 v176, v184
v_mfma_f32_16x16x32_bf16 v[196:199], v[80:83], a[52:55], v[196:199]
s_add_u32 m0, s84, 57344
ds_read_b64_tr_b16 v[70:71], v2 offset:9728
v_permlane32_swap_b32 v164, v172
v_mfma_f32_16x16x32_bf16 v[200:203], v[80:83], a[56:59], v[200:203]
v_permlane32_swap_b32 v165, v173
v_permlane32_swap_b32 v166, v174
v_mfma_f32_16x16x32_bf16 v[204:207], v[80:83], a[60:63], v[204:207]
s_add_u32 s81, s13, 2949376
ds_read_b64_tr_b16 v[72:73], v3 offset:8192
v_permlane32_swap_b32 v167, v175
v_mfma_f32_16x16x32_bf16 v[220:223], v[84:87], a[60:63], v[220:223]
buffer_load_dwordx4 v1, s[40:43], s81 offen lds
v_mfma_f32_16x16x32_bf16 v[216:219], v[84:87], a[56:59], v[216:219]
ds_read_b64_tr_b16 v[74:75], v3 offset:8704
v_permlane32_swap_b32 v180, v188
v_mfma_f32_16x16x32_bf16 v[212:215], v[84:87], a[52:55], v[212:215]
v_permlane16_swap_b32 v160, v164
v_permlane16_swap_b32 v161, v165
v_mfma_f32_16x16x32_bf16 v[208:211], v[84:87], a[48:51], v[208:211]
ds_read_b64_tr_b16 v[76:77], v3 offset:9216
v_permlane16_swap_b32 v162, v166
v_mfma_f32_16x16x32_bf16 v[224:227], v[88:91], a[48:51], v[224:227]
buffer_load_dwordx4 v1, s[44:47], s81 offen offset:1024 lds
v_mfma_f32_16x16x32_bf16 v[228:231], v[88:91], a[52:55], v[228:231]
ds_read_b64_tr_b16 v[78:79], v3 offset:9728
v_max3_f32 v16, v160, v161, v162
v_permlane16_swap_b32 v163, v167
v_mfma_f32_16x16x32_bf16 v[232:235], v[88:91], a[56:59], v[232:235]
v_permlane16_swap_b32 v176, v180
v_permlane16_swap_b32 v168, v172
v_mfma_f32_16x16x32_bf16 v[236:239], v[88:91], a[60:63], v[236:239]
ds_read_b64_tr_b16 v[80:81], v2 offset:16384
v_min3_f32 v17, v160, v161, v162
v_mfma_f32_16x16x32_bf16 v[252:255], v[92:95], a[60:63], v[252:255]
s_mul_i32 s85, s101, 162
v_min_u32 v28, 13, v0
v_min_u32 v29, 5, v0
v_permlane16_swap_b32 v169, v173
v_permlane16_swap_b32 v170, v174
v_permlane16_swap_b32 v171, v175
v_permlane16_swap_b32 v184, v188
v_max3_f32 v16, v16, v163, v164
v_min3_f32 v17, v17, v163, v164
v_max3_f32 v16, v16, v165, v166
v_mfma_f32_16x16x32_bf16 v[248:251], v[92:95], a[56:59], v[248:251]
s_mul_i32 s86, s78, 41
ds_read_b64_tr_b16 v[82:83], v2 offset:16896
v_min3_f32 v17, v17, v165, v166
v_max3_f32 v16, v16, v167, v168
v_mfma_f32_16x16x32_bf16 v[244:247], v[92:95], a[52:55], v[244:247]
s_add_u32 s85, s85, s86
v_add_u32 v28, s85, v28
v_lshlrev_b32 v28, 7, v28
v_min3_f32 v17, v17, v167, v168
v_mfma_f32_16x16x32_bf16 v[240:243], v[92:95], a[48:51], v[240:243]
s_mul_i32 s85, s76, 331776
ds_read_b64_tr_b16 v[84:85], v2 offset:17408
v_max3_f32 v16, v16, v169, v170
v_min3_f32 v17, v17, v169, v170
s_waitcnt lgkmcnt(3)
v_mfma_f32_16x16x32_bf16 v[192:195], v[64:67], a[64:67], v[192:195]
s_mul_i32 s86, s78, 6
buffer_load_dword v30, v28, s[52:55], s85 offen
v_max3_f32 v16, v16, v171, v172
v_min3_f32 v17, v17, v171, v172
v_mfma_f32_16x16x32_bf16 v[196:199], v[64:67], a[68:71], v[196:199]
s_add_u32 s85, s85, 1792
ds_read_b64_tr_b16 v[86:87], v2 offset:17920
v_max3_f32 v16, v16, v173, v174
v_min3_f32 v17, v17, v173, v174
v_mfma_f32_16x16x32_bf16 v[200:203], v[64:67], a[72:75], v[200:203]
v_max3_f32 v16, v16, v175, v176
v_min3_f32 v17, v17, v175, v176
v_max_f32 v16, v16, v180
v_mfma_f32_16x16x32_bf16 v[204:207], v[64:67], a[76:79], v[204:207]
ds_read_b64_tr_b16 v[88:89], v3 offset:16384
v_min_f32 v17, v17, v180
v_mul_f32 v16, s87, v16
v_mfma_f32_16x16x32_bf16 v[220:223], v[68:71], a[76:79], v[220:223]
v_mul_f32 v17, s88, v17
v_fma_f32 v32, v160, s87, v17
v_fma_f32 v160, v160, s88, v16
v_mfma_f32_16x16x32_bf16 v[216:219], v[68:71], a[72:75], v[216:219]
ds_read_b64_tr_b16 v[90:91], v3 offset:16896
v_fma_f32 v33, v161, s87, v17
v_fma_f32 v161, v161, s88, v16
v_mfma_f32_16x16x32_bf16 v[212:215], v[68:71], a[68:71], v[212:215]
v_fma_f32 v34, v162, s87, v17
v_fma_f32 v162, v162, s88, v16
v_fma_f32 v35, v163, s87, v17
v_mfma_f32_16x16x32_bf16 v[208:211], v[68:71], a[64:67], v[208:211]
s_add_u32 m0, s84, 0
ds_read_b64_tr_b16 v[92:93], v3 offset:17408
v_fma_f32 v163, v163, s88, v16
v_fma_f32 v36, v164, s87, v17
v_mfma_f32_16x16x32_bf16 v[224:227], v[72:75], a[64:67], v[224:227]
v_fma_f32 v164, v164, s88, v16
v_fma_f32 v37, v165, s87, v17
v_fma_f32 v165, v165, s88, v16
v_mfma_f32_16x16x32_bf16 v[228:231], v[72:75], a[68:71], v[228:231]
s_waitcnt vmcnt(7)
ds_read_b64_tr_b16 v[94:95], v3 offset:17920
v_fma_f32 v38, v166, s87, v17
v_fma_f32 v166, v166, s88, v16
v_mfma_f32_16x16x32_bf16 v[232:235], v[72:75], a[72:75], v[232:235]
s_barrier
v_fma_f32 v39, v167, s87, v17
v_mfma_f32_16x16x32_bf16 v[236:239], v[72:75], a[76:79], v[236:239]
s_add_u32 s81, s13, 3244288
ds_read_b64_tr_b16 v[64:65], v2 offset:24576
v_fma_f32 v167, v167, s88, v16
v_fma_f32 v40, v168, s87, v17
v_mfma_f32_16x16x32_bf16 v[252:255], v[76:79], a[76:79], v[252:255]
buffer_load_dwordx4 v1, s[40:43], s81 offen lds
v_fma_f32 v168, v168, s88, v16
v_mfma_f32_16x16x32_bf16 v[248:251], v[76:79], a[72:75], v[248:251]
ds_read_b64_tr_b16 v[66:67], v2 offset:25088
v_fma_f32 v41, v169, s87, v17
v_fma_f32 v169, v169, s88, v16
v_mfma_f32_16x16x32_bf16 v[244:247], v[76:79], a[68:71], v[244:247]
buffer_load_dwordx4 v1, s[44:47], s81 offen offset:1024 lds
v_fma_f32 v42, v170, s87, v17
v_mfma_f32_16x16x32_bf16 v[240:243], v[76:79], a[64:67], v[240:243]
s_waitcnt lgkmcnt(2)
ds_read_b64_tr_b16 v[68:69], v2 offset:25600
v_fma_f32 v170, v170, s88, v16
v_fma_f32 v43, v171, s87, v17
v_mfma_f32_16x16x32_bf16 v[192:195], v[80:83], a[80:83], v[192:195]
v_fma_f32 v171, v171, s88, v16
v_fma_f32 v44, v172, s87, v17
v_fma_f32 v172, v172, s88, v16
v_mfma_f32_16x16x32_bf16 v[196:199], v[80:83], a[84:87], v[196:199]
s_add_u32 m0, s84, 8192
ds_read_b64_tr_b16 v[70:71], v2 offset:26112
v_fma_f32 v45, v173, s87, v17
v_fma_f32 v173, v173, s88, v16
v_mfma_f32_16x16x32_bf16 v[200:203], v[80:83], a[88:91], v[200:203]
v_fma_f32 v46, v174, s87, v17
v_fma_f32 v174, v174, s88, v16
v_fma_f32 v47, v175, s87, v17
v_mfma_f32_16x16x32_bf16 v[204:207], v[80:83], a[92:95], v[204:207]
s_add_u32 s81, s13, 3539200
ds_read_b64_tr_b16 v[72:73], v3 offset:24576
v_fma_f32 v175, v175, s88, v16
v_fma_f32 v48, v176, s87, v17
v_mfma_f32_16x16x32_bf16 v[220:223], v[84:87], a[92:95], v[220:223]
buffer_load_dwordx4 v1, s[40:43], s81 offen lds
v_fma_f32 v176, v176, s88, v16
v_mfma_f32_16x16x32_bf16 v[216:219], v[84:87], a[88:91], v[216:219]
ds_read_b64_tr_b16 v[74:75], v3 offset:25088
v_fma_f32 v49, v180, s87, v17
v_fma_f32 v180, v180, s88, v16
v_exp_f32 v160, v160
v_mfma_f32_16x16x32_bf16 v[212:215], v[84:87], a[84:87], v[212:215]
buffer_load_dword v30, v28, s[52:55], s85 offen
v_exp_f32 v32, v32
v_mfma_f32_16x16x32_bf16 v[208:211], v[84:87], a[80:83], v[208:211]
s_add_u32 s85, s85, 1792
ds_read_b64_tr_b16 v[76:77], v3 offset:25600
v_exp_f32 v161, v161
v_mfma_f32_16x16x32_bf16 v[224:227], v[88:91], a[80:83], v[224:227]
buffer_load_dwordx4 v1, s[44:47], s81 offen offset:1024 lds
v_mfma_f32_16x16x32_bf16 v[228:231], v[88:91], a[84:87], v[228:231]
ds_read_b64_tr_b16 v[78:79], v3 offset:26112
v_add_f32 v18, v160, v161
v_exp_f32 v33, v33
v_mfma_f32_16x16x32_bf16 v[232:235], v[88:91], a[88:91], v[232:235]
v_exp_f32 v162, v162
v_mfma_f32_16x16x32_bf16 v[236:239], v[88:91], a[92:95], v[236:239]
ds_read_b64_tr_b16 v[80:81], v2 offset:32768
v_add_f32 v19, v32, v33
v_exp_f32 v34, v34
v_mfma_f32_16x16x32_bf16 v[252:255], v[92:95], a[92:95], v[252:255]
v_exp_f32 v163, v163
v_mfma_f32_16x16x32_bf16 v[248:251], v[92:95], a[88:91], v[248:251]
ds_read_b64_tr_b16 v[82:83], v2 offset:33280
v_add_f32 v18, v18, v162
v_exp_f32 v35, v35
v_mfma_f32_16x16x32_bf16 v[244:247], v[92:95], a[84:87], v[244:247]
v_add_f32 v19, v19, v34
v_add_f32 v18, v18, v163
v_mfma_f32_16x16x32_bf16 v[240:243], v[92:95], a[80:83], v[240:243]
s_waitcnt lgkmcnt(2)
ds_read_b64_tr_b16 v[84:85], v2 offset:33792
v_add_f32 v19, v19, v35
v_exp_f32 v164, v164
v_mfma_f32_16x16x32_bf16 v[192:195], v[64:67], a[96:99], v[192:195]
v_exp_f32 v36, v36
v_mfma_f32_16x16x32_bf16 v[196:199], v[64:67], a[100:103], v[196:199]
ds_read_b64_tr_b16 v[86:87], v2 offset:34304
v_add_f32 v18, v18, v164
v_exp_f32 v165, v165
v_mfma_f32_16x16x32_bf16 v[200:203], v[64:67], a[104:107], v[200:203]
v_exp_f32 v37, v37
v_mfma_f32_16x16x32_bf16 v[204:207], v[64:67], a[108:111], v[204:207]
ds_read_b64_tr_b16 v[88:89], v3 offset:32768
v_add_f32 v19, v19, v36
v_exp_f32 v166, v166
v_mfma_f32_16x16x32_bf16 v[220:223], v[68:71], a[108:111], v[220:223]
v_exp_f32 v38, v38
v_mfma_f32_16x16x32_bf16 v[216:219], v[68:71], a[104:107], v[216:219]
ds_read_b64_tr_b16 v[90:91], v3 offset:33280
v_add_f32 v18, v18, v165
v_add_f32 v19, v19, v37
v_mfma_f32_16x16x32_bf16 v[212:215], v[68:71], a[100:103], v[212:215]
v_exp_f32 v167, v167
v_exp_f32 v39, v39
v_mfma_f32_16x16x32_bf16 v[208:211], v[68:71], a[96:99], v[208:211]
s_add_u32 m0, s84, 16384
ds_read_b64_tr_b16 v[92:93], v3 offset:33792
v_add_f32 v18, v18, v166
v_mfma_f32_16x16x32_bf16 v[224:227], v[72:75], a[96:99], v[224:227]
v_add_f32 v19, v19, v38
v_add_f32 v18, v18, v167
v_exp_f32 v168, v168
v_mfma_f32_16x16x32_bf16 v[228:231], v[72:75], a[100:103], v[228:231]
s_waitcnt vmcnt(8)
ds_read_b64_tr_b16 v[94:95], v3 offset:34304
v_add_f32 v19, v19, v39
v_mfma_f32_16x16x32_bf16 v[232:235], v[72:75], a[104:107], v[232:235]
s_barrier
v_exp_f32 v40, v40
v_mfma_f32_16x16x32_bf16 v[236:239], v[72:75], a[108:111], v[236:239]
s_add_u32 s81, s13, 3834112
ds_read_b64_tr_b16 v[64:65], v2 offset:40960
v_add_f32 v18, v18, v168
v_mfma_f32_16x16x32_bf16 v[252:255], v[76:79], a[108:111], v[252:255]
buffer_load_dwordx4 v1, s[40:43], s81 offen lds
v_exp_f32 v169, v169
v_mfma_f32_16x16x32_bf16 v[248:251], v[76:79], a[104:107], v[248:251]
ds_read_b64_tr_b16 v[66:67], v2 offset:41472
v_add_f32 v19, v19, v40
v_mfma_f32_16x16x32_bf16 v[244:247], v[76:79], a[100:103], v[244:247]
buffer_load_dwordx4 v1, s[44:47], s81 offen offset:1024 lds
v_exp_f32 v41, v41
v_mfma_f32_16x16x32_bf16 v[240:243], v[76:79], a[96:99], v[240:243]
s_waitcnt lgkmcnt(2)
ds_read_b64_tr_b16 v[68:69], v2 offset:41984
v_add_f32 v18, v18, v169
v_mfma_f32_16x16x32_bf16 v[192:195], v[80:83], a[112:115], v[192:195]
buffer_load_dword v30, v28, s[52:55], s85 offen
v_add_f32 v19, v19, v41
v_exp_f32 v170, v170
v_mfma_f32_16x16x32_bf16 v[196:199], v[80:83], a[116:119], v[196:199]
s_add_u32 m0, s84, 24576
ds_read_b64_tr_b16 v[70:71], v2 offset:42496
v_add_f32 v18, v18, v170
v_exp_f32 v42, v42
v_mfma_f32_16x16x32_bf16 v[200:203], v[80:83], a[120:123], v[200:203]
s_mul_i32 s85, s101, 21
v_exp_f32 v171, v171
v_mfma_f32_16x16x32_bf16 v[204:207], v[80:83], a[124:127], v[204:207]
s_add_u32 s81, s13, 4129024
ds_read_b64_tr_b16 v[72:73], v3 offset:40960
v_add_f32 v19, v19, v42
v_exp_f32 v43, v43
v_mfma_f32_16x16x32_bf16 v[220:223], v[84:87], a[124:127], v[220:223]
buffer_load_dwordx4 v1, s[40:43], s81 offen lds
v_mfma_f32_16x16x32_bf16 v[216:219], v[84:87], a[120:123], v[216:219]
s_add_u32 s85, s85, s86
ds_read_b64_tr_b16 v[74:75], v3 offset:41472
v_add_u32 v29, s85, v29
v_exp_f32 v172, v172
v_mfma_f32_16x16x32_bf16 v[212:215], v[84:87], a[116:119], v[212:215]
s_mul_i32 s85, s76, 41472
v_lshlrev_b32 v29, 7, v29
v_add_f32 v18, v18, v171
v_mfma_f32_16x16x32_bf16 v[208:211], v[84:87], a[112:115], v[208:211]
ds_read_b64_tr_b16 v[76:77], v3 offset:41984
v_add_f32 v19, v19, v43
v_exp_f32 v44, v44
v_mfma_f32_16x16x32_bf16 v[224:227], v[88:91], a[112:115], v[224:227]
buffer_load_dwordx4 v1, s[44:47], s81 offen offset:1024 lds
v_mfma_f32_16x16x32_bf16 v[228:231], v[88:91], a[116:119], v[228:231]
ds_read_b64_tr_b16 v[78:79], v3 offset:42496
v_add_f32 v18, v18, v172
v_exp_f32 v173, v173
v_mfma_f32_16x16x32_bf16 v[232:235], v[88:91], a[120:123], v[232:235]
v_exp_f32 v45, v45
v_mfma_f32_16x16x32_bf16 v[236:239], v[88:91], a[124:127], v[236:239]
ds_read_b64_tr_b16 v[80:81], v2 offset:49152
v_add_f32 v19, v19, v44
v_exp_f32 v174, v174
v_mfma_f32_16x16x32_bf16 v[252:255], v[92:95], a[124:127], v[252:255]
v_exp_f32 v46, v46
v_mfma_f32_16x16x32_bf16 v[248:251], v[92:95], a[120:123], v[248:251]
ds_read_b64_tr_b16 v[82:83], v2 offset:49664
v_add_f32 v18, v18, v173
v_add_f32 v19, v19, v45
v_mfma_f32_16x16x32_bf16 v[244:247], v[92:95], a[116:119], v[244:247]
v_exp_f32 v175, v175
v_exp_f32 v47, v47
v_mfma_f32_16x16x32_bf16 v[240:243], v[92:95], a[112:115], v[240:243]
s_waitcnt lgkmcnt(2)
ds_read_b64_tr_b16 v[84:85], v2 offset:50176
v_add_f32 v18, v18, v174
v_mfma_f32_16x16x32_bf16 v[192:195], v[64:67], a[128:131], v[192:195]
v_add_f32 v19, v19, v46
v_add_f32 v18, v18, v175
v_exp_f32 v176, v176
v_mfma_f32_16x16x32_bf16 v[196:199], v[64:67], a[132:135], v[196:199]
ds_read_b64_tr_b16 v[86:87], v2 offset:50688
v_add_f32 v19, v19, v47
v_mfma_f32_16x16x32_bf16 v[200:203], v[64:67], a[136:139], v[200:203]
v_exp_f32 v48, v48
v_exp_f32 v180, v180
v_mfma_f32_16x16x32_bf16 v[204:207], v[64:67], a[140:143], v[204:207]
ds_read_b64_tr_b16 v[88:89], v3 offset:49152
v_add_f32 v18, v18, v176
v_mfma_f32_16x16x32_bf16 v[220:223], v[68:71], a[140:143], v[220:223]
buffer_load_dword v30, v29, s[56:59], s85 offen offset:2048
v_add_f32 v19, v19, v48
v_exp_f32 v49, v49
v_mfma_f32_16x16x32_bf16 v[216:219], v[68:71], a[136:139], v[216:219]
ds_read_b64_tr_b16 v[90:91], v3 offset:49664
v_add_f32 v18, v18, v180
v_mfma_f32_16x16x32_bf16 v[212:215], v[68:71], a[132:135], v[212:215]
v_add_f32 v19, v19, v49
v_rcp_f32 v18, v18
v_mfma_f32_16x16x32_bf16 v[208:211], v[68:71], a[128:131], v[208:211]
s_add_u32 m0, s84, 32768
ds_read_b64_tr_b16 v[92:93], v3 offset:50176
v_mul_f32 v160, v160, v18
v_rcp_f32 v19, v19
v_mfma_f32_16x16x32_bf16 v[224:227], v[72:75], a[128:131], v[224:227]
v_mul_f32 v32, v32, v19
v_mul_f32 v161, v161, v18
v_mfma_f32_16x16x32_bf16 v[228:231], v[72:75], a[132:135], v[228:231]
s_waitcnt vmcnt(9)
ds_read_b64_tr_b16 v[94:95], v3 offset:50688
v_mul_f32 v33, v33, v19
v_mul_f32 v162, v162, v18
v_mfma_f32_16x16x32_bf16 v[232:235], v[72:75], a[136:139], v[232:235]
s_barrier
v_mul_f32 v34, v34, v19
v_mfma_f32_16x16x32_bf16 v[236:239], v[72:75], a[140:143], v[236:239]
s_add_u32 s81, s13, 4423936
ds_read_b64_tr_b16 v[64:65], v2 offset:57344
v_mul_f32 v163, v163, v18
v_mul_f32 v35, v35, v19
v_mfma_f32_16x16x32_bf16 v[252:255], v[76:79], a[140:143], v[252:255]
buffer_load_dwordx4 v1, s[40:43], s81 offen lds
v_mul_f32 v164, v164, v18
v_mfma_f32_16x16x32_bf16 v[248:251], v[76:79], a[136:139], v[248:251]
ds_read_b64_tr_b16 v[66:67], v2 offset:57856
v_mul_f32 v36, v36, v19
v_mul_f32 v165, v165, v18
v_mul_f32 v37, v37, v19
v_mfma_f32_16x16x32_bf16 v[244:247], v[76:79], a[132:135], v[244:247]
buffer_load_dwordx4 v1, s[44:47], s81 offen offset:1024 lds
v_mul_f32 v166, v166, v18
v_mfma_f32_16x16x32_bf16 v[240:243], v[76:79], a[128:131], v[240:243]
s_waitcnt lgkmcnt(2)
ds_read_b64_tr_b16 v[68:69], v2 offset:58368
v_mul_f32 v38, v38, v19
v_mul_f32 v167, v167, v18
v_mfma_f32_16x16x32_bf16 v[192:195], v[80:83], a[144:147], v[192:195]
v_mul_f32 v39, v39, v19
v_mul_f32 v168, v168, v18
v_mul_f32 v40, v40, v19
v_mfma_f32_16x16x32_bf16 v[196:199], v[80:83], a[148:151], v[196:199]
s_add_u32 m0, s84, 40960
ds_read_b64_tr_b16 v[70:71], v2 offset:58880
v_mul_f32 v169, v169, v18
v_mul_f32 v41, v41, v19
v_mfma_f32_16x16x32_bf16 v[200:203], v[80:83], a[152:155], v[200:203]
v_mul_f32 v170, v170, v18
v_mul_f32 v42, v42, v19
v_mul_f32 v171, v171, v18
v_mfma_f32_16x16x32_bf16 v[204:207], v[80:83], a[156:159], v[204:207]
s_add_u32 s81, s13, 4718848
ds_read_b64_tr_b16 v[72:73], v3 offset:57344
v_mul_f32 v43, v43, v19
v_mul_f32 v172, v172, v18
v_mfma_f32_16x16x32_bf16 v[220:223], v[84:87], a[156:159], v[220:223]
buffer_load_dwordx4 v1, s[40:43], s81 offen lds
v_mul_f32 v44, v44, v19
v_mfma_f32_16x16x32_bf16 v[216:219], v[84:87], a[152:155], v[216:219]
ds_read_b64_tr_b16 v[74:75], v3 offset:57856
v_mul_f32 v173, v173, v18
v_mul_f32 v45, v45, v19
v_mfma_f32_16x16x32_bf16 v[212:215], v[84:87], a[148:151], v[212:215]
v_mul_f32 v174, v174, v18
v_mul_f32 v46, v46, v19
v_mul_f32 v175, v175, v18
v_mfma_f32_16x16x32_bf16 v[208:211], v[84:87], a[144:147], v[208:211]
ds_read_b64_tr_b16 v[76:77], v3 offset:58368
v_mul_f32 v47, v47, v19
v_mul_f32 v176, v176, v18
v_mfma_f32_16x16x32_bf16 v[224:227], v[88:91], a[144:147], v[224:227]
buffer_load_dwordx4 v1, s[44:47], s81 offen offset:1024 lds
v_mul_f32 v48, v48, v19
v_mfma_f32_16x16x32_bf16 v[228:231], v[88:91], a[148:151], v[228:231]
ds_read_b64_tr_b16 v[78:79], v3 offset:58880
v_mul_f32 v180, v180, v18
v_mul_f32 v49, v49, v19
v_mfma_f32_16x16x32_bf16 v[232:235], v[88:91], a[152:155], v[232:235]
v_cvt_pk_bf16_f32 v52, v176, v180
v_cvt_pk_bf16_f32 v184, v160, v161
v_cvt_pk_bf16_f32 v185, v162, v163
v_mfma_f32_16x16x32_bf16 v[236:239], v[88:91], a[156:159], v[236:239]
ds_read_b64_tr_b16 v[80:81], v2
v_cvt_pk_bf16_f32 v186, v164, v165
v_cvt_pk_bf16_f32 v187, v166, v167
v_mfma_f32_16x16x32_bf16 v[252:255], v[92:95], a[156:159], v[252:255]
s_lshl_b32 s98, s80, 1
v_cvt_pk_bf16_f32 v188, v168, v169
v_cvt_pk_bf16_f32 v189, v170, v171
v_cvt_pk_bf16_f32 v190, v172, v173
v_mfma_f32_16x16x32_bf16 v[248:251], v[92:95], a[152:155], v[248:251]
s_add_u32 s98, s98, s79
ds_read_b64_tr_b16 v[82:83], v2 offset:512
v_cvt_pk_bf16_f32 v191, v174, v175
v_cvt_pk_bf16_f32 v53, v32, v33
v_mfma_f32_16x16x32_bf16 v[244:247], v[92:95], a[148:151], v[244:247]
s_mul_i32 s98, s98, 5120
v_cvt_pk_bf16_f32 v54, v34, v35
v_cvt_pk_bf16_f32 v55, v36, v37
v_cvt_pk_bf16_f32 v176, v38, v39
v_mfma_f32_16x16x32_bf16 v[240:243], v[92:95], a[144:147], v[240:243]
s_add_u32 s98, s98, 32768
ds_read_b64_tr_b16 v[84:85], v2 offset:1024
v_cvt_pk_bf16_f32 v177, v40, v41
v_cvt_pk_bf16_f32 v178, v42, v43
s_waitcnt lgkmcnt(3)
v_mfma_f32_16x16x32_bf16 v[192:195], v[64:67], a[160:163], v[192:195]
v_cvt_pk_bf16_f32 v179, v44, v45
v_cvt_pk_bf16_f32 v180, v46, v47
v_cvt_pk_bf16_f32 v181, v48, v49
v_mfma_f32_16x16x32_bf16 v[196:199], v[64:67], a[164:167], v[196:199]
ds_read_b64_tr_b16 v[86:87], v2 offset:1536
v_mul_u32_u24 v21, 80, v0
v_add_u32 v21, s98, v21
v_mfma_f32_16x16x32_bf16 v[200:203], v[64:67], a[168:171], v[200:203]
ds_write_b64 v21, v[184:185]
v_mfma_f32_16x16x32_bf16 v[204:207], v[64:67], a[172:175], v[204:207]
ds_read_b64_tr_b16 v[88:89], v3
v_mfma_f32_16x16x32_bf16 v[220:223], v[68:71], a[172:175], v[220:223]
ds_write_b64 v21, v[186:187] offset:8
v_mfma_f32_16x16x32_bf16 v[216:219], v[68:71], a[168:171], v[216:219]
ds_read_b64_tr_b16 v[90:91], v3 offset:512
v_mfma_f32_16x16x32_bf16 v[212:215], v[68:71], a[164:167], v[212:215]
ds_write_b64 v21, v[188:189] offset:16
v_mfma_f32_16x16x32_bf16 v[208:211], v[68:71], a[160:163], v[208:211]
s_add_u32 m0, s84, 49152
ds_read_b64_tr_b16 v[92:93], v3 offset:1024
v_mfma_f32_16x16x32_bf16 v[224:227], v[72:75], a[160:163], v[224:227]
ds_write_b64 v21, v[190:191] offset:24
ds_write_b64 v21, v[52:53] offset:32
ds_write_b64 v21, v[54:55] offset:40
ds_write_b64 v21, v[176:177] offset:48
ds_write_b64 v21, v[178:179] offset:56
ds_write_b64 v21, v[180:181] offset:64
s_waitcnt lgkmcnt(0)
v_mfma_f32_16x16x32_bf16 v[228:231], v[72:75], a[164:167], v[228:231]
s_waitcnt vmcnt(8)
ds_read_b64_tr_b16 v[94:95], v3 offset:1536
v_mfma_f32_16x16x32_bf16 v[232:235], v[72:75], a[168:171], v[232:235]
s_barrier
v_mfma_f32_16x16x32_bf16 v[236:239], v[72:75], a[172:175], v[236:239]
s_add_u32 s81, s13, 5013760
ds_read_b64_tr_b16 v[64:65], v2 offset:8192
v_lshrrev_b32 v5, 4, v0
v_permlane32_swap_b32 v128, v136
v_mfma_f32_16x16x32_bf16 v[252:255], v[76:79], a[172:175], v[252:255]
buffer_load_dwordx4 v1, s[40:43], s81 offen lds
v_permlane32_swap_b32 v129, v137
v_mfma_f32_16x16x32_bf16 v[248:251], v[76:79], a[168:171], v[248:251]
s_mul_i32 s85, s80, 10240
ds_read_b64_tr_b16 v[66:67], v2 offset:8704
v_bfe_u32 v6, v0, 2, 2
v_permlane32_swap_b32 v130, v138
v_mfma_f32_16x16x32_bf16 v[244:247], v[76:79], a[164:167], v[244:247]
buffer_load_dwordx4 v1, s[44:47], s81 offen offset:1024 lds
v_permlane32_swap_b32 v131, v139
v_mfma_f32_16x16x32_bf16 v[240:243], v[76:79], a[160:163], v[240:243]
s_add_u32 s85, s85, 32768
ds_read_b64_tr_b16 v[68:69], v2 offset:9216
v_lshl_add_u32 v5, v5, 3, v6
v_permlane32_swap_b32 v144, v152
v_mfma_f32_16x16x32_bf16 v[192:195], v[80:83], a[176:179], v[192:195]
s_lshl_b32 s86, s79, 5
v_and_b32 v6, 3, v0
v_mul_u32_u24 v7, 80, v5
v_permlane32_swap_b32 v132, v140
v_mfma_f32_16x16x32_bf16 v[196:199], v[80:83], a[180:183], v[196:199]
s_add_u32 m0, s84, 57344
ds_read_b64_tr_b16 v[70:71], v2 offset:9728
v_add_u32 v25, s85, v7
v_permlane32_swap_b32 v133, v141
v_mfma_f32_16x16x32_bf16 v[200:203], v[80:83], a[184:187], v[200:203]
s_mul_i32 s85, s80, 9216
v_lshl_add_u32 v24, v6, 4, v25
v_mul_u32_u24 v5, 72, v5
v_permlane32_swap_b32 v134, v142
v_mfma_f32_16x16x32_bf16 v[204:207], v[80:83], a[188:191], v[204:207]
s_add_u32 s81, s12, 384
ds_read_b64_tr_b16 v[72:73], v3 offset:8192
v_permlane32_swap_b32 v135, v143
v_mfma_f32_16x16x32_bf16 v[220:223], v[84:87], a[188:191], v[220:223]
buffer_load_dwordx4 v1, s[40:43], s81 offen lds
v_permlane32_swap_b32 v148, v156
v_mfma_f32_16x16x32_bf16 v[216:219], v[84:87], a[184:187], v[216:219]
s_add_u32 s85, s85, 53256
ds_read_b64_tr_b16 v[74:75], v3 offset:8704
v_permlane16_swap_b32 v128, v132
v_permlane16_swap_b32 v129, v133
v_mfma_f32_16x16x32_bf16 v[212:215], v[84:87], a[180:183], v[212:215]
s_add_u32 s85, s85, s86
v_permlane16_swap_b32 v130, v134
v_mfma_f32_16x16x32_bf16 v[208:211], v[84:87], a[176:179], v[208:211]
s_sub_u32 s86, 1, s79
ds_read_b64_tr_b16 v[76:77], v3 offset:9216
v_mul_u32_u24 v6, s86, v6
v_permlane16_swap_b32 v131, v135
v_mfma_f32_16x16x32_bf16 v[224:227], v[88:91], a[176:179], v[224:227]
buffer_load_dwordx4 v1, s[44:47], s81 offen offset:1024 lds
v_permlane16_swap_b32 v144, v148
v_mfma_f32_16x16x32_bf16 v[228:231], v[88:91], a[180:183], v[228:231]
ds_read_b64_tr_b16 v[78:79], v3 offset:9728
v_lshl_add_u32 v5, v6, 3, v5
v_permlane16_swap_b32 v136, v140
v_mfma_f32_16x16x32_bf16 v[232:235], v[88:91], a[184:187], v[232:235]
v_add_u32 v26, s85, v5
v_max3_f32 v16, v128, v129, v130
v_permlane16_swap_b32 v137, v141
v_mfma_f32_16x16x32_bf16 v[236:239], v[88:91], a[188:191], v[236:239]
s_waitcnt lgkmcnt(2)
ds_read_b64_tr_b16 v[80:81], v2 offset:16384
v_min3_f32 v17, v128, v129, v130
v_permlane16_swap_b32 v138, v142
v_mfma_f32_16x16x32_bf16 v[252:255], v[92:95], a[188:191], v[252:255]
ds_read_b64_tr_b16 v[188:189], v26
v_max3_f32 v16, v16, v131, v132
v_permlane16_swap_b32 v139, v143
v_mfma_f32_16x16x32_bf16 v[248:251], v[92:95], a[184:187], v[248:251]
ds_read_b64_tr_b16 v[82:83], v2 offset:16896
v_min3_f32 v17, v17, v131, v132
v_permlane16_swap_b32 v152, v156
v_mfma_f32_16x16x32_bf16 v[244:247], v[92:95], a[180:183], v[244:247]
ds_read_b64_tr_b16 v[176:177], v24
v_max3_f32 v16, v16, v133, v134
v_min3_f32 v17, v17, v133, v134
v_mfma_f32_16x16x32_bf16 v[240:243], v[92:95], a[176:179], v[240:243]
ds_read_b64_tr_b16 v[84:85], v2 offset:17408
v_max3_f32 v16, v16, v135, v136
v_min3_f32 v17, v17, v135, v136
v_max3_f32 v16, v16, v137, v138
v_mfma_f32_16x16x32_bf16 v[192:195], v[64:67], a[192:195], v[192:195]
ds_read_b64_tr_b16 v[180:181], v24 offset:8
v_min3_f32 v17, v17, v137, v138
v_max3_f32 v16, v16, v139, v140
v_min3_f32 v17, v17, v139, v140
v_mfma_f32_16x16x32_bf16 v[196:199], v[64:67], a[196:199], v[196:199]
ds_read_b64_tr_b16 v[86:87], v2 offset:17920
v_max3_f32 v16, v16, v141, v142
v_min3_f32 v17, v17, v141, v142
v_max3_f32 v16, v16, v143, v144
v_mfma_f32_16x16x32_bf16 v[200:203], v[64:67], a[200:203], v[200:203]
ds_read_b64_tr_b16 v[184:185], v25 offset:64
v_min3_f32 v17, v17, v143, v144
v_max_f32 v16, v16, v148
v_mfma_f32_16x16x32_bf16 v[204:207], v[64:67], a[204:207], v[204:207]
ds_read_b64_tr_b16 v[88:89], v3 offset:16384
v_min_f32 v17, v17, v148
v_mul_f32 v16, s87, v16
v_mul_f32 v17, s88, v17
v_mfma_f32_16x16x32_bf16 v[220:223], v[68:71], a[204:207], v[220:223]
ds_read_b64_tr_b16 v[190:191], v26 offset:288
v_fma_f32 v32, v128, s87, v17
v_fma_f32 v128, v128, s88, v16
v_fma_f32 v33, v129, s87, v17
v_mfma_f32_16x16x32_bf16 v[216:219], v[68:71], a[200:203], v[216:219]
ds_read_b64_tr_b16 v[90:91], v3 offset:16896
v_fma_f32 v129, v129, s88, v16
v_fma_f32 v34, v130, s87, v17
v_fma_f32 v130, v130, s88, v16
v_mfma_f32_16x16x32_bf16 v[212:215], v[68:71], a[196:199], v[212:215]
ds_read_b64_tr_b16 v[178:179], v24 offset:320
v_fma_f32 v35, v131, s87, v17
v_fma_f32 v131, v131, s88, v16
v_fma_f32 v36, v132, s87, v17
v_mfma_f32_16x16x32_bf16 v[208:211], v[68:71], a[192:195], v[208:211]
s_add_u32 m0, s84, 0
ds_read_b64_tr_b16 v[92:93], v3 offset:17408
v_fma_f32 v132, v132, s88, v16
v_fma_f32 v37, v133, s87, v17
v_fma_f32 v133, v133, s88, v16
v_mfma_f32_16x16x32_bf16 v[224:227], v[72:75], a[192:195], v[224:227]
ds_read_b64_tr_b16 v[182:183], v24 offset:328
v_fma_f32 v38, v134, s87, v17
v_fma_f32 v134, v134, s88, v16
v_mfma_f32_16x16x32_bf16 v[228:231], v[72:75], a[196:199], v[228:231]
s_waitcnt vmcnt(6)
ds_read_b64_tr_b16 v[94:95], v3 offset:17920
v_fma_f32 v39, v135, s87, v17
v_fma_f32 v135, v135, s88, v16
v_fma_f32 v40, v136, s87, v17
v_mfma_f32_16x16x32_bf16 v[232:235], v[72:75], a[200:203], v[232:235]
s_barrier
v_fma_f32 v136, v136, s88, v16
v_fma_f32 v41, v137, s87, v17
v_mfma_f32_16x16x32_bf16 v[236:239], v[72:75], a[204:207], v[236:239]
s_add_u32 s81, s12, 295296
ds_read_b64_tr_b16 v[64:65], v2 offset:24576
v_fma_f32 v137, v137, s88, v16
v_fma_f32 v42, v138, s87, v17
v_fma_f32 v138, v138, s88, v16
s_waitcnt lgkmcnt(5)
v_mfma_f32_16x16x32_bf16 v[252:255], v[76:79], a[204:207], v[252:255]
buffer_load_dwordx4 v1, s[40:43], s81 offen lds
v_fma_f32 v43, v139, s87, v17
v_fma_f32 v139, v139, s88, v16
s_waitcnt lgkmcnt(4)
v_mfma_f32_16x16x32_bf16 v[160:163], v[176:179], v[188:191], 0
ds_read_b64_tr_b16 v[186:187], v25 offset:384
v_fma_f32 v44, v140, s87, v17
v_mfma_f32_16x16x32_bf16 v[248:251], v[76:79], a[200:203], v[248:251]
s_waitcnt lgkmcnt(3)
ds_read_b64_tr_b16 v[66:67], v2 offset:25088
v_fma_f32 v140, v140, s88, v16
v_mfma_f32_16x16x32_bf16 v[164:167], v[180:183], v[188:191], 0
ds_read_b64_tr_b16 v[28:29], v26 offset:2304
v_fma_f32 v45, v141, s87, v17
v_mfma_f32_16x16x32_bf16 v[244:247], v[76:79], a[196:199], v[244:247]
buffer_load_dwordx4 v1, s[44:47], s81 offen offset:1024 lds
v_mfma_f32_16x16x32_bf16 v[240:243], v[76:79], a[192:195], v[240:243]
ds_read_b64_tr_b16 v[68:69], v2 offset:25600
v_fma_f32 v141, v141, s88, v16
v_fma_f32 v46, v142, s87, v17
v_mfma_f32_16x16x32_bf16 v[192:195], v[80:83], a[208:211], v[192:195]
s_waitcnt lgkmcnt(3)
ds_read_b64_tr_b16 v[56:57], v24 offset:2560
v_fma_f32 v142, v142, s88, v16
v_fma_f32 v47, v143, s87, v17
v_fma_f32 v143, v143, s88, v16
v_mfma_f32_16x16x32_bf16 v[196:199], v[80:83], a[212:215], v[196:199]
s_add_u32 m0, s84, 8192
ds_read_b64_tr_b16 v[70:71], v2 offset:26112
v_fma_f32 v48, v144, s87, v17
v_fma_f32 v144, v144, s88, v16
v_fma_f32 v49, v148, s87, v17
v_mfma_f32_16x16x32_bf16 v[168:171], v[184:187], v[188:191], 0
ds_read_b64_tr_b16 v[60:61], v24 offset:2568
v_fma_f32 v148, v148, s88, v16
v_mfma_f32_16x16x32_bf16 v[200:203], v[80:83], a[216:219], v[200:203]
ds_read_b64_tr_b16 v[172:173], v25 offset:2624
v_exp_f32 v128, v128
v_mfma_f32_16x16x32_bf16 v[204:207], v[80:83], a[220:223], v[204:207]
s_add_u32 s81, s12, 590208
ds_read_b64_tr_b16 v[72:73], v3 offset:24576
v_exp_f32 v32, v32
v_mfma_f32_16x16x32_bf16 v[220:223], v[84:87], a[220:223], v[220:223]
buffer_load_dwordx4 v1, s[40:43], s81 offen lds
v_exp_f32 v129, v129
v_mfma_f32_16x16x32_bf16 v[216:219], v[84:87], a[216:219], v[216:219]
ds_read_b64_tr_b16 v[74:75], v3 offset:25088
v_add_f32 v18, v128, v129
v_exp_f32 v33, v33
v_mfma_f32_16x16x32_bf16 v[212:215], v[84:87], a[212:215], v[212:215]
ds_read_b64_tr_b16 v[30:31], v26 offset:2592
v_add_f32 v19, v32, v33
v_exp_f32 v130, v130
v_mfma_f32_16x16x32_bf16 v[208:211], v[84:87], a[208:211], v[208:211]
ds_read_b64_tr_b16 v[76:77], v3 offset:25600
v_add_f32 v18, v18, v130
v_exp_f32 v34, v34
v_mfma_f32_16x16x32_bf16 v[224:227], v[88:91], a[208:211], v[224:227]
buffer_load_dwordx4 v1, s[44:47], s81 offen offset:1024 lds
v_exp_f32 v131, v131
v_mfma_f32_16x16x32_bf16 v[228:231], v[88:91], a[212:215], v[228:231]
ds_read_b64_tr_b16 v[78:79], v3 offset:26112
v_add_f32 v19, v19, v34
v_mfma_f32_16x16x32_bf16 v[232:235], v[88:91], a[216:219], v[232:235]
ds_read_b64_tr_b16 v[58:59], v24 offset:2880
v_add_f32 v18, v18, v131
v_exp_f32 v35, v35
v_mfma_f32_16x16x32_bf16 v[236:239], v[88:91], a[220:223], v[236:239]
ds_read_b64_tr_b16 v[80:81], v2 offset:32768
v_add_f32 v19, v19, v35
v_exp_f32 v132, v132
v_mfma_f32_16x16x32_bf16 v[252:255], v[92:95], a[220:223], v[252:255]
ds_read_b64_tr_b16 v[62:63], v24 offset:2888
v_add_f32 v18, v18, v132
v_exp_f32 v36, v36
v_mfma_f32_16x16x32_bf16 v[248:251], v[92:95], a[216:219], v[248:251]
ds_read_b64_tr_b16 v[82:83], v2 offset:33280
v_add_f32 v19, v19, v36
v_exp_f32 v133, v133
v_mfma_f32_16x16x32_bf16 v[244:247], v[92:95], a[212:215], v[244:247]
ds_read_b64_tr_b16 v[174:175], v25 offset:2944
v_add_f32 v18, v18, v133
v_exp_f32 v37, v37
v_mfma_f32_16x16x32_bf16 v[240:243], v[92:95], a[208:211], v[240:243]
s_waitcnt lgkmcnt(5)
ds_read_b64_tr_b16 v[84:85], v2 offset:33792
v_add_f32 v19, v19, v37
v_exp_f32 v134, v134
v_mfma_f32_16x16x32_bf16 v[192:195], v[64:67], a[224:227], v[192:195]
s_waitcnt lgkmcnt(5)
ds_read_b64_tr_b16 v[188:189], v26 offset:4608
v_add_f32 v18, v18, v134
v_exp_f32 v38, v38
v_mfma_f32_16x16x32_bf16 v[160:163], v[56:59], v[28:31], v[160:163]
ds_read_b64_tr_b16 v[176:177], v24 offset:5120
v_add_f32 v19, v19, v38
v_mfma_f32_16x16x32_bf16 v[196:199], v[64:67], a[228:231], v[196:199]
s_waitcnt lgkmcnt(5)
ds_read_b64_tr_b16 v[86:87], v2 offset:34304
v_mfma_f32_16x16x32_bf16 v[164:167], v[60:63], v[28:31], v[164:167]
ds_read_b64_tr_b16 v[180:181], v24 offset:5128
v_mfma_f32_16x16x32_bf16 v[200:203], v[64:67], a[232:235], v[200:203]
s_waitcnt lgkmcnt(5)
ds_read_b64_tr_b16 v[184:185], v25 offset:5184
v_exp_f32 v135, v135
v_mfma_f32_16x16x32_bf16 v[168:171], v[172:175], v[28:31], v[168:171]
ds_read_b64_tr_b16 v[190:191], v26 offset:4896
v_add_f32 v18, v18, v135
v_mfma_f32_16x16x32_bf16 v[204:207], v[64:67], a[236:239], v[204:207]
ds_read_b64_tr_b16 v[88:89], v3 offset:32768
v_exp_f32 v39, v39
v_mfma_f32_16x16x32_bf16 v[220:223], v[68:71], a[236:239], v[220:223]
ds_read_b64_tr_b16 v[178:179], v24 offset:5440
v_add_f32 v19, v19, v39
v_exp_f32 v136, v136
v_mfma_f32_16x16x32_bf16 v[216:219], v[68:71], a[232:235], v[216:219]
ds_read_b64_tr_b16 v[90:91], v3 offset:33280
v_add_f32 v18, v18, v136
v_mfma_f32_16x16x32_bf16 v[212:215], v[68:71], a[228:231], v[212:215]
ds_read_b64_tr_b16 v[182:183], v24 offset:5448
v_exp_f32 v40, v40
v_exp_f32 v137, v137
v_mfma_f32_16x16x32_bf16 v[208:211], v[68:71], a[224:227], v[208:211]
s_add_u32 m0, s84, 16384
ds_read_b64_tr_b16 v[92:93], v3 offset:33792
v_add_f32 v19, v19, v40
v_exp_f32 v41, v41
v_mfma_f32_16x16x32_bf16 v[224:227], v[72:75], a[224:227], v[224:227]
ds_read_b64_tr_b16 v[186:187], v25 offset:5504
v_add_f32 v18, v18, v137
v_exp_f32 v138, v138
v_mfma_f32_16x16x32_bf16 v[228:231], v[72:75], a[228:231], v[228:231]
s_waitcnt vmcnt(6)
ds_read_b64_tr_b16 v[94:95], v3 offset:34304
v_add_f32 v19, v19, v41
v_exp_f32 v42, v42
v_mfma_f32_16x16x32_bf16 v[232:235], v[72:75], a[232:235], v[232:235]
s_barrier
v_exp_f32 v139, v139
s_waitcnt lgkmcnt(5)
v_mfma_f32_16x16x32_bf16 v[160:163], v[176:179], v[188:191], v[160:163]
s_lshl_b32 s85, s76, 1
ds_read_b64_tr_b16 v[28:29], v26 offset:6912
v_add_f32 v18, v18, v138
v_mfma_f32_16x16x32_bf16 v[236:239], v[72:75], a[236:239], v[236:239]
s_add_u32 s81, s12, 885120
ds_read_b64_tr_b16 v[64:65], v2 offset:40960
v_add_f32 v19, v19, v42
s_waitcnt lgkmcnt(5)
v_mfma_f32_16x16x32_bf16 v[164:167], v[180:183], v[188:191], v[164:167]
s_add_u32 s85, s85, s80
ds_read_b64_tr_b16 v[56:57], v24 offset:7680
v_add_f32 v18, v18, v139
v_mfma_f32_16x16x32_bf16 v[252:255], v[76:79], a[236:239], v[252:255]
buffer_load_dwordx4 v1, s[40:43], s81 offen lds
s_waitcnt lgkmcnt(4)
v_mfma_f32_16x16x32_bf16 v[168:171], v[184:187], v[188:191], v[168:171]
s_lshl_b32 s85, s85, 4
ds_read_b64_tr_b16 v[60:61], v24 offset:7688
v_lshlrev_b32 v5, 4, v0
v_mfma_f32_16x16x32_bf16 v[248:251], v[76:79], a[232:235], v[248:251]
s_add_u32 s85, s85, s77
ds_read_b64_tr_b16 v[66:67], v2 offset:41472
v_and_b32 v6, 15, v0
v_mfma_f32_16x16x32_bf16 v[244:247], v[76:79], a[228:231], v[244:247]
buffer_load_dwordx4 v1, s[44:47], s81 offen offset:1024 lds
v_mfma_f32_16x16x32_bf16 v[240:243], v[76:79], a[224:227], v[240:243]
s_mul_i32 s85, s85, 1536
ds_read_b64_tr_b16 v[68:69], v2 offset:41984
v_lshrrev_b32 v7, 4, v0
v_exp_f32 v43, v43
v_mfma_f32_16x16x32_bf16 v[192:195], v[80:83], a[240:243], v[192:195]
s_mov_b32 s91, 2146435072
ds_read_b64_tr_b16 v[172:173], v25 offset:7744
v_cmp_gt_u32 vcc, 3, v6
v_exp_f32 v140, v140
v_mfma_f32_16x16x32_bf16 v[196:199], v[80:83], a[244:247], v[196:199]
s_add_u32 m0, s84, 24576
ds_read_b64_tr_b16 v[70:71], v2 offset:42496
v_mul_u32_u24 v7, 3, v7
v_exp_f32 v44, v44
v_mfma_f32_16x16x32_bf16 v[200:203], v[80:83], a[248:251], v[200:203]
s_cmp_eq_u32 s79, 1
s_cselect_b64 s[94:95], -1, 0
ds_read_b64_tr_b16 v[30:31], v26 offset:7200
v_add_u32 v6, v6, v7
v_add_f32 v19, v19, v43
v_mfma_f32_16x16x32_bf16 v[204:207], v[80:83], a[252:255], v[204:207]
s_add_u32 s81, s12, 1180032
ds_read_b64_tr_b16 v[72:73], v3 offset:40960
v_lshlrev_b32 v6, 4, v6
v_exp_f32 v141, v141
v_mfma_f32_16x16x32_bf16 v[220:223], v[84:87], a[252:255], v[220:223]
buffer_load_dwordx4 v1, s[40:43], s81 offen lds
v_exp_f32 v45, v45
v_mfma_f32_16x16x32_bf16 v[216:219], v[84:87], a[248:251], v[216:219]
ds_read_b64_tr_b16 v[74:75], v3 offset:41472
v_add_u32 v6, 1280, v6
v_add_f32 v18, v18, v140
v_add_f32 v19, v19, v44
v_mfma_f32_16x16x32_bf16 v[212:215], v[84:87], a[244:247], v[212:215]
ds_read_b64_tr_b16 v[58:59], v24 offset:8000
v_mov_b32 v7, s91
v_exp_f32 v142, v142
v_mfma_f32_16x16x32_bf16 v[208:211], v[84:87], a[240:243], v[208:211]
ds_read_b64_tr_b16 v[76:77], v3 offset:41984
v_cndmask_b32 v6, v7, v6, vcc
v_exp_f32 v46, v46
v_mfma_f32_16x16x32_bf16 v[224:227], v[88:91], a[240:243], v[224:227]
buffer_load_dwordx4 v1, s[44:47], s81 offen offset:1024 lds
v_add_f32 v18, v18, v141
v_mfma_f32_16x16x32_bf16 v[228:231], v[88:91], a[244:247], v[228:231]
ds_read_b64_tr_b16 v[78:79], v3 offset:42496
v_cmp_gt_u32 vcc, 16, v0
v_add_f32 v19, v19, v45
v_exp_f32 v143, v143
v_mfma_f32_16x16x32_bf16 v[232:235], v[88:91], a[248:251], v[232:235]
ds_read_b64_tr_b16 v[62:63], v24 offset:8008
v_cndmask_b32 v24, v5, v6, s[94:95]
v_exp_f32 v47, v47
v_mfma_f32_16x16x32_bf16 v[236:239], v[88:91], a[252:255], v[236:239]
s_waitcnt lgkmcnt(4)
ds_read_b64_tr_b16 v[80:81], v2 offset:49152
v_add_u32 v5, 1024, v5
v_add_f32 v18, v18, v142
v_mfma_f32_16x16x32_bf16 v[252:255], v[92:95], a[252:255], v[252:255]
s_waitcnt lgkmcnt(4)
ds_read_b64_tr_b16 v[174:175], v25 offset:8064
v_add_u32 v6, 192, v6
v_add_f32 v19, v19, v46
v_mfma_f32_16x16x32_bf16 v[160:163], v[56:59], v[28:31], v[160:163]
v_cndmask_b32 v5, v5, v6, s[94:95]
v_cndmask_b32 v25, v7, v5, vcc
v_mfma_f32_16x16x32_bf16 v[248:251], v[92:95], a[248:251], v[248:251]
ds_read_b64_tr_b16 v[82:83], v2 offset:49664
v_add_f32 v18, v18, v143
v_mfma_f32_16x16x32_bf16 v[244:247], v[92:95], a[244:247], v[244:247]
v_exp_f32 v144, v144
v_exp_f32 v48, v48
v_mfma_f32_16x16x32_bf16 v[240:243], v[92:95], a[240:243], v[240:243]
s_waitcnt lgkmcnt(3)
ds_read_b64_tr_b16 v[84:85], v2 offset:50176
v_add_f32 v19, v19, v47
v_exp_f32 v148, v148
v_mfma_f32_16x16x32_bf16 v[164:167], v[60:63], v[28:31], v[164:167]
v_exp_f32 v49, v49
v_mfma_f32_16x16x32_bf16 v[192:195], v[64:67], v[96:99], v[192:195]
s_waitcnt lgkmcnt(2)
v_add_f32 v18, v18, v144
v_add_f32 v19, v19, v48
v_mfma_f32_16x16x32_bf16 v[168:171], v[172:175], v[28:31], v[168:171]
v_cvt_pk_bf16_f32 v28, v160, v161
v_cvt_pk_bf16_f32 v29, v162, v163
v_mfma_f32_16x16x32_bf16 v[196:199], v[64:67], v[100:103], v[196:199]
ds_read_b64_tr_b16 v[86:87], v2 offset:50688
v_add_f32 v18, v18, v148
v_mfma_f32_16x16x32_bf16 v[200:203], v[64:67], v[104:107], v[200:203]
v_cvt_pk_bf16_f32 v30, v164, v165
v_cvt_pk_bf16_f32 v31, v166, v167
v_add_f32 v19, v19, v49
v_mfma_f32_16x16x32_bf16 v[204:207], v[64:67], v[108:111], v[204:207]
ds_read_b64_tr_b16 v[88:89], v3 offset:49152
v_rcp_f32 v18, v18
v_rcp_f32 v19, v19
v_mfma_f32_16x16x32_bf16 v[220:223], v[68:71], v[108:111], v[220:223]
v_cvt_pk_bf16_f32 v172, v168, v169
v_cvt_pk_bf16_f32 v173, v170, v171
v_mul_f32 v128, v128, v18
v_mfma_f32_16x16x32_bf16 v[216:219], v[68:71], v[104:107], v[216:219]
ds_read_b64_tr_b16 v[90:91], v3 offset:49664
v_cvt_pk_bf16_f32 v174, v168, v169
v_mul_f32 v32, v32, v19
v_mul_f32 v129, v129, v18
v_mfma_f32_16x16x32_bf16 v[212:215], v[68:71], v[100:103], v[212:215]
v_cvt_pk_bf16_f32 v175, v170, v171
v_mul_f32 v33, v33, v19
v_mul_f32 v130, v130, v18
v_mul_f32 v34, v34, v19
v_mfma_f32_16x16x32_bf16 v[208:211], v[68:71], v[96:99], v[208:211]
s_add_u32 m0, s84, 32768
ds_read_b64_tr_b16 v[92:93], v3 offset:50176
v_mul_f32 v131, v131, v18
v_mul_f32 v35, v35, v19
v_mul_f32 v132, v132, v18
v_mfma_f32_16x16x32_bf16 v[224:227], v[72:75], v[96:99], v[224:227]
buffer_store_dwordx4 v[28:31], v24, s[64:67], s85 offen sc1
v_mul_f32 v36, v36, v19
v_mfma_f32_16x16x32_bf16 v[228:231], v[72:75], v[100:103], v[228:231]
s_waitcnt vmcnt(7)
ds_read_b64_tr_b16 v[94:95], v3 offset:50688
v_mul_f32 v133, v133, v18
v_mul_f32 v37, v37, v19
v_mul_f32 v134, v134, v18
v_mfma_f32_16x16x32_bf16 v[232:235], v[72:75], v[104:107], v[232:235]
s_barrier
v_mul_f32 v38, v38, v19
v_mul_f32 v135, v135, v18
v_mfma_f32_16x16x32_bf16 v[236:239], v[72:75], v[108:111], v[236:239]
s_add_u32 s81, s12, 1474944
ds_read_b64_tr_b16 v[64:65], v2 offset:57344
v_mul_f32 v39, v39, v19
v_mul_f32 v136, v136, v18
v_mul_f32 v40, v40, v19
v_mfma_f32_16x16x32_bf16 v[252:255], v[76:79], v[108:111], v[252:255]
buffer_load_dwordx4 v1, s[40:43], s81 offen lds
v_mul_f32 v137, v137, v18
v_mul_f32 v41, v41, v19
v_mfma_f32_16x16x32_bf16 v[248:251], v[76:79], v[104:107], v[248:251]
ds_read_b64_tr_b16 v[66:67], v2 offset:57856
v_mul_f32 v138, v138, v18
v_mul_f32 v42, v42, v19
v_mul_f32 v139, v139, v18
v_mfma_f32_16x16x32_bf16 v[244:247], v[76:79], v[100:103], v[244:247]
buffer_load_dwordx4 v1, s[44:47], s81 offen offset:1024 lds
v_mul_f32 v43, v43, v19
v_mfma_f32_16x16x32_bf16 v[240:243], v[76:79], v[96:99], v[240:243]
s_waitcnt lgkmcnt(2)
ds_read_b64_tr_b16 v[68:69], v2 offset:58368
v_mul_f32 v140, v140, v18
v_mul_f32 v44, v44, v19
v_mul_f32 v141, v141, v18
v_mfma_f32_16x16x32_bf16 v[192:195], v[80:83], v[112:115], v[192:195]
buffer_store_dwordx4 v[172:175], v25, s[64:67], s85 offen sc1
v_mul_f32 v45, v45, v19
v_mul_f32 v142, v142, v18
v_mfma_f32_16x16x32_bf16 v[196:199], v[80:83], v[116:119], v[196:199]
s_add_u32 m0, s84, 40960
ds_read_b64_tr_b16 v[70:71], v2 offset:58880
v_mul_f32 v46, v46, v19
v_mul_f32 v143, v143, v18
v_mul_f32 v47, v47, v19
v_mfma_f32_16x16x32_bf16 v[200:203], v[80:83], v[120:123], v[200:203]
v_mul_f32 v144, v144, v18
v_mul_f32 v48, v48, v19
v_mul_f32 v148, v148, v18
v_mul_f32 v49, v49, v19
v_mfma_f32_16x16x32_bf16 v[204:207], v[80:83], v[124:127], v[204:207]
s_add_u32 s81, s12, 1769856
ds_read_b64_tr_b16 v[72:73], v3 offset:57344
v_cvt_pk_bf16_f32 v52, v144, v148
v_cvt_pk_bf16_f32 v152, v128, v129
v_cvt_pk_bf16_f32 v153, v130, v131
v_mfma_f32_16x16x32_bf16 v[220:223], v[84:87], v[124:127], v[220:223]
buffer_load_dwordx4 v1, s[40:43], s81 offen lds
v_cvt_pk_bf16_f32 v154, v132, v133
v_mfma_f32_16x16x32_bf16 v[216:219], v[84:87], v[120:123], v[216:219]
s_mul_i32 s98, s78, 5120
ds_read_b64_tr_b16 v[74:75], v3 offset:57856
v_cvt_pk_bf16_f32 v155, v134, v135
v_cvt_pk_bf16_f32 v156, v136, v137
v_cvt_pk_bf16_f32 v157, v138, v139
v_mfma_f32_16x16x32_bf16 v[212:215], v[84:87], v[116:119], v[212:215]
s_add_u32 s98, s98, 139264
v_cvt_pk_bf16_f32 v158, v140, v141
v_cvt_pk_bf16_f32 v159, v142, v143
v_cvt_pk_bf16_f32 v53, v32, v33
v_cvt_pk_bf16_f32 v54, v34, v35
v_mfma_f32_16x16x32_bf16 v[208:211], v[84:87], v[112:115], v[208:211]
ds_read_b64_tr_b16 v[76:77], v3 offset:58368
v_cvt_pk_bf16_f32 v55, v36, v37
v_cvt_pk_bf16_f32 v144, v38, v39
v_cvt_pk_bf16_f32 v145, v40, v41
v_mfma_f32_16x16x32_bf16 v[224:227], v[88:91], v[112:115], v[224:227]
buffer_load_dwordx4 v1, s[44:47], s81 offen offset:1024 lds
v_cvt_pk_bf16_f32 v146, v42, v43
v_cvt_pk_bf16_f32 v147, v44, v45
v_mfma_f32_16x16x32_bf16 v[228:231], v[88:91], v[116:119], v[228:231]
ds_read_b64_tr_b16 v[78:79], v3 offset:58880
v_cvt_pk_bf16_f32 v148, v46, v47
v_cvt_pk_bf16_f32 v149, v48, v49
v_mul_u32_u24 v21, 80, v0
v_mfma_f32_16x16x32_bf16 v[232:235], v[88:91], v[120:123], v[232:235]
v_add_u32 v21, s98, v21
v_mfma_f32_16x16x32_bf16 v[236:239], v[88:91], v[124:127], v[236:239]
ds_read_b64_tr_b16 v[80:81], v2
v_mfma_f32_16x16x32_bf16 v[252:255], v[92:95], v[124:127], v[252:255]
ds_write_b64 v21, v[152:153]
v_mfma_f32_16x16x32_bf16 v[248:251], v[92:95], v[120:123], v[248:251]
ds_read_b64_tr_b16 v[82:83], v2 offset:512
v_mfma_f32_16x16x32_bf16 v[244:247], v[92:95], v[116:119], v[244:247]
ds_write_b64 v21, v[154:155] offset:8
v_mfma_f32_16x16x32_bf16 v[240:243], v[92:95], v[112:115], v[240:243]
s_waitcnt lgkmcnt(4)
ds_read_b64_tr_b16 v[84:85], v2 offset:1024
ds_write_b64 v21, v[156:157] offset:16
ds_write_b64 v21, v[158:159] offset:24
ds_write_b64 v21, v[52:53] offset:32
ds_write_b64 v21, v[54:55] offset:40
ds_write_b64 v21, v[144:145] offset:48
ds_write_b64 v21, v[146:147] offset:56
ds_write_b64 v21, v[148:149] offset:64
v_mfma_f32_16x16x32_bf16 v[128:131], v[64:67], a[0:3], 0
v_mfma_f32_16x16x32_bf16 v[132:135], v[64:67], a[4:7], 0
ds_read_b64_tr_b16 v[86:87], v2 offset:1536
v_mfma_f32_16x16x32_bf16 v[136:139], v[64:67], a[8:11], 0
v_mfma_f32_16x16x32_bf16 v[140:143], v[64:67], a[12:15], 0
ds_read_b64_tr_b16 v[88:89], v3
v_mfma_f32_16x16x32_bf16 v[156:159], v[68:71], a[12:15], 0
v_mul_f32 v16, s87, v192
v_mul_f32 v17, s87, v193
v_mfma_f32_16x16x32_bf16 v[152:155], v[68:71], a[8:11], 0
ds_read_b64_tr_b16 v[90:91], v3 offset:512
v_mul_f32 v18, s87, v194
v_mfma_f32_16x16x32_bf16 v[148:151], v[68:71], a[4:7], 0
v_mul_f32 v19, s87, v195
v_mul_f32 v192, v192, v208
v_mfma_f32_16x16x32_bf16 v[144:147], v[68:71], a[0:3], 0
s_add_u32 m0, s84, 49152
ds_read_b64_tr_b16 v[92:93], v3 offset:1024
v_mul_f32 v193, v193, v209
v_mfma_f32_16x16x32_bf16 v[160:163], v[72:75], a[0:3], 0
v_exp_f32 v16, v16
v_mfma_f32_16x16x32_bf16 v[164:167], v[72:75], a[4:7], 0
s_waitcnt vmcnt(8)
ds_read_b64_tr_b16 v[94:95], v3 offset:1536
v_mul_f32 v194, v194, v210
v_mfma_f32_16x16x32_bf16 v[168:171], v[72:75], a[8:11], 0
s_barrier
v_mfma_f32_16x16x32_bf16 v[172:175], v[72:75], a[12:15], 0
s_add_u32 s81, s12, 2064768
ds_read_b64_tr_b16 v[64:65], v2 offset:8192
v_mul_f32 v195, v195, v211
v_mfma_f32_16x16x32_bf16 v[188:191], v[76:79], a[12:15], 0
buffer_load_dwordx4 v1, s[40:43], s81 offen lds
v_mfma_f32_16x16x32_bf16 v[184:187], v[76:79], a[8:11], 0
ds_read_b64_tr_b16 v[66:67], v2 offset:8704
v_add_f32 v16, 1.0, v16
v_mfma_f32_16x16x32_bf16 v[180:183], v[76:79], a[4:7], 0
buffer_load_dwordx4 v1, s[44:47], s81 offen offset:1024 lds
v_mfma_f32_16x16x32_bf16 v[176:179], v[76:79], a[0:3], 0
s_waitcnt lgkmcnt(2)
ds_read_b64_tr_b16 v[68:69], v2 offset:9216
v_mfma_f32_16x16x32_bf16 v[128:131], v[80:83], a[16:19], v[128:131]
v_exp_f32 v17, v17
v_mfma_f32_16x16x32_bf16 v[132:135], v[80:83], a[20:23], v[132:135]
s_add_u32 m0, s84, 57344
ds_read_b64_tr_b16 v[70:71], v2 offset:9728
v_add_f32 v17, 1.0, v17
v_mfma_f32_16x16x32_bf16 v[136:139], v[80:83], a[24:27], v[136:139]
v_exp_f32 v18, v18
v_mfma_f32_16x16x32_bf16 v[140:143], v[80:83], a[28:31], v[140:143]
s_add_u32 s81, s12, 2359680
ds_read_b64_tr_b16 v[72:73], v3 offset:8192
v_add_f32 v18, 1.0, v18
v_mfma_f32_16x16x32_bf16 v[156:159], v[84:87], a[28:31], v[156:159]
buffer_load_dwordx4 v1, s[40:43], s81 offen lds
v_mfma_f32_16x16x32_bf16 v[152:155], v[84:87], a[24:27], v[152:155]
ds_read_b64_tr_b16 v[74:75], v3 offset:8704
v_mul_f32 v20, s87, v224
v_mfma_f32_16x16x32_bf16 v[148:151], v[84:87], a[20:23], v[148:151]
v_exp_f32 v19, v19
v_mfma_f32_16x16x32_bf16 v[144:147], v[84:87], a[16:19], v[144:147]
ds_read_b64_tr_b16 v[76:77], v3 offset:9216
v_add_f32 v19, 1.0, v19
v_mfma_f32_16x16x32_bf16 v[160:163], v[88:91], a[16:19], v[160:163]
buffer_load_dwordx4 v1, s[44:47], s81 offen offset:1024 lds
v_mfma_f32_16x16x32_bf16 v[164:167], v[88:91], a[20:23], v[164:167]
ds_read_b64_tr_b16 v[78:79], v3 offset:9728
v_mul_f32 v21, s87, v225
v_mfma_f32_16x16x32_bf16 v[168:171], v[88:91], a[24:27], v[168:171]
v_rcp_f32 v16, v16
v_mfma_f32_16x16x32_bf16 v[172:175], v[88:91], a[28:31], v[172:175]
ds_read_b64_tr_b16 v[80:81], v2 offset:16384
v_mul_f32 v192, v192, v16
v_mfma_f32_16x16x32_bf16 v[188:191], v[92:95], a[28:31], v[188:191]
v_rcp_f32 v17, v17
v_mfma_f32_16x16x32_bf16 v[184:187], v[92:95], a[24:27], v[184:187]
ds_read_b64_tr_b16 v[82:83], v2 offset:16896
v_mul_f32 v193, v193, v17
v_mfma_f32_16x16x32_bf16 v[180:183], v[92:95], a[20:23], v[180:183]
v_rcp_f32 v18, v18
v_mfma_f32_16x16x32_bf16 v[176:179], v[92:95], a[16:19], v[176:179]
s_waitcnt lgkmcnt(2)
ds_read_b64_tr_b16 v[84:85], v2 offset:17408
v_mul_f32 v194, v194, v18
v_mfma_f32_16x16x32_bf16 v[128:131], v[64:67], a[32:35], v[128:131]
v_rcp_f32 v19, v19
v_mfma_f32_16x16x32_bf16 v[132:135], v[64:67], a[36:39], v[132:135]
ds_read_b64_tr_b16 v[86:87], v2 offset:17920
v_mul_f32 v195, v195, v19
v_mfma_f32_16x16x32_bf16 v[136:139], v[64:67], a[40:43], v[136:139]
v_cvt_pk_bf16_f32 v24, v192, v193
v_cvt_pk_bf16_f32 v25, v194, v195
v_mfma_f32_16x16x32_bf16 v[140:143], v[64:67], a[44:47], v[140:143]
ds_read_b64_tr_b16 v[88:89], v3 offset:16384
v_mul_f32 v22, s87, v226
v_mfma_f32_16x16x32_bf16 v[156:159], v[68:71], a[44:47], v[156:159]
ds_write_b64 v4, v[24:25] offset:32768
v_mfma_f32_16x16x32_bf16 v[152:155], v[68:71], a[40:43], v[152:155]
ds_read_b64_tr_b16 v[90:91], v3 offset:16896
v_mul_f32 v23, s87, v227
v_mfma_f32_16x16x32_bf16 v[148:151], v[68:71], a[36:39], v[148:151]
v_exp_f32 v20, v20
v_mfma_f32_16x16x32_bf16 v[144:147], v[68:71], a[32:35], v[144:147]
s_add_u32 m0, s84, 0
ds_read_b64_tr_b16 v[92:93], v3 offset:17408
v_mul_f32 v224, v224, v240
v_mfma_f32_16x16x32_bf16 v[160:163], v[72:75], a[32:35], v[160:163]
v_exp_f32 v21, v21
v_mfma_f32_16x16x32_bf16 v[164:167], v[72:75], a[36:39], v[164:167]
s_waitcnt vmcnt(6)
ds_read_b64_tr_b16 v[94:95], v3 offset:17920
v_mul_f32 v225, v225, v241
v_mfma_f32_16x16x32_bf16 v[168:171], v[72:75], a[40:43], v[168:171]
s_barrier
v_mfma_f32_16x16x32_bf16 v[172:175], v[72:75], a[44:47], v[172:175]
s_add_u32 s81, s12, 2654592
ds_read_b64_tr_b16 v[64:65], v2 offset:24576
v_cmp_eq_u32 vcc, 0, v0
v_mfma_f32_16x16x32_bf16 v[188:191], v[76:79], a[44:47], v[188:191]
buffer_load_dwordx4 v1, s[40:43], s81 offen lds
v_mfma_f32_16x16x32_bf16 v[184:187], v[76:79], a[40:43], v[184:187]
s_lshl_b32 s85, s76, 4
ds_read_b64_tr_b16 v[66:67], v2 offset:25088
v_lshrrev_b32 v7, 5, v0
v_mfma_f32_16x16x32_bf16 v[180:183], v[76:79], a[36:39], v[180:183]
buffer_load_dwordx4 v1, s[44:47], s81 offen offset:1024 lds
v_mfma_f32_16x16x32_bf16 v[176:179], v[76:79], a[32:35], v[176:179]
s_mov_b32 s86, 2146435072
ds_read_b64_tr_b16 v[68:69], v2 offset:25600
v_mov_b32 v5, s86
s_waitcnt lgkmcnt(3)
v_mfma_f32_16x16x32_bf16 v[128:131], v[80:83], a[48:51], v[128:131]
s_cmp_eq_u32 s78, 0
s_cselect_b32 s85, s85, s86
v_mov_b32 v6, s85
v_cndmask_b32 v5, v5, v6, vcc
v_mfma_f32_16x16x32_bf16 v[132:135], v[80:83], a[52:55], v[132:135]
s_add_u32 m0, s84, 8192
ds_read_b64_tr_b16 v[70:71], v2 offset:26112
v_mov_b32 v6, 1
v_mfma_f32_16x16x32_bf16 v[136:139], v[80:83], a[56:59], v[136:139]
s_lshl_b32 s85, s80, 4
buffer_atomic_add v6, v5, s[68:71], 0 offen
v_mfma_f32_16x16x32_bf16 v[140:143], v[80:83], a[60:63], v[140:143]
s_add_u32 s81, s13, 2949504
ds_read_b64_tr_b16 v[72:73], v3 offset:24576
v_lshrrev_b32 v5, 2, v0
v_mfma_f32_16x16x32_bf16 v[156:159], v[84:87], a[60:63], v[156:159]
buffer_load_dwordx4 v1, s[40:43], s81 offen lds
v_mfma_f32_16x16x32_bf16 v[152:155], v[84:87], a[56:59], v[152:155]
ds_read_b64_tr_b16 v[74:75], v3 offset:25088
v_add_u32 v5, s85, v5
v_mfma_f32_16x16x32_bf16 v[148:151], v[84:87], a[52:55], v[148:151]
v_mul_u32_u24 v5, 9216, v5
v_bfe_u32 v6, v0, 1, 1
v_mfma_f32_16x16x32_bf16 v[144:147], v[84:87], a[48:51], v[144:147]
ds_read_b64_tr_b16 v[76:77], v3 offset:25600
v_xor_b32 v6, v6, v7
v_mfma_f32_16x16x32_bf16 v[160:163], v[88:91], a[48:51], v[160:163]
buffer_load_dwordx4 v1, s[44:47], s81 offen offset:1024 lds
v_mfma_f32_16x16x32_bf16 v[164:167], v[88:91], a[52:55], v[164:167]
ds_read_b64_tr_b16 v[78:79], v3 offset:26112
v_lshl_add_u32 v5, v6, 5, v5
v_mfma_f32_16x16x32_bf16 v[168:171], v[88:91], a[56:59], v[168:171]
s_lshl_b32 s85, s79, 12
v_and_b32 v6, 1, v0
v_lshl_add_u32 v8, v6, 4, v5
v_mfma_f32_16x16x32_bf16 v[172:175], v[88:91], a[60:63], v[172:175]
s_lshl_b32 s86, s80, 3
ds_read_b64_tr_b16 v[80:81], v2 offset:32768
v_add_u32 v9, 293888, v8
v_mfma_f32_16x16x32_bf16 v[188:191], v[92:95], a[60:63], v[188:191]
s_add_u32 s85, s85, s86
v_lshrrev_b32 v5, 5, v0
v_lshlrev_b32 v5, 11, v5
v_mfma_f32_16x16x32_bf16 v[184:187], v[92:95], a[56:59], v[184:187]
s_add_u32 s85, s85, 65536
ds_read_b64_tr_b16 v[82:83], v2 offset:33280
v_bfe_u32 v6, v0, 4, 1
v_mfma_f32_16x16x32_bf16 v[180:183], v[92:95], a[52:55], v[180:183]
v_lshl_add_u32 v5, v6, 9, v5
v_xor_b32 v6, s80, v6
v_mfma_f32_16x16x32_bf16 v[176:179], v[92:95], a[48:51], v[176:179]
s_waitcnt lgkmcnt(2)
ds_read_b64_tr_b16 v[84:85], v2 offset:33792
v_lshl_add_u32 v5, v6, 5, v5
v_mfma_f32_16x16x32_bf16 v[128:131], v[64:67], a[64:67], v[128:131]
v_bfe_u32 v6, v0, 2, 2
v_lshl_add_u32 v5, v6, 6, v5
v_mfma_f32_16x16x32_bf16 v[132:135], v[64:67], a[68:71], v[132:135]
ds_read_b64_tr_b16 v[86:87], v2 offset:34304
v_and_b32 v6, 3, v0
v_mfma_f32_16x16x32_bf16 v[136:139], v[64:67], a[72:75], v[136:139]
v_lshl_add_u32 v5, v6, 3, v5
v_add_u32 v10, 73728, v5
v_mfma_f32_16x16x32_bf16 v[140:143], v[64:67], a[76:79], v[140:143]
ds_read_b64_tr_b16 v[88:89], v3 offset:32768
v_lshlrev_b32 v5, 4, v0
v_mfma_f32_16x16x32_bf16 v[156:159], v[68:71], a[76:79], v[156:159]
v_add_u32 v11, s85, v5
v_mul_f32 v226, v226, v242
v_mfma_f32_16x16x32_bf16 v[152:155], v[68:71], a[72:75], v[152:155]
ds_read_b64_tr_b16 v[90:91], v3 offset:33280
v_mul_f32 v227, v227, v243
v_mfma_f32_16x16x32_bf16 v[148:151], v[68:71], a[68:71], v[148:151]
v_exp_f32 v22, v22
v_mfma_f32_16x16x32_bf16 v[144:147], v[68:71], a[64:67], v[144:147]
s_add_u32 m0, s84, 16384
ds_read_b64_tr_b16 v[92:93], v3 offset:33792
v_add_f32 v20, 1.0, v20
v_mfma_f32_16x16x32_bf16 v[160:163], v[72:75], a[64:67], v[160:163]
v_exp_f32 v23, v23
v_mfma_f32_16x16x32_bf16 v[164:167], v[72:75], a[68:71], v[164:167]
s_waitcnt vmcnt(7)
ds_read_b64_tr_b16 v[94:95], v3 offset:34304
v_add_f32 v21, 1.0, v21
v_mfma_f32_16x16x32_bf16 v[168:171], v[72:75], a[72:75], v[168:171]
s_barrier
v_mfma_f32_16x16x32_bf16 v[172:175], v[72:75], a[76:79], v[172:175]
s_add_u32 s81, s13, 3244416
ds_read_b64_tr_b16 v[64:65], v2 offset:40960
v_add_f32 v22, 1.0, v22
v_mfma_f32_16x16x32_bf16 v[188:191], v[76:79], a[76:79], v[188:191]
buffer_load_dwordx4 v1, s[40:43], s81 offen lds
v_mfma_f32_16x16x32_bf16 v[184:187], v[76:79], a[72:75], v[184:187]
ds_read_b64_tr_b16 v[66:67], v2 offset:41472
v_add_f32 v23, 1.0, v23
v_mfma_f32_16x16x32_bf16 v[180:183], v[76:79], a[68:71], v[180:183]
buffer_load_dwordx4 v1, s[44:47], s81 offen offset:1024 lds
v_mfma_f32_16x16x32_bf16 v[176:179], v[76:79], a[64:67], v[176:179]
s_waitcnt lgkmcnt(2)
ds_read_b64_tr_b16 v[68:69], v2 offset:41984
v_mul_f32 v16, s87, v196
v_mfma_f32_16x16x32_bf16 v[128:131], v[80:83], a[80:83], v[128:131]
v_rcp_f32 v20, v20
v_mfma_f32_16x16x32_bf16 v[132:135], v[80:83], a[84:87], v[132:135]
s_add_u32 m0, s84, 24576
ds_read_b64_tr_b16 v[70:71], v2 offset:42496
v_mul_f32 v224, v224, v20
v_mfma_f32_16x16x32_bf16 v[136:139], v[80:83], a[88:91], v[136:139]
v_rcp_f32 v21, v21
v_mfma_f32_16x16x32_bf16 v[140:143], v[80:83], a[92:95], v[140:143]
s_add_u32 s81, s13, 3539328
ds_read_b64_tr_b16 v[72:73], v3 offset:40960
v_mul_f32 v225, v225, v21
v_mfma_f32_16x16x32_bf16 v[156:159], v[84:87], a[92:95], v[156:159]
buffer_load_dwordx4 v1, s[40:43], s81 offen lds
v_mfma_f32_16x16x32_bf16 v[152:155], v[84:87], a[88:91], v[152:155]
ds_read_b64_tr_b16 v[74:75], v3 offset:41472
v_cvt_pk_bf16_f32 v26, v224, v225
v_mfma_f32_16x16x32_bf16 v[148:151], v[84:87], a[84:87], v[148:151]
v_rcp_f32 v22, v22
v_mfma_f32_16x16x32_bf16 v[144:147], v[84:87], a[80:83], v[144:147]
ds_read_b64_tr_b16 v[76:77], v3 offset:41984
v_mul_f32 v226, v226, v22
v_mfma_f32_16x16x32_bf16 v[160:163], v[88:91], a[80:83], v[160:163]
buffer_load_dwordx4 v1, s[44:47], s81 offen offset:1024 lds
v_mfma_f32_16x16x32_bf16 v[164:167], v[88:91], a[84:87], v[164:167]
ds_read_b64_tr_b16 v[78:79], v3 offset:42496
v_mul_f32 v17, s87, v197
v_mfma_f32_16x16x32_bf16 v[168:171], v[88:91], a[88:91], v[168:171]
v_rcp_f32 v23, v23
v_mfma_f32_16x16x32_bf16 v[172:175], v[88:91], a[92:95], v[172:175]
ds_read_b64_tr_b16 v[80:81], v2 offset:49152
v_mul_f32 v227, v227, v23
v_mfma_f32_16x16x32_bf16 v[188:191], v[92:95], a[92:95], v[188:191]
v_cvt_pk_bf16_f32 v27, v226, v227
v_mul_f32 v18, s87, v198
v_mfma_f32_16x16x32_bf16 v[184:187], v[92:95], a[88:91], v[184:187]
ds_read_b64_tr_b16 v[82:83], v2 offset:49664
v_mul_f32 v19, s87, v199
v_mfma_f32_16x16x32_bf16 v[180:183], v[92:95], a[84:87], v[180:183]
ds_write_b64 v4, v[26:27] offset:32776
v_mfma_f32_16x16x32_bf16 v[176:179], v[92:95], a[80:83], v[176:179]
s_waitcnt lgkmcnt(3)
ds_read_b64_tr_b16 v[84:85], v2 offset:50176
v_mul_f32 v196, v196, v212
v_mfma_f32_16x16x32_bf16 v[128:131], v[64:67], a[96:99], v[128:131]
v_exp_f32 v16, v16
v_mfma_f32_16x16x32_bf16 v[132:135], v[64:67], a[100:103], v[132:135]
ds_read_b64_tr_b16 v[86:87], v2 offset:50688
v_mul_f32 v197, v197, v213
v_mfma_f32_16x16x32_bf16 v[136:139], v[64:67], a[104:107], v[136:139]
v_exp_f32 v17, v17
v_mfma_f32_16x16x32_bf16 v[140:143], v[64:67], a[108:111], v[140:143]
ds_read_b64_tr_b16 v[88:89], v3 offset:49152
v_mul_f32 v198, v198, v214
v_mfma_f32_16x16x32_bf16 v[156:159], v[68:71], a[108:111], v[156:159]
v_exp_f32 v18, v18
v_mfma_f32_16x16x32_bf16 v[152:155], v[68:71], a[104:107], v[152:155]
ds_read_b64_tr_b16 v[90:91], v3 offset:49664
v_mul_f32 v199, v199, v215
v_mfma_f32_16x16x32_bf16 v[148:151], v[68:71], a[100:103], v[148:151]
v_exp_f32 v19, v19
v_mfma_f32_16x16x32_bf16 v[144:147], v[68:71], a[96:99], v[144:147]
s_add_u32 m0, s84, 32768
ds_read_b64_tr_b16 v[92:93], v3 offset:50176
v_add_f32 v16, 1.0, v16
v_mfma_f32_16x16x32_bf16 v[160:163], v[72:75], a[96:99], v[160:163]
v_add_f32 v17, 1.0, v17
v_add_f32 v18, 1.0, v18
v_mfma_f32_16x16x32_bf16 v[164:167], v[72:75], a[100:103], v[164:167]
s_waitcnt vmcnt(7)
ds_read_b64_tr_b16 v[94:95], v3 offset:50688
v_add_f32 v19, 1.0, v19
v_mfma_f32_16x16x32_bf16 v[168:171], v[72:75], a[104:107], v[168:171]
s_barrier
v_mfma_f32_16x16x32_bf16 v[172:175], v[72:75], a[108:111], v[172:175]
s_add_u32 s81, s13, 3834240
ds_read_b64_tr_b16 v[64:65], v2 offset:57344
v_mul_f32 v20, s87, v228
v_mfma_f32_16x16x32_bf16 v[188:191], v[76:79], a[108:111], v[188:191]
buffer_load_dwordx4 v1, s[40:43], s81 offen lds
v_mfma_f32_16x16x32_bf16 v[184:187], v[76:79], a[104:107], v[184:187]
ds_read_b64_tr_b16 v[66:67], v2 offset:57856
v_mul_f32 v21, s87, v229
v_mfma_f32_16x16x32_bf16 v[180:183], v[76:79], a[100:103], v[180:183]
buffer_load_dwordx4 v1, s[44:47], s81 offen offset:1024 lds
v_mfma_f32_16x16x32_bf16 v[176:179], v[76:79], a[96:99], v[176:179]
s_waitcnt lgkmcnt(2)
ds_read_b64_tr_b16 v[68:69], v2 offset:58368
v_mul_f32 v22, s87, v230
v_mfma_f32_16x16x32_bf16 v[128:131], v[80:83], a[112:115], v[128:131]
v_rcp_f32 v16, v16
v_mfma_f32_16x16x32_bf16 v[132:135], v[80:83], a[116:119], v[132:135]
s_add_u32 m0, s84, 40960
ds_read_b64_tr_b16 v[70:71], v2 offset:58880
v_mul_f32 v196, v196, v16
v_mfma_f32_16x16x32_bf16 v[136:139], v[80:83], a[120:123], v[136:139]
v_rcp_f32 v17, v17
v_mfma_f32_16x16x32_bf16 v[140:143], v[80:83], a[124:127], v[140:143]
s_add_u32 s81, s13, 4129152
ds_read_b64_tr_b16 v[72:73], v3 offset:57344
v_mul_f32 v197, v197, v17
v_mfma_f32_16x16x32_bf16 v[156:159], v[84:87], a[124:127], v[156:159]
buffer_load_dwordx4 v1, s[40:43], s81 offen lds
v_mfma_f32_16x16x32_bf16 v[152:155], v[84:87], a[120:123], v[152:155]
ds_read_b64_tr_b16 v[74:75], v3 offset:57856
v_cvt_pk_bf16_f32 v28, v196, v197
v_mfma_f32_16x16x32_bf16 v[148:151], v[84:87], a[116:119], v[148:151]
v_rcp_f32 v18, v18
v_mfma_f32_16x16x32_bf16 v[144:147], v[84:87], a[112:115], v[144:147]
ds_read_b64_tr_b16 v[76:77], v3 offset:58368
v_mul_f32 v198, v198, v18
v_mfma_f32_16x16x32_bf16 v[160:163], v[88:91], a[112:115], v[160:163]
buffer_load_dwordx4 v1, s[44:47], s81 offen offset:1024 lds
v_mfma_f32_16x16x32_bf16 v[164:167], v[88:91], a[116:119], v[164:167]
ds_read_b64_tr_b16 v[78:79], v3 offset:58880
v_mul_f32 v23, s87, v231
v_mfma_f32_16x16x32_bf16 v[168:171], v[88:91], a[120:123], v[168:171]
v_rcp_f32 v19, v19
v_mfma_f32_16x16x32_bf16 v[172:175], v[88:91], a[124:127], v[172:175]
ds_read_b64_tr_b16 v[80:81], v2
v_mul_f32 v199, v199, v19
v_mfma_f32_16x16x32_bf16 v[188:191], v[92:95], a[124:127], v[188:191]
v_cvt_pk_bf16_f32 v29, v198, v199
v_mul_f32 v228, v228, v244
v_mfma_f32_16x16x32_bf16 v[184:187], v[92:95], a[120:123], v[184:187]
ds_read_b64_tr_b16 v[82:83], v2 offset:512
v_mul_f32 v229, v229, v245
v_mfma_f32_16x16x32_bf16 v[180:183], v[92:95], a[116:119], v[180:183]
ds_write_b64 v4, v[28:29] offset:33792
v_mfma_f32_16x16x32_bf16 v[176:179], v[92:95], a[112:115], v[176:179]
s_waitcnt lgkmcnt(3)
ds_read_b64_tr_b16 v[84:85], v2 offset:1024
v_mul_f32 v230, v230, v246
v_mfma_f32_16x16x32_bf16 v[128:131], v[64:67], a[128:131], v[128:131]
v_exp_f32 v20, v20
v_mfma_f32_16x16x32_bf16 v[132:135], v[64:67], a[132:135], v[132:135]
ds_read_b64_tr_b16 v[86:87], v2 offset:1536
v_mul_f32 v231, v231, v247
v_mfma_f32_16x16x32_bf16 v[136:139], v[64:67], a[136:139], v[136:139]
v_exp_f32 v21, v21
v_mfma_f32_16x16x32_bf16 v[140:143], v[64:67], a[140:143], v[140:143]
ds_read_b64_tr_b16 v[88:89], v3
v_add_f32 v20, 1.0, v20
v_mfma_f32_16x16x32_bf16 v[156:159], v[68:71], a[140:143], v[156:159]
v_exp_f32 v22, v22
v_mfma_f32_16x16x32_bf16 v[152:155], v[68:71], a[136:139], v[152:155]
ds_read_b64_tr_b16 v[90:91], v3 offset:512
v_add_f32 v21, 1.0, v21
v_mfma_f32_16x16x32_bf16 v[148:151], v[68:71], a[132:135], v[148:151]
v_exp_f32 v23, v23
v_mfma_f32_16x16x32_bf16 v[144:147], v[68:71], a[128:131], v[144:147]
s_add_u32 m0, s84, 49152
ds_read_b64_tr_b16 v[92:93], v3 offset:1024
v_add_f32 v22, 1.0, v22
v_mfma_f32_16x16x32_bf16 v[160:163], v[72:75], a[128:131], v[160:163]
v_add_f32 v23, 1.0, v23
v_mul_f32 v16, s87, v200
v_mfma_f32_16x16x32_bf16 v[164:167], v[72:75], a[132:135], v[164:167]
s_waitcnt vmcnt(6)
ds_read_b64_tr_b16 v[94:95], v3 offset:1536
v_mul_f32 v17, s87, v201
v_mfma_f32_16x16x32_bf16 v[168:171], v[72:75], a[136:139], v[168:171]
s_barrier
v_mfma_f32_16x16x32_bf16 v[172:175], v[72:75], a[140:143], v[172:175]
s_add_u32 s81, s13, 4424064
ds_read_b64_tr_b16 v[64:65], v2 offset:8192
v_mul_f32 v18, s87, v202
v_mfma_f32_16x16x32_bf16 v[188:191], v[76:79], a[140:143], v[188:191]
buffer_load_dwordx4 v1, s[40:43], s81 offen lds
v_mfma_f32_16x16x32_bf16 v[184:187], v[76:79], a[136:139], v[184:187]
ds_read_b64_tr_b16 v[66:67], v2 offset:8704
v_mul_f32 v19, s87, v203
v_mfma_f32_16x16x32_bf16 v[180:183], v[76:79], a[132:135], v[180:183]
buffer_load_dwordx4 v1, s[44:47], s81 offen offset:1024 lds
v_mfma_f32_16x16x32_bf16 v[176:179], v[76:79], a[128:131], v[176:179]
s_waitcnt lgkmcnt(2)
ds_read_b64_tr_b16 v[68:69], v2 offset:9216
v_mul_f32 v200, v200, v216
v_mfma_f32_16x16x32_bf16 v[128:131], v[80:83], a[144:147], v[128:131]
v_rcp_f32 v20, v20
v_mfma_f32_16x16x32_bf16 v[132:135], v[80:83], a[148:151], v[132:135]
s_add_u32 m0, s84, 57344
ds_read_b64_tr_b16 v[70:71], v2 offset:9728
v_mul_f32 v228, v228, v20
v_mfma_f32_16x16x32_bf16 v[136:139], v[80:83], a[152:155], v[136:139]
v_rcp_f32 v21, v21
v_mfma_f32_16x16x32_bf16 v[140:143], v[80:83], a[156:159], v[140:143]
s_add_u32 s81, s13, 4718976
ds_read_b64_tr_b16 v[72:73], v3 offset:8192
v_mul_f32 v229, v229, v21
v_mfma_f32_16x16x32_bf16 v[156:159], v[84:87], a[156:159], v[156:159]
buffer_load_dwordx4 v1, s[40:43], s81 offen lds
v_mfma_f32_16x16x32_bf16 v[152:155], v[84:87], a[152:155], v[152:155]
ds_read_b64_tr_b16 v[74:75], v3 offset:8704
v_cvt_pk_bf16_f32 v30, v228, v229
v_mfma_f32_16x16x32_bf16 v[148:151], v[84:87], a[148:151], v[148:151]
v_rcp_f32 v22, v22
v_mfma_f32_16x16x32_bf16 v[144:147], v[84:87], a[144:147], v[144:147]
ds_read_b64_tr_b16 v[76:77], v3 offset:9216
v_mul_f32 v230, v230, v22
v_mfma_f32_16x16x32_bf16 v[160:163], v[88:91], a[144:147], v[160:163]
buffer_load_dwordx4 v1, s[44:47], s81 offen offset:1024 lds
v_mfma_f32_16x16x32_bf16 v[164:167], v[88:91], a[148:151], v[164:167]
ds_read_b64_tr_b16 v[78:79], v3 offset:9728
v_mul_f32 v201, v201, v217
v_mfma_f32_16x16x32_bf16 v[168:171], v[88:91], a[152:155], v[168:171]
v_rcp_f32 v23, v23
v_mfma_f32_16x16x32_bf16 v[172:175], v[88:91], a[156:159], v[172:175]
ds_read_b64_tr_b16 v[80:81], v2 offset:16384
v_mul_f32 v231, v231, v23
v_mfma_f32_16x16x32_bf16 v[188:191], v[92:95], a[156:159], v[188:191]
v_cvt_pk_bf16_f32 v31, v230, v231
v_mul_f32 v202, v202, v218
v_mfma_f32_16x16x32_bf16 v[184:187], v[92:95], a[152:155], v[184:187]
ds_read_b64_tr_b16 v[82:83], v2 offset:16896
v_mul_f32 v203, v203, v219
v_mfma_f32_16x16x32_bf16 v[180:183], v[92:95], a[148:151], v[180:183]
ds_write_b64 v4, v[30:31] offset:33800
v_mfma_f32_16x16x32_bf16 v[176:179], v[92:95], a[144:147], v[176:179]
s_waitcnt lgkmcnt(3)
ds_read_b64_tr_b16 v[84:85], v2 offset:17408
v_mfma_f32_16x16x32_bf16 v[128:131], v[64:67], a[160:163], v[128:131]
v_exp_f32 v16, v16
v_mfma_f32_16x16x32_bf16 v[132:135], v[64:67], a[164:167], v[132:135]
ds_read_b64_tr_b16 v[86:87], v2 offset:17920
v_add_f32 v16, 1.0, v16
v_mfma_f32_16x16x32_bf16 v[136:139], v[64:67], a[168:171], v[136:139]
v_exp_f32 v17, v17
v_mfma_f32_16x16x32_bf16 v[140:143], v[64:67], a[172:175], v[140:143]
ds_read_b64_tr_b16 v[88:89], v3 offset:16384
v_add_f32 v17, 1.0, v17
v_mfma_f32_16x16x32_bf16 v[156:159], v[68:71], a[172:175], v[156:159]
v_exp_f32 v18, v18
v_mfma_f32_16x16x32_bf16 v[152:155], v[68:71], a[168:171], v[152:155]
ds_read_b64_tr_b16 v[90:91], v3 offset:16896
v_add_f32 v18, 1.0, v18
v_mfma_f32_16x16x32_bf16 v[148:151], v[68:71], a[164:167], v[148:151]
v_exp_f32 v19, v19
v_mfma_f32_16x16x32_bf16 v[144:147], v[68:71], a[160:163], v[144:147]
s_add_u32 m0, s84, 0
ds_read_b64_tr_b16 v[92:93], v3 offset:17408
v_add_f32 v19, 1.0, v19
v_mfma_f32_16x16x32_bf16 v[160:163], v[72:75], a[160:163], v[160:163]
v_rcp_f32 v16, v16
v_mfma_f32_16x16x32_bf16 v[164:167], v[72:75], a[164:167], v[164:167]
s_waitcnt vmcnt(6)
ds_read_b64_tr_b16 v[94:95], v3 offset:17920
v_mul_f32 v200, v200, v16
v_mfma_f32_16x16x32_bf16 v[168:171], v[72:75], a[168:171], v[168:171]
s_barrier
v_mfma_f32_16x16x32_bf16 v[172:175], v[72:75], a[172:175], v[172:175]
s_add_u32 s81, s13, 5013888
ds_read_b64_tr_b16 v[64:65], v2 offset:24576
v_mul_f32 v20, s87, v232
v_mfma_f32_16x16x32_bf16 v[188:191], v[76:79], a[172:175], v[188:191]
buffer_load_dwordx4 v1, s[40:43], s81 offen lds
v_mfma_f32_16x16x32_bf16 v[184:187], v[76:79], a[168:171], v[184:187]
ds_read_b64_tr_b16 v[66:67], v2 offset:25088
v_mul_f32 v21, s87, v233
v_mfma_f32_16x16x32_bf16 v[180:183], v[76:79], a[164:167], v[180:183]
buffer_load_dwordx4 v1, s[44:47], s81 offen offset:1024 lds
v_mfma_f32_16x16x32_bf16 v[176:179], v[76:79], a[160:163], v[176:179]
s_waitcnt lgkmcnt(2)
ds_read_b64_tr_b16 v[68:69], v2 offset:25600
v_mul_f32 v22, s87, v234
v_mfma_f32_16x16x32_bf16 v[128:131], v[80:83], a[176:179], v[128:131]
v_rcp_f32 v17, v17
v_mfma_f32_16x16x32_bf16 v[132:135], v[80:83], a[180:183], v[132:135]
s_add_u32 m0, s84, 8192
ds_read_b64_tr_b16 v[70:71], v2 offset:26112
v_mul_f32 v201, v201, v17
v_mfma_f32_16x16x32_bf16 v[136:139], v[80:83], a[184:187], v[136:139]
v_rcp_f32 v18, v18
v_mfma_f32_16x16x32_bf16 v[140:143], v[80:83], a[188:191], v[140:143]
s_add_u32 s81, s10, 0
ds_read_b64_tr_b16 v[72:73], v3 offset:24576
v_mul_f32 v202, v202, v18
v_mfma_f32_16x16x32_bf16 v[156:159], v[84:87], a[188:191], v[156:159]
buffer_load_dwordx4 v8, s[48:51], s81 offen lds
v_mfma_f32_16x16x32_bf16 v[152:155], v[84:87], a[184:187], v[152:155]
ds_read_b64_tr_b16 v[74:75], v3 offset:25088
v_cvt_pk_bf16_f32 v24, v200, v201
v_mfma_f32_16x16x32_bf16 v[148:151], v[84:87], a[180:183], v[148:151]
v_rcp_f32 v19, v19
v_mfma_f32_16x16x32_bf16 v[144:147], v[84:87], a[176:179], v[144:147]
ds_read_b64_tr_b16 v[76:77], v3 offset:25600
v_mul_f32 v203, v203, v19
v_mfma_f32_16x16x32_bf16 v[160:163], v[88:91], a[176:179], v[160:163]
buffer_load_dwordx4 v9, s[48:51], s81 offen offset:1024 lds
v_mfma_f32_16x16x32_bf16 v[164:167], v[88:91], a[180:183], v[164:167]
ds_read_b64_tr_b16 v[78:79], v3 offset:26112
v_cvt_pk_bf16_f32 v25, v202, v203
v_mfma_f32_16x16x32_bf16 v[168:171], v[88:91], a[184:187], v[168:171]
ds_write_b64 v4, v[24:25] offset:34816
v_mfma_f32_16x16x32_bf16 v[172:175], v[88:91], a[188:191], v[172:175]
ds_read_b64_tr_b16 v[80:81], v2 offset:32768
v_mul_f32 v23, s87, v235
v_mfma_f32_16x16x32_bf16 v[188:191], v[92:95], a[188:191], v[188:191]
v_exp_f32 v20, v20
v_mfma_f32_16x16x32_bf16 v[184:187], v[92:95], a[184:187], v[184:187]
ds_read_b64_tr_b16 v[82:83], v2 offset:33280
v_mul_f32 v232, v232, v248
v_mfma_f32_16x16x32_bf16 v[180:183], v[92:95], a[180:183], v[180:183]
v_exp_f32 v21, v21
v_mfma_f32_16x16x32_bf16 v[176:179], v[92:95], a[176:179], v[176:179]
s_waitcnt lgkmcnt(3)
ds_read_b64_tr_b16 v[84:85], v2 offset:33792
v_mul_f32 v233, v233, v249
v_mfma_f32_16x16x32_bf16 v[128:131], v[64:67], a[192:195], v[128:131]
v_exp_f32 v22, v22
v_mfma_f32_16x16x32_bf16 v[132:135], v[64:67], a[196:199], v[132:135]
ds_read_b64_tr_b16 v[86:87], v2 offset:34304
v_mul_f32 v234, v234, v250
v_mfma_f32_16x16x32_bf16 v[136:139], v[64:67], a[200:203], v[136:139]
v_exp_f32 v23, v23
v_mfma_f32_16x16x32_bf16 v[140:143], v[64:67], a[204:207], v[140:143]
ds_read_b64_tr_b16 v[88:89], v3 offset:32768
v_mul_f32 v235, v235, v251
v_mfma_f32_16x16x32_bf16 v[156:159], v[68:71], a[204:207], v[156:159]
v_add_f32 v20, 1.0, v20
v_add_f32 v21, 1.0, v21
v_mfma_f32_16x16x32_bf16 v[152:155], v[68:71], a[200:203], v[152:155]
ds_read_b64_tr_b16 v[90:91], v3 offset:33280
v_add_f32 v22, 1.0, v22
v_mfma_f32_16x16x32_bf16 v[148:151], v[68:71], a[196:199], v[148:151]
v_add_f32 v23, 1.0, v23
v_mul_f32 v16, s87, v204
v_mfma_f32_16x16x32_bf16 v[144:147], v[68:71], a[192:195], v[144:147]
s_add_u32 m0, s84, 16384
ds_read_b64_tr_b16 v[92:93], v3 offset:33792
v_mul_f32 v17, s87, v205
v_mfma_f32_16x16x32_bf16 v[160:163], v[72:75], a[192:195], v[160:163]
v_rcp_f32 v20, v20
v_mfma_f32_16x16x32_bf16 v[164:167], v[72:75], a[196:199], v[164:167]
s_waitcnt vmcnt(6)
ds_read_b64_tr_b16 v[94:95], v3 offset:34304
v_mul_f32 v232, v232, v20
v_mfma_f32_16x16x32_bf16 v[168:171], v[72:75], a[200:203], v[168:171]
s_barrier
v_mfma_f32_16x16x32_bf16 v[172:175], v[72:75], a[204:207], v[172:175]
s_add_u32 s81, s10, 589824
ds_read_b64_tr_b16 v[64:65], v2 offset:40960
v_mul_f32 v18, s87, v206
v_mfma_f32_16x16x32_bf16 v[188:191], v[76:79], a[204:207], v[188:191]
buffer_load_dwordx4 v8, s[48:51], s81 offen lds
v_mfma_f32_16x16x32_bf16 v[184:187], v[76:79], a[200:203], v[184:187]
ds_read_b64_tr_b16 v[66:67], v2 offset:41472
v_mul_f32 v19, s87, v207
v_mfma_f32_16x16x32_bf16 v[180:183], v[76:79], a[196:199], v[180:183]
buffer_load_dwordx4 v9, s[48:51], s81 offen offset:1024 lds
v_mfma_f32_16x16x32_bf16 v[176:179], v[76:79], a[192:195], v[176:179]
s_waitcnt lgkmcnt(2)
ds_read_b64_tr_b16 v[68:69], v2 offset:41984
v_mul_f32 v204, v204, v220
v_mfma_f32_16x16x32_bf16 v[128:131], v[80:83], a[208:211], v[128:131]
v_rcp_f32 v21, v21
v_mfma_f32_16x16x32_bf16 v[132:135], v[80:83], a[212:215], v[132:135]
s_add_u32 m0, s84, 24576
ds_read_b64_tr_b16 v[70:71], v2 offset:42496
v_mul_f32 v233, v233, v21
v_mfma_f32_16x16x32_bf16 v[136:139], v[80:83], a[216:219], v[136:139]
v_rcp_f32 v22, v22
v_mfma_f32_16x16x32_bf16 v[140:143], v[80:83], a[220:223], v[140:143]
s_add_u32 s81, s10, 1179648
ds_read_b64_tr_b16 v[72:73], v3 offset:40960
v_mul_f32 v234, v234, v22
v_mfma_f32_16x16x32_bf16 v[156:159], v[84:87], a[220:223], v[156:159]
buffer_load_dwordx4 v8, s[48:51], s81 offen lds
v_mfma_f32_16x16x32_bf16 v[152:155], v[84:87], a[216:219], v[152:155]
ds_read_b64_tr_b16 v[74:75], v3 offset:41472
v_cvt_pk_bf16_f32 v26, v232, v233
v_mfma_f32_16x16x32_bf16 v[148:151], v[84:87], a[212:215], v[148:151]
v_rcp_f32 v23, v23
v_mfma_f32_16x16x32_bf16 v[144:147], v[84:87], a[208:211], v[144:147]
ds_read_b64_tr_b16 v[76:77], v3 offset:41984
v_mul_f32 v235, v235, v23
v_mfma_f32_16x16x32_bf16 v[160:163], v[88:91], a[208:211], v[160:163]
buffer_load_dwordx4 v9, s[48:51], s81 offen offset:1024 lds
v_mfma_f32_16x16x32_bf16 v[164:167], v[88:91], a[212:215], v[164:167]
ds_read_b64_tr_b16 v[78:79], v3 offset:42496
v_cvt_pk_bf16_f32 v27, v234, v235
v_mfma_f32_16x16x32_bf16 v[168:171], v[88:91], a[216:219], v[168:171]
ds_write_b64 v4, v[26:27] offset:34824
v_mfma_f32_16x16x32_bf16 v[172:175], v[88:91], a[220:223], v[172:175]
ds_read_b64_tr_b16 v[80:81], v2 offset:49152
v_mul_f32 v205, v205, v221
v_mfma_f32_16x16x32_bf16 v[188:191], v[92:95], a[220:223], v[188:191]
v_exp_f32 v16, v16
v_mfma_f32_16x16x32_bf16 v[184:187], v[92:95], a[216:219], v[184:187]
ds_read_b64_tr_b16 v[82:83], v2 offset:49664
v_mul_f32 v206, v206, v222
v_mfma_f32_16x16x32_bf16 v[180:183], v[92:95], a[212:215], v[180:183]
v_exp_f32 v17, v17
v_mfma_f32_16x16x32_bf16 v[176:179], v[92:95], a[208:211], v[176:179]
s_waitcnt lgkmcnt(3)
ds_read_b64_tr_b16 v[84:85], v2 offset:50176
v_mul_f32 v207, v207, v223
v_mfma_f32_16x16x32_bf16 v[128:131], v[64:67], a[224:227], v[128:131]
v_exp_f32 v18, v18
v_mfma_f32_16x16x32_bf16 v[132:135], v[64:67], a[228:231], v[132:135]
ds_read_b64_tr_b16 v[86:87], v2 offset:50688
v_add_f32 v16, 1.0, v16
v_mfma_f32_16x16x32_bf16 v[136:139], v[64:67], a[232:235], v[136:139]
v_exp_f32 v19, v19
v_mfma_f32_16x16x32_bf16 v[140:143], v[64:67], a[236:239], v[140:143]
ds_read_b64_tr_b16 v[88:89], v3 offset:49152
v_add_f32 v17, 1.0, v17
v_mfma_f32_16x16x32_bf16 v[156:159], v[68:71], a[236:239], v[156:159]
v_add_f32 v18, 1.0, v18
v_add_f32 v19, 1.0, v19
v_mfma_f32_16x16x32_bf16 v[152:155], v[68:71], a[232:235], v[152:155]
ds_read_b64_tr_b16 v[90:91], v3 offset:49664
v_mul_f32 v20, s87, v236
v_mfma_f32_16x16x32_bf16 v[148:151], v[68:71], a[228:231], v[148:151]
s_lshl_b32 s86, s80, 1
v_lshrrev_b32 v5, 5, v0
v_lshlrev_b32 v5, 10, v5
v_bfe_u32 v6, v0, 2, 3
v_rcp_f32 v16, v16
v_rcp_f32 v17, v17
v_rcp_f32 v18, v18
v_rcp_f32 v19, v19
v_mul_f32 v21, s87, v237
v_mul_f32 v22, s87, v238
v_mul_f32 v23, s87, v239
v_exp_f32 v20, v20
v_mul_f32 v236, v236, v252
v_exp_f32 v21, v21
v_mul_f32 v237, v237, v253
v_exp_f32 v22, v22
v_mul_f32 v238, v238, v254
v_exp_f32 v23, v23
v_mul_f32 v239, v239, v255
v_mfma_f32_16x16x32_bf16 v[144:147], v[68:71], a[224:227], v[144:147]
s_add_u32 m0, s84, 32768
ds_read_b64_tr_b16 v[92:93], v3 offset:50176
v_lshl_add_u32 v5, v6, 7, v5
v_mul_f32 v204, v204, v16
v_mul_f32 v205, v205, v17
v_mul_f32 v206, v206, v18
v_mfma_f32_16x16x32_bf16 v[160:163], v[72:75], a[224:227], v[160:163]
s_lshl_b32 s85, s78, 10
v_and_b32 v7, 3, v0
v_lshl_add_u32 v5, v7, 3, v5
v_mfma_f32_16x16x32_bf16 v[164:167], v[72:75], a[228:231], v[164:167]
s_waitcnt vmcnt(6)
ds_read_b64_tr_b16 v[94:95], v3 offset:50688
v_lshrrev_b32 v6, 1, v6
v_mfma_f32_16x16x32_bf16 v[168:171], v[72:75], a[232:235], v[168:171]
s_barrier
v_mfma_f32_16x16x32_bf16 v[172:175], v[72:75], a[236:239], v[172:175]
s_add_u32 s81, s10, 1769472
ds_read_b64_tr_b16 v[64:65], v2 offset:57344
v_xor_b32 v6, s86, v6
v_mfma_f32_16x16x32_bf16 v[188:191], v[76:79], a[236:239], v[188:191]
buffer_load_dwordx4 v8, s[48:51], s81 offen lds
v_mfma_f32_16x16x32_bf16 v[184:187], v[76:79], a[232:235], v[184:187]
ds_read_b64_tr_b16 v[66:67], v2 offset:57856
v_lshlrev_b32 v6, 5, v6
v_mfma_f32_16x16x32_bf16 v[180:183], v[76:79], a[228:231], v[180:183]
buffer_load_dwordx4 v9, s[48:51], s81 offen offset:1024 lds
v_mfma_f32_16x16x32_bf16 v[176:179], v[76:79], a[224:227], v[176:179]
s_waitcnt lgkmcnt(2)
ds_read_b64_tr_b16 v[68:69], v2 offset:58368
v_xor_b32 v56, 32, v6
v_mfma_f32_16x16x32_bf16 v[128:131], v[80:83], a[240:243], v[128:131]
v_add_u32 v58, v5, v6
v_add_u32 v59, v5, v56
v_mfma_f32_16x16x32_bf16 v[132:135], v[80:83], a[244:247], v[132:135]
s_add_u32 m0, s84, 40960
ds_read_b64_tr_b16 v[70:71], v2 offset:58880
v_bfe_u32 v6, v0, 2, 2
v_mfma_f32_16x16x32_bf16 v[136:139], v[80:83], a[248:251], v[136:139]
v_lshlrev_b32 v5, 7, v6
v_lshl_add_u32 v5, v7, 3, v5
v_mfma_f32_16x16x32_bf16 v[140:143], v[80:83], a[252:255], v[140:143]
s_add_u32 s81, s10, 2359296
ds_read_b64_tr_b16 v[72:73], v3 offset:57344
v_lshrrev_b32 v6, 1, v6
v_mfma_f32_16x16x32_bf16 v[156:159], v[84:87], a[252:255], v[156:159]
buffer_load_dwordx4 v8, s[48:51], s81 offen lds
v_mfma_f32_16x16x32_bf16 v[152:155], v[84:87], a[248:251], v[152:155]
ds_read_b64_tr_b16 v[74:75], v3 offset:57856
v_xor_b32 v6, s86, v6
v_mfma_f32_16x16x32_bf16 v[148:151], v[84:87], a[244:247], v[148:151]
v_lshlrev_b32 v6, 5, v6
v_xor_b32 v56, 32, v6
v_mfma_f32_16x16x32_bf16 v[144:147], v[84:87], a[240:243], v[144:147]
ds_read_b64_tr_b16 v[76:77], v3 offset:58368
v_add3_u32 v62, v5, v6, s85
v_mfma_f32_16x16x32_bf16 v[160:163], v[88:91], a[240:243], v[160:163]
buffer_load_dwordx4 v9, s[48:51], s81 offen offset:1024 lds
v_mfma_f32_16x16x32_bf16 v[164:167], v[88:91], a[244:247], v[164:167]
ds_read_b64_tr_b16 v[78:79], v3 offset:58880
v_add3_u32 v63, v5, v56, s85
v_mfma_f32_16x16x32_bf16 v[168:171], v[88:91], a[248:251], v[168:171]
s_lshl_b32 s85, s78, 3
v_add_u32 v56, 73728, v58
v_add_u32 v60, 73728, v62
v_mfma_f32_16x16x32_bf16 v[172:175], v[88:91], a[252:255], v[172:175]
ds_read_b64_tr_b16 v[80:81], v2
v_add_u32 v57, 73728, v59
v_mfma_f32_16x16x32_bf16 v[188:191], v[92:95], a[252:255], v[188:191]
v_add_u32 v61, 73728, v63
v_bfe_u32 v6, v0, 1, 2
v_mfma_f32_16x16x32_bf16 v[184:187], v[92:95], a[248:251], v[184:187]
ds_read_b64_tr_b16 v[82:83], v2 offset:512
v_lshrrev_b32 v7, 4, v0
v_mfma_f32_16x16x32_bf16 v[180:183], v[92:95], a[244:247], v[180:183]
v_xor_b32 v6, v6, v7
v_lshlrev_b32 v6, 5, v6
v_mfma_f32_16x16x32_bf16 v[176:179], v[92:95], a[240:243], v[176:179]
s_waitcnt lgkmcnt(2)
ds_read_b64_tr_b16 v[84:85], v2 offset:1024
v_and_b32 v7, 1, v0
v_mfma_f32_16x16x32_bf16 v[128:131], v[64:67], v[96:99], v[128:131]
s_mul_i32 s82, s92, 1152
v_lshl_add_u32 v6, v7, 4, v6
v_lshrrev_b32 v5, 3, v0
v_mfma_f32_16x16x32_bf16 v[132:135], v[64:67], v[100:103], v[132:135]
s_mul_i32 s93, s93, 1152
ds_read_b64_tr_b16 v[86:87], v2 offset:1536
v_add_u32 v7, s85, v5
v_mfma_f32_16x16x32_bf16 v[136:139], v[64:67], v[104:107], v[136:139]
s_mul_i32 s85, s79, 2304
v_mul_u32_u24 v7, 1152, v7
v_add_u32 v12, v7, v6
v_mfma_f32_16x16x32_bf16 v[140:143], v[64:67], v[108:111], v[140:143]
s_add_u32 s85, s85, 2048
ds_read_b64_tr_b16 v[88:89], v3
v_add_u32 v1, s85, v12
v_mfma_f32_16x16x32_bf16 v[156:159], v[68:71], v[108:111], v[156:159]
s_mul_i32 s89, s76, 41472
v_and_b32 v5, 3, v5
v_lshrrev_b32 v7, 1, v5
v_mfma_f32_16x16x32_bf16 v[152:155], v[68:71], v[104:107], v[152:155]
s_lshl_b32 s90, s78, 10
ds_read_b64_tr_b16 v[90:91], v3 offset:512
v_lshl_add_u32 v5, v7, 4, v5
v_mfma_f32_16x16x32_bf16 v[148:151], v[68:71], v[100:103], v[148:151]
v_add_u32 v5, 16, v5
v_mul_u32_u24 v5, 1152, v5
v_mfma_f32_16x16x32_bf16 v[144:147], v[68:71], v[96:99], v[144:147]
s_add_u32 m0, s84, 49152
ds_read_b64_tr_b16 v[92:93], v3 offset:1024
v_add_u32 v5, 2048, v5
v_mfma_f32_16x16x32_bf16 v[160:163], v[72:75], v[96:99], v[160:163]
v_add_u32 v13, v5, v6
v_mul_f32 v207, v207, v19
v_mfma_f32_16x16x32_bf16 v[164:167], v[72:75], v[100:103], v[164:167]
s_waitcnt vmcnt(6)
ds_read_b64_tr_b16 v[94:95], v3 offset:1536
v_cvt_pk_bf16_f32 v28, v204, v205
v_mfma_f32_16x16x32_bf16 v[168:171], v[72:75], v[104:107], v[168:171]
s_barrier
v_mfma_f32_16x16x32_bf16 v[172:175], v[72:75], v[108:111], v[172:175]
s_add_u32 s81, s11, 2949120
ds_read_b64_tr_b16 v[64:65], v10 offset:8192
v_cvt_pk_bf16_f32 v29, v206, v207
v_mfma_f32_16x16x32_bf16 v[188:191], v[76:79], v[108:111], v[188:191]
buffer_load_dwordx4 v8, s[48:51], s81 offen lds
v_mfma_f32_16x16x32_bf16 v[184:187], v[76:79], v[104:107], v[184:187]
ds_read_b64_tr_b16 v[66:67], v10 offset:8448
v_add_f32 v20, 1.0, v20
v_mfma_f32_16x16x32_bf16 v[180:183], v[76:79], v[100:103], v[180:183]
buffer_load_dwordx4 v9, s[48:51], s81 offen offset:1024 lds
v_mfma_f32_16x16x32_bf16 v[176:179], v[76:79], v[96:99], v[176:179]
s_waitcnt lgkmcnt(2)
ds_read_b64_tr_b16 v[68:69], v10 offset:12288
v_add_f32 v21, 1.0, v21
v_mfma_f32_16x16x32_bf16 v[128:131], v[80:83], v[112:115], v[128:131]
ds_write_b64 v4, v[28:29] offset:35840
v_mfma_f32_16x16x32_bf16 v[132:135], v[80:83], v[116:119], v[132:135]
s_add_u32 m0, s84, 57344
ds_read_b64_tr_b16 v[70:71], v10 offset:12544
v_add_f32 v22, 1.0, v22
v_mfma_f32_16x16x32_bf16 v[136:139], v[80:83], v[120:123], v[136:139]
v_add_f32 v23, 1.0, v23
v_rcp_f32 v20, v20
v_mfma_f32_16x16x32_bf16 v[140:143], v[80:83], v[124:127], v[140:143]
s_add_u32 s81, s11, 3538944
ds_read_b64_tr_b16 v[72:73], v10 offset:9216
v_mul_f32 v236, v236, v20
v_mfma_f32_16x16x32_bf16 v[156:159], v[84:87], v[124:127], v[156:159]
buffer_load_dwordx4 v8, s[48:51], s81 offen lds
v_mfma_f32_16x16x32_bf16 v[152:155], v[84:87], v[120:123], v[152:155]
ds_read_b64_tr_b16 v[74:75], v10 offset:9472
v_mfma_f32_16x16x32_bf16 v[148:151], v[84:87], v[116:119], v[148:151]
v_rcp_f32 v21, v21
v_mfma_f32_16x16x32_bf16 v[144:147], v[84:87], v[112:115], v[144:147]
ds_read_b64_tr_b16 v[76:77], v10 offset:13312
v_mul_f32 v237, v237, v21
v_mfma_f32_16x16x32_bf16 v[160:163], v[88:91], v[112:115], v[160:163]
buffer_load_dwordx4 v9, s[48:51], s81 offen offset:1024 lds
v_mfma_f32_16x16x32_bf16 v[164:167], v[88:91], v[116:119], v[164:167]
ds_read_b64_tr_b16 v[78:79], v10 offset:13568
v_cvt_pk_bf16_f32 v30, v236, v237
v_mfma_f32_16x16x32_bf16 v[168:171], v[88:91], v[120:123], v[168:171]
v_rcp_f32 v22, v22
v_mfma_f32_16x16x32_bf16 v[172:175], v[88:91], v[124:127], v[172:175]
ds_read_b64_tr_b16 v[80:81], v10 offset:16384
v_mul_f32 v238, v238, v22
v_mfma_f32_16x16x32_bf16 v[188:191], v[92:95], v[124:127], v[188:191]
v_rcp_f32 v23, v23
v_mfma_f32_16x16x32_bf16 v[184:187], v[92:95], v[120:123], v[184:187]
ds_read_b64_tr_b16 v[82:83], v10 offset:16640
v_mul_f32 v239, v239, v23
v_mfma_f32_16x16x32_bf16 v[180:183], v[92:95], v[116:119], v[180:183]
v_cvt_pk_bf16_f32 v31, v238, v239
v_mfma_f32_16x16x32_bf16 v[176:179], v[92:95], v[112:115], v[176:179]
s_waitcnt lgkmcnt(2)
ds_read_b64_tr_b16 v[84:85], v10 offset:20480
ds_write_b64 v4, v[30:31] offset:35848
v_mfma_f32_16x16x32_bf16 v[192:195], v[64:67], a[0:3], 0
s_mov_b32 s86, 2146435072
v_lshlrev_b32 v5, 4, v0
v_and_b32 v224, 1, v0
v_mfma_f32_16x16x32_bf16 v[196:199], v[64:67], a[4:7], 0
s_cmp_eq_u32 s78, 0
s_cselect_b32 s85, 0, s86
ds_read_b64_tr_b16 v[86:87], v10 offset:20736
v_max_u32 v5, s85, v5
v_mfma_f32_16x16x32_bf16 v[200:203], v[64:67], a[8:11], 0
buffer_load_dword v6, v5, s[68:71], 0 offen sc1
v_lshlrev_b32 v224, 4, v224
v_mfma_f32_16x16x32_bf16 v[204:207], v[64:67], a[12:15], 0
ds_read_b64_tr_b16 v[88:89], v10 offset:17408
v_mov_b32 v226, 0x3f80
v_mfma_f32_16x16x32_bf16 v[220:223], v[68:71], a[12:15], 0
v_lshlrev_b32 v224, v224, v226
v_and_b32 v225, 14, v0
v_mul_f32 v16, s87, v128
v_mfma_f32_16x16x32_bf16 v[216:219], v[68:71], a[8:11], 0
ds_read_b64_tr_b16 v[90:91], v10 offset:17664
v_cmp_eq_u32 vcc, 0, v225
v_mul_f32 v17, s87, v129
v_mfma_f32_16x16x32_bf16 v[212:215], v[68:71], a[4:7], 0
v_mul_f32 v18, s87, v130
v_mul_f32 v19, s87, v131
v_exp_f32 v16, v16
v_mfma_f32_16x16x32_bf16 v[208:211], v[68:71], a[0:3], 0
s_add_u32 m0, s84, 0
ds_read_b64_tr_b16 v[92:93], v10 offset:21504
v_cndmask_b32 v228, 0, v224, vcc
v_mfma_f32_16x16x32_bf16 v[192:195], v[72:75], a[16:19], v[192:195]
v_cmp_eq_u32 vcc, 4, v225
v_mul_f32 v128, v128, v144
v_exp_f32 v17, v17
v_mfma_f32_16x16x32_bf16 v[196:199], v[72:75], a[20:23], v[196:199]
s_waitcnt vmcnt(7)
ds_read_b64_tr_b16 v[94:95], v10 offset:21760
v_mul_f32 v129, v129, v145
v_mfma_f32_16x16x32_bf16 v[200:203], v[72:75], a[24:27], v[200:203]
s_barrier
v_exp_f32 v18, v18
v_mfma_f32_16x16x32_bf16 v[204:207], v[72:75], a[28:31], v[204:207]
s_add_u32 s81, s11, 4128768
ds_read_b64_tr_b16 v[64:65], v10 offset:24576
v_cndmask_b32 v229, 0, v224, vcc
v_mfma_f32_16x16x32_bf16 v[220:223], v[76:79], a[28:31], v[220:223]
buffer_load_dwordx4 v8, s[48:51], s81 offen lds
v_mul_f32 v130, v130, v146
v_mfma_f32_16x16x32_bf16 v[216:219], v[76:79], a[24:27], v[216:219]
ds_read_b64_tr_b16 v[66:67], v10 offset:24832
v_cmp_eq_u32 vcc, 8, v225
v_exp_f32 v19, v19
v_mfma_f32_16x16x32_bf16 v[212:215], v[76:79], a[20:23], v[212:215]
buffer_load_dwordx4 v9, s[48:51], s81 offen offset:1024 lds
v_mfma_f32_16x16x32_bf16 v[208:211], v[76:79], a[16:19], v[208:211]
s_waitcnt lgkmcnt(2)
ds_read_b64_tr_b16 v[68:69], v10 offset:28672
v_cndmask_b32 v230, 0, v224, vcc
v_mul_f32 v131, v131, v147
v_mfma_f32_16x16x32_bf16 v[192:195], v[80:83], a[32:35], v[192:195]
s_lshl_b32 s98, s79, 12
v_cmp_eq_u32 vcc, 12, v225
v_lshlrev_b32 v3, 4, v0
v_add_f32 v16, 1.0, v16
v_add_f32 v17, 1.0, v17
v_add_f32 v18, 1.0, v18
v_add_f32 v19, 1.0, v19
v_rcp_f32 v16, v16
v_rcp_f32 v17, v17
v_rcp_f32 v18, v18
v_rcp_f32 v19, v19
v_mfma_f32_16x16x32_bf16 v[196:199], v[80:83], a[36:39], v[196:199]
s_add_u32 m0, s84, 8192
ds_read_b64_tr_b16 v[70:71], v10 offset:28928
v_add_u32 v2, s98, v3
v_mfma_f32_16x16x32_bf16 v[200:203], v[80:83], a[40:43], v[200:203]
v_cndmask_b32 v231, 0, v224, vcc
v_add_u32 v3, 65536, v2
v_mul_f32 v128, v128, v16
v_mfma_f32_16x16x32_bf16 v[204:207], v[80:83], a[44:47], v[204:207]
s_add_u32 s81, s11, 4718592
ds_read_b64_tr_b16 v[72:73], v10 offset:25600
v_mul_f32 v129, v129, v17
v_mul_f32 v130, v130, v18
v_mfma_f32_16x16x32_bf16 v[220:223], v[84:87], a[44:47], v[220:223]
buffer_load_dwordx4 v8, s[48:51], s81 offen lds
v_mul_f32 v131, v131, v19
v_mfma_f32_16x16x32_bf16 v[216:219], v[84:87], a[40:43], v[216:219]
ds_read_b64_tr_b16 v[74:75], v10 offset:25856
v_cvt_pk_bf16_f32 v24, v128, v129
v_cvt_pk_bf16_f32 v25, v130, v131
v_mfma_f32_16x16x32_bf16 v[212:215], v[84:87], a[36:39], v[212:215]
ds_read_b128 a[0:3], v2
v_mul_f32 v20, s87, v160
v_mul_f32 v21, s87, v161
v_mfma_f32_16x16x32_bf16 v[208:211], v[84:87], a[32:35], v[208:211]
ds_read_b64_tr_b16 v[76:77], v10 offset:29696
v_mul_f32 v22, s87, v162
v_mul_f32 v23, s87, v163
v_mfma_f32_16x16x32_bf16 v[192:195], v[88:91], a[48:51], v[192:195]
buffer_load_dwordx4 v9, s[48:51], s81 offen offset:1024 lds
v_exp_f32 v20, v20
v_mfma_f32_16x16x32_bf16 v[196:199], v[88:91], a[52:55], v[196:199]
ds_read_b64_tr_b16 v[78:79], v10 offset:29952
v_mul_f32 v160, v160, v176
v_mfma_f32_16x16x32_bf16 v[200:203], v[88:91], a[56:59], v[200:203]
ds_read_b128 a[4:7], v2 offset:1024
v_mul_f32 v161, v161, v177
v_exp_f32 v21, v21
v_mfma_f32_16x16x32_bf16 v[204:207], v[88:91], a[60:63], v[204:207]
ds_read_b64_tr_b16 v[80:81], v10 offset:32768
v_mul_f32 v162, v162, v178
v_mfma_f32_16x16x32_bf16 v[220:223], v[92:95], a[60:63], v[220:223]
ds_read_b128 a[8:11], v2 offset:2048
v_mul_f32 v163, v163, v179
v_exp_f32 v22, v22
v_mfma_f32_16x16x32_bf16 v[216:219], v[92:95], a[56:59], v[216:219]
ds_read_b64_tr_b16 v[82:83], v10 offset:33024
v_add_f32 v20, 1.0, v20
v_mfma_f32_16x16x32_bf16 v[212:215], v[92:95], a[52:55], v[212:215]
ds_read_b128 a[12:15], v2 offset:3072
v_add_f32 v21, 1.0, v21
v_mfma_f32_16x16x32_bf16 v[208:211], v[92:95], a[48:51], v[208:211]
s_waitcnt lgkmcnt(5)
ds_read_b64_tr_b16 v[84:85], v10 offset:36864
v_add_f32 v22, 1.0, v22
v_exp_f32 v23, v23
v_mfma_f32_16x16x32_bf16 v[192:195], v[64:67], a[64:67], v[192:195]
s_waitcnt vmcnt(4)
ds_read_b128 a[16:19], v2 offset:8192
v_cmp_le_u32 vcc, 16, v6
v_mfma_f32_16x16x32_bf16 v[196:199], v[64:67], a[68:71], v[196:199]
ds_read_b64_tr_b16 v[86:87], v10 offset:37120
v_add_f32 v23, 1.0, v23
v_rcp_f32 v20, v20
v_mfma_f32_16x16x32_bf16 v[200:203], v[64:67], a[72:75], v[200:203]
s_cmp_eq_u32 vcc_lo, s3
s_cbranch_scc0 L_kv_spin
L_kv_ok:
ds_read_b128 a[20:23], v2 offset:9216
v_mul_f32 v160, v160, v20
v_mfma_f32_16x16x32_bf16 v[204:207], v[64:67], a[76:79], v[204:207]
ds_read_b64_tr_b16 v[88:89], v10 offset:33792
v_mul_f32 v16, s87, v132
v_rcp_f32 v21, v21
v_mfma_f32_16x16x32_bf16 v[220:223], v[68:71], a[76:79], v[220:223]
ds_read_b128 a[24:27], v2 offset:10240
v_mul_f32 v161, v161, v21
v_mfma_f32_16x16x32_bf16 v[216:219], v[68:71], a[72:75], v[216:219]
ds_read_b64_tr_b16 v[90:91], v10 offset:34048
v_cvt_pk_bf16_f32 v26, v160, v161
v_rcp_f32 v22, v22
v_mfma_f32_16x16x32_bf16 v[212:215], v[68:71], a[68:71], v[212:215]
ds_read_b128 a[28:31], v2 offset:11264
v_mul_f32 v162, v162, v22
v_mfma_f32_16x16x32_bf16 v[208:211], v[68:71], a[64:67], v[208:211]
ds_read_b64_tr_b16 v[92:93], v10 offset:37888
v_mul_f32 v17, s87, v133
v_rcp_f32 v23, v23
v_mfma_f32_16x16x32_bf16 v[192:195], v[72:75], a[80:83], v[192:195]
ds_read_b128 a[32:35], v2 offset:16384
v_mul_f32 v163, v163, v23
v_cvt_pk_bf16_f32 v27, v162, v163
v_mul_f32 v18, s87, v134
v_mul_f32 v19, s87, v135
v_exp_f32 v16, v16
v_mul_f32 v132, v132, v148
v_exp_f32 v17, v17
v_mfma_f32_16x16x32_bf16 v[196:199], v[72:75], a[84:87], v[196:199]
ds_read_b64_tr_b16 v[94:95], v10 offset:38144
v_mul_f32 v133, v133, v149
v_exp_f32 v18, v18
v_mfma_f32_16x16x32_bf16 v[200:203], v[72:75], a[88:91], v[200:203]
s_barrier
v_mfma_f32_16x16x32_bf16 v[204:207], v[72:75], a[92:95], v[204:207]
s_lshl_b32 s85, s76, 1
s_add_u32 s85, s85, s80
s_mul_i32 s85, s85, 24576
s_mul_i32 s86, s79, 768
s_add_u32 s85, s85, s86
ds_read_b64_tr_b16 v[64:65], v10 offset:40960
v_lshrrev_b32 v5, 4, v0
v_mul_u32_u24 v5, 1536, v5
v_and_b32 v6, 15, v0
v_mul_f32 v134, v134, v150
v_exp_f32 v19, v19
v_mul_f32 v135, v135, v151
v_add_f32 v16, 1.0, v16
v_add_f32 v17, 1.0, v17
v_add_f32 v18, 1.0, v18
v_rcp_f32 v16, v16
v_rcp_f32 v17, v17
v_rcp_f32 v18, v18
v_mul_f32 v20, s87, v164
v_mul_f32 v21, s87, v165
v_mul_f32 v22, s87, v166
v_mul_f32 v23, s87, v167
v_exp_f32 v20, v20
v_mul_f32 v164, v164, v180
v_exp_f32 v21, v21
v_mul_f32 v165, v165, v181
v_exp_f32 v22, v22
v_mul_f32 v166, v166, v182
v_exp_f32 v23, v23
v_mfma_f32_16x16x32_bf16 v[220:223], v[76:79], a[92:95], v[220:223]
ds_read_b128 a[36:39], v2 offset:17408
v_lshl_add_u32 v5, v6, 4, v5
v_mfma_f32_16x16x32_bf16 v[216:219], v[76:79], a[88:91], v[216:219]
ds_read_b64_tr_b16 v[66:67], v10 offset:41216
v_add_f32 v19, 1.0, v19
v_rcp_f32 v19, v19
v_mfma_f32_16x16x32_bf16 v[212:215], v[76:79], a[84:87], v[212:215]
ds_read_b128 a[40:43], v2 offset:18432
v_mul_f32 v132, v132, v16
v_mfma_f32_16x16x32_bf16 v[208:211], v[76:79], a[80:83], v[208:211]
s_waitcnt lgkmcnt(4)
ds_read_b64_tr_b16 v[68:69], v10 offset:45056
v_mul_f32 v133, v133, v17
v_mul_f32 v134, v134, v18
v_mfma_f32_16x16x32_bf16 v[192:195], v[80:83], a[96:99], v[192:195]
ds_read_b128 a[44:47], v2 offset:19456
v_mul_f32 v135, v135, v19
v_cvt_pk_bf16_f32 v28, v132, v133
v_mfma_f32_16x16x32_bf16 v[196:199], v[80:83], a[100:103], v[196:199]
ds_read_b64_tr_b16 v[70:71], v10 offset:45312
v_cvt_pk_bf16_f32 v29, v134, v135
v_mul_f32 v167, v167, v183
v_mfma_f32_16x16x32_bf16 v[200:203], v[80:83], a[104:107], v[200:203]
ds_read_b128 a[48:51], v2 offset:24576
v_add_f32 v20, 1.0, v20
v_add_f32 v21, 1.0, v21
v_mfma_f32_16x16x32_bf16 v[204:207], v[80:83], a[108:111], v[204:207]
ds_read_b64_tr_b16 v[72:73], v10 offset:41984
v_add_f32 v22, 1.0, v22
v_add_f32 v23, 1.0, v23
v_mfma_f32_16x16x32_bf16 v[220:223], v[84:87], a[108:111], v[220:223]
ds_read_b128 a[52:55], v2 offset:25600
v_rcp_f32 v20, v20
v_mfma_f32_16x16x32_bf16 v[216:219], v[84:87], a[104:107], v[216:219]
ds_read_b64_tr_b16 v[74:75], v10 offset:42240
v_mul_f32 v164, v164, v20
v_rcp_f32 v21, v21
v_mfma_f32_16x16x32_bf16 v[212:215], v[84:87], a[100:103], v[212:215]
ds_read_b128 a[56:59], v2 offset:26624
v_mul_f32 v165, v165, v21
v_mfma_f32_16x16x32_bf16 v[208:211], v[84:87], a[96:99], v[208:211]
ds_read_b64_tr_b16 v[76:77], v10 offset:46080
v_cvt_pk_bf16_f32 v30, v164, v165
v_mfma_f32_16x16x32_bf16 v[192:195], v[88:91], a[112:115], v[192:195]
ds_read_b128 a[60:63], v2 offset:27648
v_mul_f32 v16, s87, v136
v_rcp_f32 v22, v22
v_mfma_f32_16x16x32_bf16 v[196:199], v[88:91], a[116:119], v[196:199]
ds_read_b64_tr_b16 v[78:79], v10 offset:46336
v_mul_f32 v166, v166, v22
v_mfma_f32_16x16x32_bf16 v[200:203], v[88:91], a[120:123], v[200:203]
buffer_load_dwordx4 v[32:35], v5, s[64:67], s85 offen sc1
v_mul_f32 v17, s87, v137
v_rcp_f32 v23, v23
v_mfma_f32_16x16x32_bf16 v[204:207], v[88:91], a[124:127], v[204:207]
ds_read_b64_tr_b16 v[80:81], v10 offset:49152
v_mul_f32 v167, v167, v23
v_mfma_f32_16x16x32_bf16 v[220:223], v[92:95], a[124:127], v[220:223]
ds_read_b128 a[64:67], v2 offset:32768
v_cvt_pk_bf16_f32 v31, v166, v167
v_mul_f32 v18, s87, v138
v_mul_f32 v19, s87, v139
v_exp_f32 v16, v16
v_mul_f32 v136, v136, v152
v_exp_f32 v17, v17
v_mul_f32 v137, v137, v153
v_exp_f32 v18, v18
v_mfma_f32_16x16x32_bf16 v[216:219], v[92:95], a[120:123], v[216:219]
ds_read_b64_tr_b16 v[82:83], v10 offset:49408
v_mul_f32 v138, v138, v154
v_mfma_f32_16x16x32_bf16 v[212:215], v[92:95], a[116:119], v[212:215]
ds_read_b128 a[68:71], v2 offset:33792
v_mul_f32 v139, v139, v155
v_exp_f32 v19, v19
v_mfma_f32_16x16x32_bf16 v[208:211], v[92:95], a[112:115], v[208:211]
s_waitcnt lgkmcnt(4)
ds_read_b64_tr_b16 v[84:85], v10 offset:53248
v_add_f32 v16, 1.0, v16
v_mfma_f32_16x16x32_bf16 v[192:195], v[64:67], a[128:131], v[192:195]
ds_read_b128 a[72:75], v2 offset:34816
v_add_f32 v17, 1.0, v17
v_add_f32 v18, 1.0, v18
v_mfma_f32_16x16x32_bf16 v[196:199], v[64:67], a[132:135], v[196:199]
ds_read_b64_tr_b16 v[86:87], v10 offset:53504
v_add_f32 v19, 1.0, v19
v_rcp_f32 v16, v16
v_mfma_f32_16x16x32_bf16 v[200:203], v[64:67], a[136:139], v[200:203]
ds_read_b128 a[76:79], v2 offset:35840
v_mul_f32 v136, v136, v16
v_mfma_f32_16x16x32_bf16 v[204:207], v[64:67], a[140:143], v[204:207]
ds_read_b64_tr_b16 v[88:89], v10 offset:50176
v_mul_f32 v20, s87, v168
v_mfma_f32_16x16x32_bf16 v[220:223], v[68:71], a[140:143], v[220:223]
ds_read_b128 a[80:83], v2 offset:40960
v_mul_f32 v21, s87, v169
v_rcp_f32 v17, v17
v_mfma_f32_16x16x32_bf16 v[216:219], v[68:71], a[136:139], v[216:219]
ds_read_b64_tr_b16 v[90:91], v10 offset:50432
v_mul_f32 v137, v137, v17
v_mfma_f32_16x16x32_bf16 v[212:215], v[68:71], a[132:135], v[212:215]
ds_read_b128 a[84:87], v2 offset:41984
v_mul_f32 v22, s87, v170
v_rcp_f32 v18, v18
v_mfma_f32_16x16x32_bf16 v[208:211], v[68:71], a[128:131], v[208:211]
ds_read_b64_tr_b16 v[92:93], v10 offset:54272
v_mul_f32 v138, v138, v18
v_mfma_f32_16x16x32_bf16 v[192:195], v[72:75], a[144:147], v[192:195]
ds_read_b128 a[88:91], v2 offset:43008
v_mul_f32 v23, s87, v171
v_rcp_f32 v19, v19
v_mfma_f32_16x16x32_bf16 v[196:199], v[72:75], a[148:151], v[196:199]
s_waitcnt vmcnt(3)
ds_read_b64_tr_b16 v[94:95], v10 offset:54528
v_mul_f32 v139, v139, v19
v_mfma_f32_16x16x32_bf16 v[200:203], v[72:75], a[152:155], v[200:203]
s_barrier
ds_write_b64 v4, v[24:25] offset:49152
v_mfma_f32_16x16x32_bf16 v[204:207], v[72:75], a[156:159], v[204:207]
ds_read_b64_tr_b16 v[64:65], v10 offset:57344
v_cvt_pk_bf16_f32 v24, v136, v137
v_mfma_f32_16x16x32_bf16 v[220:223], v[76:79], a[156:159], v[220:223]
ds_read_b128 a[92:95], v2 offset:44032
v_cvt_pk_bf16_f32 v25, v138, v139
v_exp_f32 v20, v20
v_mfma_f32_16x16x32_bf16 v[216:219], v[76:79], a[152:155], v[216:219]
ds_read_b64_tr_b16 v[66:67], v10 offset:57600
v_mul_f32 v168, v168, v184
v_mfma_f32_16x16x32_bf16 v[212:215], v[76:79], a[148:151], v[212:215]
buffer_load_dwordx4 v[48:51], v5, s[64:67], s85 offen offset:256 sc1
v_mul_f32 v169, v169, v185
v_exp_f32 v21, v21
v_mfma_f32_16x16x32_bf16 v[208:211], v[76:79], a[144:147], v[208:211]
s_waitcnt lgkmcnt(4)
ds_read_b64_tr_b16 v[68:69], v10 offset:61440
v_mul_f32 v170, v170, v186
v_mfma_f32_16x16x32_bf16 v[192:195], v[80:83], a[160:163], v[192:195]
s_mul_i32 s86, s79, 768
buffer_load_dwordx4 v[240:243], v5, s[64:67], s85 offen offset:512 sc1
v_mul_f32 v171, v171, v187
v_mfma_f32_16x16x32_bf16 v[196:199], v[80:83], a[164:167], v[196:199]
s_add_u32 s85, s85, 6144
ds_read_b64_tr_b16 v[70:71], v10 offset:61696
v_add_f32 v20, 1.0, v20
v_exp_f32 v22, v22
v_mfma_f32_16x16x32_bf16 v[200:203], v[80:83], a[168:171], v[200:203]
buffer_load_dwordx4 v[36:39], v5, s[64:67], s85 offen sc1
v_lshrrev_b32 v7, 4, v0
v_mfma_f32_16x16x32_bf16 v[204:207], v[80:83], a[172:175], v[204:207]
ds_read_b64_tr_b16 v[72:73], v10 offset:58368
v_lshlrev_b32 v7, 2, v7
v_exp_f32 v23, v23
v_mfma_f32_16x16x32_bf16 v[220:223], v[84:87], a[172:175], v[220:223]
buffer_load_dwordx4 v[52:55], v5, s[64:67], s85 offen offset:256 sc1
v_lshl_add_u32 v7, v6, 4, v7
v_mfma_f32_16x16x32_bf16 v[216:219], v[84:87], a[168:171], v[216:219]
ds_read_b64_tr_b16 v[74:75], v10 offset:58624
v_add_f32 v21, 1.0, v21
v_add_f32 v22, 1.0, v22
v_mfma_f32_16x16x32_bf16 v[212:215], v[84:87], a[164:167], v[212:215]
buffer_load_dwordx4 v[244:247], v5, s[64:67], s85 offen offset:512 sc1
v_add_f32 v23, 1.0, v23
v_rcp_f32 v20, v20
v_mfma_f32_16x16x32_bf16 v[208:211], v[84:87], a[160:163], v[208:211]
s_add_u32 s85, s85, 6144
ds_read_b64_tr_b16 v[76:77], v10 offset:62464
v_mul_f32 v168, v168, v20
v_mfma_f32_16x16x32_bf16 v[192:195], v[88:91], a[176:179], v[192:195]
buffer_load_dwordx4 v[40:43], v5, s[64:67], s85 offen sc1
v_mul_f32 v16, s87, v140
v_rcp_f32 v21, v21
v_mfma_f32_16x16x32_bf16 v[196:199], v[88:91], a[180:183], v[196:199]
ds_read_b64_tr_b16 v[78:79], v10 offset:62720
v_mul_f32 v169, v169, v21
v_mfma_f32_16x16x32_bf16 v[200:203], v[88:91], a[184:187], v[200:203]
buffer_load_dwordx4 v[232:235], v5, s[64:67], s85 offen offset:256 sc1
v_mul_f32 v17, s87, v141
v_rcp_f32 v22, v22
v_mfma_f32_16x16x32_bf16 v[204:207], v[88:91], a[188:191], v[204:207]
ds_read_b64_tr_b16 v[80:81], v10
v_mul_f32 v170, v170, v22
v_mfma_f32_16x16x32_bf16 v[220:223], v[92:95], a[188:191], v[220:223]
buffer_load_dwordx4 v[248:251], v5, s[64:67], s85 offen offset:512 sc1
v_mul_f32 v18, s87, v142
v_rcp_f32 v23, v23
v_mfma_f32_16x16x32_bf16 v[216:219], v[92:95], a[184:187], v[216:219]
s_add_u32 s85, s85, 6144
ds_read_b64_tr_b16 v[82:83], v10 offset:256
v_mul_f32 v171, v171, v23
v_mfma_f32_16x16x32_bf16 v[212:215], v[92:95], a[180:183], v[212:215]
buffer_load_dwordx4 v[44:47], v5, s[64:67], s85 offen sc1
v_mul_f32 v19, s87, v143
v_mfma_f32_16x16x32_bf16 v[208:211], v[92:95], a[176:179], v[208:211]
s_waitcnt lgkmcnt(2)
ds_read_b64_tr_b16 v[84:85], v10 offset:4096
v_mul_f32 v140, v140, v156
v_exp_f32 v16, v16
v_mfma_f32_16x16x32_bf16 v[192:195], v[64:67], a[192:195], v[192:195]
buffer_load_dwordx4 v[236:239], v5, s[64:67], s85 offen offset:256 sc1
v_mul_f32 v141, v141, v157
v_mfma_f32_16x16x32_bf16 v[196:199], v[64:67], a[196:199], v[196:199]
ds_read_b64_tr_b16 v[86:87], v10 offset:4352
v_mul_f32 v142, v142, v158
v_exp_f32 v17, v17
v_mfma_f32_16x16x32_bf16 v[200:203], v[64:67], a[200:203], v[200:203]
buffer_load_dwordx4 v[252:255], v5, s[64:67], s85 offen offset:512 sc1
v_mul_f32 v143, v143, v159
v_mfma_f32_16x16x32_bf16 v[204:207], v[64:67], a[204:207], v[204:207]
s_mul_i32 s85, s80, 1536
ds_read_b64_tr_b16 v[88:89], v10 offset:1024
v_add_f32 v16, 1.0, v16
v_exp_f32 v18, v18
v_mfma_f32_16x16x32_bf16 v[220:223], v[68:71], a[204:207], v[220:223]
s_add_u32 s85, s85, s86
ds_write_b64 v4, v[26:27] offset:49160
v_mfma_f32_16x16x32_bf16 v[216:219], v[68:71], a[200:203], v[216:219]
s_add_u32 s85, s85, 160512
ds_read_b64_tr_b16 v[90:91], v10 offset:1280
v_add_u32 v7, s85, v7
v_cvt_pk_bf16_f32 v26, v168, v169
v_mfma_f32_16x16x32_bf16 v[212:215], v[68:71], a[196:199], v[212:215]
ds_write_b64 v4, v[28:29] offset:50176
v_cvt_pk_bf16_f32 v27, v170, v171
v_mfma_f32_16x16x32_bf16 v[208:211], v[68:71], a[192:195], v[208:211]
ds_read_b64_tr_b16 v[92:93], v10 offset:5120
v_add_f32 v17, 1.0, v17
v_exp_f32 v19, v19
v_mfma_f32_16x16x32_bf16 v[192:195], v[72:75], a[208:211], v[192:195]
ds_write_b64 v4, v[30:31] offset:50184
v_mfma_f32_16x16x32_bf16 v[196:199], v[72:75], a[212:215], v[196:199]
s_waitcnt vmcnt(12)
ds_read_b64_tr_b16 v[94:95], v10 offset:5376
v_add_f32 v18, 1.0, v18
v_add_f32 v19, 1.0, v19
v_mfma_f32_16x16x32_bf16 v[200:203], v[72:75], a[216:219], v[200:203]
s_barrier
v_mfma_f32_16x16x32_bf16 v[204:207], v[72:75], a[220:223], v[204:207]
s_add_u32 m0, s90, 90112
s_add_u32 s81, s82, 0
ds_read_b64_tr_b16 v[64:65], v10 offset:8192
v_mul_f32 v20, s87, v172
v_rcp_f32 v16, v16
s_waitcnt vmcnt(11)
v_mfma_f32_16x16x32_bf16 v[224:227], v[228:231], v[32:35], 0
buffer_load_dwordx4 v12, s[52:55], s81 offen lds
v_mfma_f32_16x16x32_bf16 v[220:223], v[76:79], a[220:223], v[220:223]
s_add_u32 m0, s90, 94208
ds_write_b64 v4, v[24:25] offset:51200
v_mfma_f32_16x16x32_bf16 v[216:219], v[76:79], a[216:219], v[216:219]
s_add_u32 s81, s82, 36864
ds_read_b64_tr_b16 v[66:67], v10 offset:8448
v_mul_f32 v140, v140, v16
v_rcp_f32 v17, v17
v_mfma_f32_16x16x32_bf16 v[212:215], v[76:79], a[212:215], v[212:215]
buffer_load_dwordx4 v12, s[52:55], s81 offen lds
v_rcp_f32 v18, v18
v_mfma_f32_16x16x32_bf16 v[208:211], v[76:79], a[208:211], v[208:211]
s_add_u32 m0, s90, 98304
ds_read_b64_tr_b16 v[68:69], v10 offset:12288
v_mul_f32 v141, v141, v17
v_rcp_f32 v19, v19
s_waitcnt lgkmcnt(4)
v_mfma_f32_16x16x32_bf16 v[192:195], v[80:83], a[224:227], v[192:195]
s_add_u32 s81, s82, 73728
ds_write_b64 v4, v[26:27] offset:51208
v_mfma_f32_16x16x32_bf16 v[196:199], v[80:83], a[228:231], v[196:199]
ds_read_b64_tr_b16 v[70:71], v10 offset:12544
v_mul_f32 v142, v142, v18
v_mul_f32 v143, v143, v19
v_mfma_f32_16x16x32_bf16 v[200:203], v[80:83], a[232:235], v[200:203]
buffer_load_dwordx4 v12, s[52:55], s81 offen lds
v_cvt_pk_bf16_f32 v28, v140, v141
v_cvt_pk_bf16_f32 v29, v142, v143
v_mul_f32 v21, s87, v173
v_mfma_f32_16x16x32_bf16 v[204:207], v[80:83], a[236:239], v[204:207]
s_add_u32 m0, s90, 102400
ds_read_b64_tr_b16 v[72:73], v10 offset:9216
v_mul_f32 v22, s87, v174
v_mul_f32 v23, s87, v175
v_mfma_f32_16x16x32_bf16 v[220:223], v[84:87], a[236:239], v[220:223]
s_add_u32 s81, s82, 110592
ds_write_b64 v4, v[28:29] offset:52224
v_exp_f32 v20, v20
v_mfma_f32_16x16x32_bf16 v[216:219], v[84:87], a[232:235], v[216:219]
ds_read_b64_tr_b16 v[74:75], v10 offset:9472
v_mul_f32 v172, v172, v188
v_mfma_f32_16x16x32_bf16 v[212:215], v[84:87], a[228:231], v[212:215]
buffer_load_dwordx4 v12, s[52:55], s81 offen lds
v_exp_f32 v21, v21
v_mul_f32 v173, v173, v189
v_mfma_f32_16x16x32_bf16 v[208:211], v[84:87], a[224:227], v[208:211]
s_add_u32 m0, s90, 106496
ds_read_b64_tr_b16 v[76:77], v10 offset:13312
v_mul_f32 v174, v174, v190
v_mfma_f32_16x16x32_bf16 v[192:195], v[88:91], a[240:243], v[192:195]
s_add_u32 s81, s82, 147456
buffer_load_dwordx4 v12, s[52:55], s81 offen lds
v_exp_f32 v22, v22
v_exp_f32 v23, v23
v_mfma_f32_16x16x32_bf16 v[196:199], v[88:91], a[244:247], v[196:199]
s_add_u32 m0, s90, 110592
ds_read_b64_tr_b16 v[78:79], v10 offset:13568
v_mul_f32 v175, v175, v191
v_mfma_f32_16x16x32_bf16 v[200:203], v[88:91], a[248:251], v[200:203]
s_add_u32 s81, s82, 184320
v_add_f32 v20, 1.0, v20
v_add_f32 v21, 1.0, v21
v_add_f32 v22, 1.0, v22
v_mfma_f32_16x16x32_bf16 v[204:207], v[88:91], a[252:255], v[204:207]
buffer_load_dwordx4 v12, s[52:55], s81 offen lds
v_add_f32 v23, 1.0, v23
v_rcp_f32 v20, v20
v_mfma_f32_16x16x32_bf16 v[220:223], v[92:95], a[252:255], v[220:223]
s_add_u32 m0, s90, 114688
v_rcp_f32 v21, v21
v_rcp_f32 v22, v22
v_mfma_f32_16x16x32_bf16 v[216:219], v[92:95], a[248:251], v[216:219]
s_add_u32 s81, s82, 128
v_rcp_f32 v23, v23
v_mfma_f32_16x16x32_bf16 v[212:215], v[92:95], a[244:247], v[212:215]
buffer_load_dwordx4 v12, s[52:55], s81 offen lds
v_mul_f32 v172, v172, v20
v_mul_f32 v173, v173, v21
v_mul_f32 v174, v174, v22
s_waitcnt vmcnt(17)
v_mfma_f32_16x16x32_bf16 v[32:35], v[228:231], v[48:51], 0
s_add_u32 m0, s90, 118784
v_mul_f32 v175, v175, v23
v_cvt_pk_bf16_f32 v30, v172, v173
v_mfma_f32_16x16x32_bf16 v[208:211], v[92:95], a[240:243], v[208:211]
s_add_u32 s81, s82, 36992
v_cvt_pk_bf16_f32 v31, v174, v175
s_waitcnt lgkmcnt(0)
v_mfma_f32_16x16x32_bf16 v[192:195], v[64:67], v[96:99], v[192:195]
buffer_load_dwordx4 v12, s[52:55], s81 offen lds
v_mfma_f32_16x16x32_bf16 v[196:199], v[64:67], v[100:103], v[196:199]
s_add_u32 m0, s90, 122880
ds_write_b64 v4, v[30:31] offset:52232
s_waitcnt vmcnt(16)
v_mfma_f32_16x16x32_bf16 v[224:227], v[228:231], v[36:39], v[224:227]
s_add_u32 s81, s82, 73856
v_mfma_f32_16x16x32_bf16 v[36:39], v[228:231], v[240:243], 0
buffer_load_dwordx4 v12, s[52:55], s81 offen lds
s_waitcnt vmcnt(16)
v_mfma_f32_16x16x32_bf16 v[32:35], v[228:231], v[52:55], v[32:35]
s_add_u32 m0, s90, 126976
v_mfma_f32_16x16x32_bf16 v[200:203], v[64:67], v[104:107], v[200:203]
s_add_u32 s81, s82, 110720
buffer_load_dwordx4 v12, s[52:55], s81 offen lds
s_waitcnt vmcnt(16)
v_mfma_f32_16x16x32_bf16 v[36:39], v[228:231], v[244:247], v[36:39]
s_add_u32 m0, s90, 131072
v_mfma_f32_16x16x32_bf16 v[204:207], v[64:67], v[108:111], v[204:207]
s_add_u32 s81, s82, 147584
buffer_load_dwordx4 v12, s[52:55], s81 offen lds
s_waitcnt vmcnt(16)
v_mfma_f32_16x16x32_bf16 v[224:227], v[228:231], v[40:43], v[224:227]
s_add_u32 m0, s90, 135168
s_add_u32 s81, s82, 184448
buffer_load_dwordx4 v12, s[52:55], s81 offen lds
s_waitcnt vmcnt(14)
v_mfma_f32_16x16x32_bf16 v[224:227], v[228:231], v[44:47], v[224:227]
v_mfma_f32_16x16x32_bf16 v[32:35], v[228:231], v[232:235], v[32:35]
s_waitcnt vmcnt(13)
v_mfma_f32_16x16x32_bf16 v[32:35], v[228:231], v[236:239], v[32:35]
v_mfma_f32_16x16x32_bf16 v[36:39], v[228:231], v[248:251], v[36:39]
s_waitcnt vmcnt(12)
v_mfma_f32_16x16x32_bf16 v[36:39], v[228:231], v[252:255], v[36:39]
s_nop 1
v_cvt_pk_bf16_f32 v224, v224, v225
ds_write_b32 v7, v224
s_nop 0
v_cvt_pk_bf16_f32 v32, v32, v33
ds_write_b32 v7, v32 offset:256
s_nop 0
v_cvt_pk_bf16_f32 v36, v36, v37
ds_write_b32 v7, v36 offset:512
v_mfma_f32_16x16x32_bf16 v[220:223], v[68:71], v[108:111], v[220:223]
v_mfma_f32_16x16x32_bf16 v[216:219], v[68:71], v[104:107], v[216:219]
v_mfma_f32_16x16x32_bf16 v[212:215], v[68:71], v[100:103], v[212:215]
v_mfma_f32_16x16x32_bf16 v[208:211], v[68:71], v[96:99], v[208:211]
s_waitcnt vmcnt(6) lgkmcnt(0)
v_mfma_f32_16x16x32_bf16 v[192:195], v[72:75], v[112:115], v[192:195]
s_barrier
v_mfma_f32_16x16x32_bf16 v[196:199], v[72:75], v[116:119], v[196:199]
ds_read_b64_tr_b16 v[80:81], v56 offset:16384
v_mfma_f32_16x16x32_bf16 v[200:203], v[72:75], v[120:123], v[200:203]
ds_read_b64_tr_b16 v[82:83], v56 offset:18432
v_mfma_f32_16x16x32_bf16 v[204:207], v[72:75], v[124:127], v[204:207]
ds_read_b64_tr_b16 v[84:85], v57 offset:16384
v_mfma_f32_16x16x32_bf16 v[220:223], v[76:79], v[124:127], v[220:223]
ds_read_b64_tr_b16 v[86:87], v57 offset:18432
v_mfma_f32_16x16x32_bf16 v[216:219], v[76:79], v[120:123], v[216:219]
ds_read_b64_tr_b16 v[88:89], v56 offset:20480
v_mfma_f32_16x16x32_bf16 v[212:215], v[76:79], v[116:119], v[212:215]
ds_read_b64_tr_b16 v[90:91], v56 offset:22528
v_mfma_f32_16x16x32_bf16 v[208:211], v[76:79], v[112:115], v[208:211]
s_waitcnt lgkmcnt(4)
ds_read_b64_tr_b16 v[92:93], v57 offset:20480
ds_read_b64_tr_b16 v[94:95], v57 offset:22528
v_mfma_f32_16x16x32_bf16 v[128:131], v[80:83], a[0:3], 0
s_add_u32 m0, s90, 0
s_mul_i32 s85, s80, 1536
s_add_u32 s85, s85, 160512
ds_read_b128 a[96:99], v2 offset:49152
v_lshlrev_b32 v5, 4, v0
v_add_u32 v5, s85, v5
v_mfma_f32_16x16x32_bf16 v[132:135], v[80:83], a[4:7], 0
s_add_u32 s81, s82, 221184
ds_read_b64_tr_b16 v[64:65], v56 offset:24576
v_lshrrev_b32 v6, 4, v0
v_mfma_f32_16x16x32_bf16 v[136:139], v[80:83], a[8:11], 0
buffer_load_dwordx4 v12, s[52:55], s81 offen lds
v_mul_u32_u24 v6, 3, v6
v_mul_f32 v16, s87, v192
v_mfma_f32_16x16x32_bf16 v[140:143], v[80:83], a[12:15], 0
s_add_u32 m0, s90, 4096
ds_read_b64_tr_b16 v[66:67], v56 offset:26624
v_mul_f32 v17, s87, v193
s_waitcnt lgkmcnt(6)
v_mfma_f32_16x16x32_bf16 v[156:159], v[84:87], a[12:15], 0
s_add_u32 s81, s82, 258048
ds_read_b128 a[100:103], v2 offset:50176
v_mul_f32 v18, s87, v194
v_mul_f32 v19, s87, v195
v_mfma_f32_16x16x32_bf16 v[152:155], v[84:87], a[8:11], 0
s_waitcnt lgkmcnt(2)
ds_read_b64_tr_b16 v[68:69], v57 offset:24576
v_mul_f32 v192, v192, v208
v_mfma_f32_16x16x32_bf16 v[148:151], v[84:87], a[4:7], 0
buffer_load_dwordx4 v12, s[52:55], s81 offen lds
v_mfma_f32_16x16x32_bf16 v[144:147], v[84:87], a[0:3], 0
s_add_u32 m0, s90, 8192
ds_read_b64_tr_b16 v[70:71], v57 offset:26624
v_mul_f32 v193, v193, v209
v_mfma_f32_16x16x32_bf16 v[128:131], v[88:91], a[16:19], v[128:131]
s_add_u32 s81, s82, 221312
ds_read_b128 a[104:107], v2 offset:51200
v_and_b32 v7, 15, v0
v_lshlrev_b32 v7, 4, v7
v_add_u32 v7, s85, v7
v_exp_f32 v16, v16
v_mfma_f32_16x16x32_bf16 v[132:135], v[88:91], a[20:23], v[132:135]
ds_read_b64_tr_b16 v[72:73], v56 offset:28672
v_mul_f32 v194, v194, v210
v_mfma_f32_16x16x32_bf16 v[136:139], v[88:91], a[24:27], v[136:139]
buffer_load_dwordx4 v12, s[52:55], s81 offen lds
v_mfma_f32_16x16x32_bf16 v[140:143], v[88:91], a[28:31], v[140:143]
s_add_u32 m0, s90, 12288
ds_read_b64_tr_b16 v[74:75], v56 offset:30720
v_mul_f32 v195, v195, v211
v_mfma_f32_16x16x32_bf16 v[156:159], v[92:95], a[28:31], v[156:159]
s_add_u32 s81, s82, 258176
ds_read_b128 a[108:111], v2 offset:52224
v_add_f32 v16, 1.0, v16
v_exp_f32 v17, v17
v_mfma_f32_16x16x32_bf16 v[152:155], v[92:95], a[24:27], v[152:155]
s_waitcnt lgkmcnt(2)
ds_read_b64_tr_b16 v[76:77], v57 offset:28672
v_add_f32 v17, 1.0, v17
v_mfma_f32_16x16x32_bf16 v[148:151], v[92:95], a[20:23], v[148:151]
buffer_load_dwordx4 v12, s[52:55], s81 offen lds
v_mfma_f32_16x16x32_bf16 v[144:147], v[92:95], a[16:19], v[144:147]
s_add_u32 m0, s90, 16384
ds_read_b64_tr_b16 v[78:79], v57 offset:30720
v_mfma_f32_16x16x32_bf16 v[128:131], v[64:67], a[32:35], v[128:131]
s_add_u32 s81, s93, 0
ds_read_b128 a[112:115], v2 offset:57344
v_exp_f32 v18, v18
v_exp_f32 v19, v19
v_mfma_f32_16x16x32_bf16 v[132:135], v[64:67], a[36:39], v[132:135]
ds_read_b64_tr_b16 v[80:81], v56 offset:32768
v_add_f32 v18, 1.0, v18
v_mfma_f32_16x16x32_bf16 v[136:139], v[64:67], a[40:43], v[136:139]
buffer_load_dwordx4 v12, s[52:55], s81 offen lds
v_mfma_f32_16x16x32_bf16 v[140:143], v[64:67], a[44:47], v[140:143]
s_add_u32 m0, s90, 20480
ds_read_b64_tr_b16 v[82:83], v56 offset:34816
v_add_f32 v19, 1.0, v19
v_mfma_f32_16x16x32_bf16 v[156:159], v[68:71], a[44:47], v[156:159]
s_add_u32 s81, s89, 0
ds_read_b128 a[116:119], v2 offset:58368
v_mul_f32 v20, s87, v196
v_mfma_f32_16x16x32_bf16 v[152:155], v[68:71], a[40:43], v[152:155]
ds_read_b64_tr_b16 v[84:85], v57 offset:32768
v_mul_f32 v21, s87, v197
v_mfma_f32_16x16x32_bf16 v[148:151], v[68:71], a[36:39], v[148:151]
buffer_load_dwordx4 v1, s[56:59], s81 offen lds
v_mfma_f32_16x16x32_bf16 v[144:147], v[68:71], a[32:35], v[144:147]
s_waitcnt lgkmcnt(3)
ds_read_b64_tr_b16 v[86:87], v57 offset:34816
v_mul_f32 v22, s87, v198
v_mfma_f32_16x16x32_bf16 v[128:131], v[72:75], a[48:51], v[128:131]
ds_read_b128 a[120:123], v2 offset:59392
v_mul_f32 v23, s87, v199
v_rcp_f32 v16, v16
v_mfma_f32_16x16x32_bf16 v[132:135], v[72:75], a[52:55], v[132:135]
ds_read_b64_tr_b16 v[88:89], v56 offset:36864
v_mul_f32 v192, v192, v16
v_mfma_f32_16x16x32_bf16 v[136:139], v[72:75], a[56:59], v[136:139]
ds_read_b128 a[124:127], v2 offset:60416
v_mul_f32 v196, v196, v212
v_mfma_f32_16x16x32_bf16 v[140:143], v[72:75], a[60:63], v[140:143]
ds_read_b64_tr_b16 v[90:91], v56 offset:38912
v_mul_f32 v197, v197, v213
v_mfma_f32_16x16x32_bf16 v[156:159], v[76:79], a[60:63], v[156:159]
ds_read_b128 v[108:111], v5
v_and_b32 v5, 3, v0
v_min_u32 v5, 2, v5
v_add_u32 v6, v6, v5
v_lshlrev_b32 v6, 4, v6
v_add_u32 v6, s85, v6
v_lshlrev_b32 v5, 4, v5
v_add_u32 v5, s85, v5
v_rcp_f32 v17, v17
v_mfma_f32_16x16x32_bf16 v[152:155], v[76:79], a[56:59], v[152:155]
s_lshl_b32 s85, s79, 8
s_add_u32 s85, s85, 159744
ds_read_b64_tr_b16 v[92:93], v57 offset:36864
v_mul_f32 v193, v193, v17
v_mfma_f32_16x16x32_bf16 v[148:151], v[76:79], a[52:55], v[148:151]
s_waitcnt lgkmcnt(4)
ds_read_b128 v[112:115], v6 offset:1280
v_cvt_pk_bf16_f32 v24, v192, v193
v_rcp_f32 v18, v18
v_mfma_f32_16x16x32_bf16 v[144:147], v[76:79], a[48:51], v[144:147]
s_waitcnt vmcnt(6)
ds_read_b64_tr_b16 v[94:95], v57 offset:38912
v_mul_f32 v194, v194, v18
v_mfma_f32_16x16x32_bf16 v[128:131], v[80:83], a[64:67], v[128:131]
s_barrier
ds_read_b64 v[104:105], v7 offset:1024
v_mfma_f32_16x16x32_bf16 v[132:135], v[80:83], a[68:71], v[132:135]
s_add_u32 m0, s90, 24576
ds_read_b64_tr_b16 v[64:65], v56 offset:40960
v_mul_f32 v198, v198, v214
v_rcp_f32 v19, v19
v_exp_f32 v20, v20
v_exp_f32 v21, v21
v_exp_f32 v22, v22
v_exp_f32 v23, v23
v_mul_f32 v199, v199, v215
v_mfma_f32_16x16x32_bf16 v[136:139], v[80:83], a[72:75], v[136:139]
s_add_u32 s81, s89, 0
ds_read_b64 v[106:107], v5 offset:1472
v_and_b32 v5, 15, v0
v_lshlrev_b32 v6, 2, v5
v_add_u32 v6, s85, v6
v_mul_u32_u24 v5, 80, v5
v_mul_f32 v195, v195, v19
v_cvt_pk_bf16_f32 v25, v194, v195
v_add_f32 v20, 1.0, v20
v_add_f32 v21, 1.0, v21
v_add_f32 v22, 1.0, v22
v_add_f32 v23, 1.0, v23
v_rcp_f32 v20, v20
v_mfma_f32_16x16x32_bf16 v[140:143], v[80:83], a[76:79], v[140:143]
s_mul_i32 s85, s78, 5120
s_add_u32 s85, s85, 139264
ds_read_b64_tr_b16 v[66:67], v56 offset:43008
v_mul_f32 v196, v196, v20
v_add_u32 v5, s85, v5
v_mfma_f32_16x16x32_bf16 v[156:159], v[84:87], a[76:79], v[156:159]
buffer_load_dwordx4 v13, s[56:59], s81 offen lds
v_mfma_f32_16x16x32_bf16 v[152:155], v[84:87], a[72:75], v[152:155]
s_add_u32 m0, s90, 28672
ds_read_b64_tr_b16 v[68:69], v57 offset:40960
v_mul_f32 v16, s87, v200
v_mfma_f32_16x16x32_bf16 v[148:151], v[84:87], a[68:71], v[148:151]
s_add_u32 s81, s93, 128
s_mov_b32 s91, 0x42700000
ds_read_b32 v236, v6
v_cmp_gt_u32 vcc, 16, v0
v_rcp_f32 v21, v21
v_mfma_f32_16x16x32_bf16 v[144:147], v[84:87], a[64:67], v[144:147]
s_waitcnt lgkmcnt(4)
ds_read_b64_tr_b16 v[70:71], v57 offset:43008
v_mul_f32 v197, v197, v21
v_mfma_f32_16x16x32_bf16 v[128:131], v[88:91], a[80:83], v[128:131]
buffer_load_dwordx4 v12, s[52:55], s81 offen lds
v_mfma_f32_16x16x32_bf16 v[132:135], v[88:91], a[84:87], v[132:135]
s_add_u32 m0, s90, 32768
ds_read_b64_tr_b16 v[72:73], v56 offset:45056
v_cvt_pk_bf16_f32 v28, v196, v197
v_mfma_f32_16x16x32_bf16 v[136:139], v[88:91], a[88:91], v[136:139]
s_add_u32 s81, s89, 128
ds_read_b32 v237, v6 offset:64
v_mul_f32 v17, s87, v201
v_mfma_f32_16x16x32_bf16 v[140:143], v[88:91], a[92:95], v[140:143]
ds_read_b64_tr_b16 v[74:75], v56 offset:47104
v_mul_f32 v18, s87, v202
v_mfma_f32_16x16x32_bf16 v[156:159], v[92:95], a[92:95], v[156:159]
buffer_load_dwordx4 v1, s[56:59], s81 offen lds
v_mfma_f32_16x16x32_bf16 v[152:155], v[92:95], a[88:91], v[152:155]
s_add_u32 m0, s90, 36864
ds_read_b64_tr_b16 v[76:77], v57 offset:45056
v_mul_f32 v19, s87, v203
v_rcp_f32 v22, v22
v_mfma_f32_16x16x32_bf16 v[148:151], v[92:95], a[84:87], v[148:151]
s_add_u32 s81, s89, 128
ds_read_b32 v238, v6 offset:128
v_mov_b32 v242, 0
v_mov_b32 v243, 0
s_waitcnt lgkmcnt(5)
v_min_f32 v236, s91, v236
v_mul_f32 v236, s88, v236
v_exp_f32 v236, v236
v_rcp_f32 v23, v23
v_mfma_f32_16x16x32_bf16 v[144:147], v[92:95], a[80:83], v[144:147]
ds_read_b64_tr_b16 v[78:79], v57 offset:47104
v_mul_f32 v198, v198, v22
v_mfma_f32_16x16x32_bf16 v[160:163], v[64:67], a[0:3], 0
buffer_load_dwordx4 v13, s[56:59], s81 offen lds
v_mfma_f32_16x16x32_bf16 v[164:167], v[64:67], a[4:7], 0
s_add_u32 m0, s90, 40960
ds_read_b64_tr_b16 v[80:81], v56 offset:49152
v_mul_f32 v199, v199, v23
v_mfma_f32_16x16x32_bf16 v[168:171], v[64:67], a[8:11], 0
s_add_u32 s81, s82, 256
ds_read_b32 v239, v6 offset:192
v_lshrrev_b32 v6, 4, v0
v_lshl_add_u32 v6, v6, 4, v5
v_mov_b32 v246, 0
v_mov_b32 v247, 0
s_waitcnt lgkmcnt(5)
v_min_f32 v237, s91, v237
v_mul_f32 v237, s88, v237
v_exp_f32 v237, v237
v_cvt_pk_bf16_f32 v29, v198, v199
v_mfma_f32_16x16x32_bf16 v[172:175], v[64:67], a[12:15], 0
ds_read_b64_tr_b16 v[82:83], v56 offset:51200
v_mul_f32 v200, v200, v216
v_mfma_f32_16x16x32_bf16 v[188:191], v[68:71], a[12:15], 0
buffer_load_dwordx4 v12, s[52:55], s81 offen lds
v_mfma_f32_16x16x32_bf16 v[184:187], v[68:71], a[8:11], 0
s_add_u32 m0, s90, 45056
ds_read_b64_tr_b16 v[84:85], v57 offset:49152
v_mul_f32 v201, v201, v217
v_mfma_f32_16x16x32_bf16 v[180:183], v[68:71], a[4:7], 0
s_add_u32 s81, s82, 37120
ds_read_b128 a[176:179], v6
v_mov_b32 v250, 0
v_mov_b32 v251, 0
s_waitcnt lgkmcnt(5)
v_min_f32 v238, s91, v238
v_mul_f32 v238, s88, v238
v_exp_f32 v238, v238
v_exp_f32 v16, v16
v_mfma_f32_16x16x32_bf16 v[176:179], v[68:71], a[0:3], 0
ds_read_b64_tr_b16 v[86:87], v57 offset:51200
v_mul_f32 v202, v202, v218
v_mfma_f32_16x16x32_bf16 v[160:163], v[72:75], a[16:19], v[160:163]
buffer_load_dwordx4 v12, s[52:55], s81 offen lds
v_mfma_f32_16x16x32_bf16 v[164:167], v[72:75], a[20:23], v[164:167]
s_add_u32 m0, s90, 73728
ds_read_b64_tr_b16 v[88:89], v56 offset:53248
v_mul_f32 v203, v203, v219
v_mfma_f32_16x16x32_bf16 v[168:171], v[72:75], a[24:27], v[168:171]
s_add_u32 s81, s82, 73984
ds_read_b64 v[240:241], v5 offset:64
v_add_f32 v16, 1.0, v16
v_exp_f32 v17, v17
v_mfma_f32_16x16x32_bf16 v[172:175], v[72:75], a[28:31], v[172:175]
ds_read_b64_tr_b16 v[90:91], v56 offset:55296
v_add_f32 v17, 1.0, v17
v_mfma_f32_16x16x32_bf16 v[188:191], v[76:79], a[28:31], v[188:191]
buffer_load_dwordx4 v12, s[52:55], s81 offen lds
v_mfma_f32_16x16x32_bf16 v[184:187], v[76:79], a[24:27], v[184:187]
s_add_u32 m0, s90, 77824
ds_read_b64_tr_b16 v[92:93], v57 offset:53248
v_exp_f32 v18, v18
v_mfma_f32_16x16x32_bf16 v[180:183], v[76:79], a[20:23], v[180:183]
s_add_u32 s81, s82, 110848
ds_read_b128 a[180:183], v6 offset:1280
v_mov_b32 v254, 0
v_mov_b32 v255, 0
s_waitcnt lgkmcnt(5)
v_min_f32 v239, s91, v239
v_mul_f32 v239, s88, v239
v_exp_f32 v239, v239
v_exp_f32 v19, v19
v_mfma_f32_16x16x32_bf16 v[32:35], v[108:111], a[176:179], 0
buffer_load_dwordx4 v12, s[52:55], s81 offen lds
v_mfma_f32_16x16x32_bf16 v[36:39], v[112:115], a[176:179], 0
ds_read_b64 v[244:245], v5 offset:1344
v_add_f32 v18, 1.0, v18
v_mfma_f32_16x16x32_bf16 v[176:179], v[76:79], a[16:19], v[176:179]
s_waitcnt lgkmcnt(3)
ds_read_b64_tr_b16 v[94:95], v57 offset:55296
v_cndmask_b32 v240, 0, v240, vcc
v_cndmask_b32 v241, 0, v241, vcc
v_mfma_f32_16x16x32_bf16 v[160:163], v[80:83], a[32:35], v[160:163]
ds_read_b128 a[184:187], v6 offset:2560
v_add_f32 v19, 1.0, v19
v_mfma_f32_16x16x32_bf16 v[164:167], v[80:83], a[36:39], v[164:167]
ds_read_b64_tr_b16 v[64:65], v56 offset:57344
v_mul_f32 v20, s87, v204
v_mfma_f32_16x16x32_bf16 v[168:171], v[80:83], a[40:43], v[168:171]
s_waitcnt lgkmcnt(4)
ds_read_b64 v[248:249], v5 offset:2624
v_mul_f32 v21, s87, v205
v_mfma_f32_16x16x32_bf16 v[40:43], v[108:111], a[180:183], 0
ds_read_b128 a[188:191], v6 offset:3840
v_mul_f32 v22, s87, v206
v_mfma_f32_16x16x32_bf16 v[44:47], v[112:115], a[180:183], 0
ds_read_b64 v[252:253], v5 offset:3904
v_mul_f32 v23, s87, v207
v_mfma_f32_16x16x32_bf16 v[32:35], v[104:107], v[240:243], v[32:35]
s_waitcnt lgkmcnt(5)
v_cndmask_b32 v244, 0, v244, vcc
v_cndmask_b32 v245, 0, v245, vcc
v_mfma_f32_16x16x32_bf16 v[36:39], v[106:109], v[240:243], v[36:39]
s_waitcnt lgkmcnt(4)
ds_write_b64 v11, v[24:25]
v_mfma_f32_16x16x32_bf16 v[48:51], v[108:111], a[184:187], 0
s_mul_i32 s85, s78, 5120
s_add_u32 s85, s85, 139264
s_mov_b32 s91, 0x358637bd
ds_write_b64 v11, v[28:29] offset:1024
v_lshlrev_b32 v5, 3, v0
v_add_u32 v5, s85, v5
v_lshlrev_b32 v6, 2, v0
v_add_u32 v6, s85, v6
v_mfma_f32_16x16x32_bf16 v[52:55], v[112:115], a[184:187], 0
v_rcp_f32 v16, v16
v_mfma_f32_16x16x32_bf16 v[40:43], v[104:107], v[244:247], v[40:43]
s_waitcnt lgkmcnt(3)
v_cndmask_b32 v248, 0, v248, vcc
v_cndmask_b32 v249, 0, v249, vcc
v_mfma_f32_16x16x32_bf16 v[96:99], v[108:111], a[188:191], 0
v_add_f32 v38, s91, v38
v_mul_f32 v200, v200, v16
v_rcp_f32 v38, v38
v_mfma_f32_16x16x32_bf16 v[100:103], v[112:115], a[188:191], 0
s_waitcnt lgkmcnt(2)
v_cndmask_b32 v252, 0, v252, vcc
v_cndmask_b32 v253, 0, v253, vcc
v_mul_f32 v236, v236, v38
v_mfma_f32_16x16x32_bf16 v[44:47], v[106:109], v[244:247], v[44:47]
v_mul_f32 v32, v32, v236
v_mul_f32 v33, v33, v236
v_mul_f32 v34, v34, v236
v_mul_f32 v35, v35, v236
v_mul_f32 v36, v36, v236
v_mul_f32 v37, v37, v236
v_cvt_pk_bf16_f32 v32, v32, v33
v_cvt_pk_bf16_f32 v33, v34, v35
v_cvt_pk_bf16_f32 v36, v36, v37
v_mfma_f32_16x16x32_bf16 v[48:51], v[104:107], v[248:251], v[48:51]
ds_write_b64 v5, v[32:33]
v_mfma_f32_16x16x32_bf16 v[52:55], v[106:109], v[248:251], v[52:55]
ds_write_b32 v6, v36 offset:2048
v_mfma_f32_16x16x32_bf16 v[96:99], v[104:107], v[252:255], v[96:99]
v_rcp_f32 v17, v17
v_mfma_f32_16x16x32_bf16 v[100:103], v[106:109], v[252:255], v[100:103]
v_add_f32 v46, s91, v46
v_mul_f32 v201, v201, v17
v_rcp_f32 v46, v46
v_mfma_f32_16x16x32_bf16 v[172:175], v[80:83], a[44:47], v[172:175]
ds_read_b64_tr_b16 v[66:67], v56 offset:59392
v_mul_f32 v237, v237, v46
v_mul_f32 v40, v40, v237
v_mul_f32 v41, v41, v237
v_mul_f32 v42, v42, v237
v_mul_f32 v43, v43, v237
v_mul_f32 v44, v44, v237
v_mul_f32 v45, v45, v237
v_cvt_pk_bf16_f32 v40, v40, v41
v_cvt_pk_bf16_f32 v41, v42, v43
v_cvt_pk_bf16_f32 v44, v44, v45
v_mfma_f32_16x16x32_bf16 v[188:191], v[84:87], a[44:47], v[188:191]
ds_write_b64 v5, v[40:41] offset:512
v_add_f32 v54, s91, v54
v_cvt_pk_bf16_f32 v24, v200, v201
v_rcp_f32 v54, v54
v_mfma_f32_16x16x32_bf16 v[184:187], v[84:87], a[40:43], v[184:187]
ds_read_b64_tr_b16 v[68:69], v57 offset:57344
v_mul_f32 v238, v238, v54
v_mul_f32 v48, v48, v238
v_mul_f32 v49, v49, v238
v_mul_f32 v50, v50, v238
v_mul_f32 v51, v51, v238
v_mul_f32 v52, v52, v238
v_mul_f32 v53, v53, v238
v_cvt_pk_bf16_f32 v48, v48, v49
v_cvt_pk_bf16_f32 v49, v50, v51
v_cvt_pk_bf16_f32 v52, v52, v53
v_mfma_f32_16x16x32_bf16 v[180:183], v[84:87], a[36:39], v[180:183]
ds_write_b32 v6, v44 offset:2304
v_add_f32 v102, s91, v102
v_mul_f32 v204, v204, v220
v_rcp_f32 v102, v102
v_mfma_f32_16x16x32_bf16 v[176:179], v[84:87], a[32:35], v[176:179]
s_mul_i32 s85, s79, 10240
ds_read_b64_tr_b16 v[70:71], v57 offset:59392
v_mul_f32 v239, v239, v102
v_mul_f32 v96, v96, v239
v_mul_f32 v97, v97, v239
v_mul_f32 v98, v98, v239
v_mul_f32 v99, v99, v239
v_mul_f32 v100, v100, v239
v_mul_f32 v101, v101, v239
v_cvt_pk_bf16_f32 v96, v96, v97
v_mfma_f32_16x16x32_bf16 v[160:163], v[88:91], a[48:51], v[160:163]
s_add_u32 s85, s85, 139264
ds_write_b64 v5, v[48:49] offset:1024
v_mfma_f32_16x16x32_bf16 v[164:167], v[88:91], a[52:55], v[164:167]
ds_read_b64_tr_b16 v[72:73], v56 offset:61440
v_cvt_pk_bf16_f32 v97, v98, v99
v_mfma_f32_16x16x32_bf16 v[168:171], v[88:91], a[56:59], v[168:171]
ds_write_b32 v6, v52 offset:2560
v_mfma_f32_16x16x32_bf16 v[172:175], v[88:91], a[60:63], v[172:175]
ds_read_b64_tr_b16 v[74:75], v56 offset:63488
v_cvt_pk_bf16_f32 v100, v100, v101
v_mfma_f32_16x16x32_bf16 v[188:191], v[92:95], a[60:63], v[188:191]
ds_write_b64 v5, v[96:97] offset:1536
v_rcp_f32 v18, v18
v_mfma_f32_16x16x32_bf16 v[184:187], v[92:95], a[56:59], v[184:187]
ds_read_b64_tr_b16 v[76:77], v57 offset:61440
v_lshlrev_b32 v5, 3, v0
v_mfma_f32_16x16x32_bf16 v[180:183], v[92:95], a[52:55], v[180:183]
s_waitcnt lgkmcnt(4)
ds_write_b32 v6, v100 offset:2816
v_rcp_f32 v19, v19
v_mfma_f32_16x16x32_bf16 v[176:179], v[92:95], a[48:51], v[176:179]
s_waitcnt vmcnt(10)
ds_read_b64_tr_b16 v[78:79], v57 offset:63488
v_add_u32 v5, s85, v5
v_mul_f32 v202, v202, v18
v_mfma_f32_16x16x32_bf16 v[160:163], v[64:67], a[64:67], v[160:163]
s_barrier
v_mfma_f32_16x16x32_bf16 v[164:167], v[64:67], a[68:71], v[164:167]
s_add_u32 m0, s90, 81920
s_add_u32 s81, s82, 147712
ds_read_b64_tr_b16 v[80:81], v58
v_lshrrev_b32 v6, 4, v0
v_mul_f32 v203, v203, v19
v_mfma_f32_16x16x32_bf16 v[168:171], v[64:67], a[72:75], v[168:171]
buffer_load_dwordx4 v12, s[52:55], s81 offen lds
v_cvt_pk_bf16_f32 v25, v202, v203
v_exp_f32 v20, v20
v_mfma_f32_16x16x32_bf16 v[172:175], v[64:67], a[76:79], v[172:175]
s_add_u32 m0, s90, 86016
ds_read_b64_tr_b16 v[82:83], v58 offset:2048
v_lshlrev_b32 v6, 8, v6
v_mfma_f32_16x16x32_bf16 v[188:191], v[68:71], a[76:79], v[188:191]
s_add_u32 s81, s82, 184576
ds_write_b64 v11, v[24:25] offset:2048
v_and_b32 v7, 15, v0
v_lshl_add_u32 v6, v7, 2, v6
v_mfma_f32_16x16x32_bf16 v[184:187], v[68:71], a[72:75], v[184:187]
s_waitcnt lgkmcnt(2)
ds_read_b64_tr_b16 v[84:85], v59
v_add_u32 v6, s85, v6
v_exp_f32 v21, v21
v_mfma_f32_16x16x32_bf16 v[180:183], v[68:71], a[68:71], v[180:183]
buffer_load_dwordx4 v12, s[52:55], s81 offen lds
v_mul_f32 v205, v205, v221
v_mfma_f32_16x16x32_bf16 v[176:179], v[68:71], a[64:67], v[176:179]
s_add_u32 m0, s90, 90112
ds_read_b64_tr_b16 v[86:87], v59 offset:2048
v_mul_f32 v206, v206, v222
v_mfma_f32_16x16x32_bf16 v[160:163], v[72:75], a[80:83], v[160:163]
s_add_u32 s81, s82, 221440
v_exp_f32 v22, v22
v_mfma_f32_16x16x32_bf16 v[164:167], v[72:75], a[84:87], v[164:167]
s_waitcnt lgkmcnt(2)
ds_read_b64_tr_b16 v[88:89], v58 offset:4096
v_mul_f32 v207, v207, v223
v_exp_f32 v23, v23
v_mfma_f32_16x16x32_bf16 v[168:171], v[72:75], a[88:91], v[168:171]
buffer_load_dwordx4 v12, s[52:55], s81 offen lds
v_add_f32 v20, 1.0, v20
v_mfma_f32_16x16x32_bf16 v[172:175], v[72:75], a[92:95], v[172:175]
s_add_u32 m0, s90, 94208
ds_read_b64_tr_b16 v[90:91], v58 offset:6144
v_add_f32 v21, 1.0, v21
v_mfma_f32_16x16x32_bf16 v[188:191], v[76:79], a[92:95], v[188:191]
s_add_u32 s81, s82, 258304
v_add_f32 v22, 1.0, v22
v_add_f32 v23, 1.0, v23
v_mfma_f32_16x16x32_bf16 v[184:187], v[76:79], a[88:91], v[184:187]
ds_read_b64_tr_b16 v[92:93], v59 offset:4096
v_rcp_f32 v20, v20
v_mfma_f32_16x16x32_bf16 v[180:183], v[76:79], a[84:87], v[180:183]
buffer_load_dwordx4 v12, s[52:55], s81 offen lds
v_rcp_f32 v21, v21
v_mfma_f32_16x16x32_bf16 v[176:179], v[76:79], a[80:83], v[176:179]
s_add_u32 m0, s90, 98304
ds_read_b64_tr_b16 v[94:95], v59 offset:6144
v_mul_f32 v204, v204, v20
v_mfma_f32_16x16x32_bf16 v[128:131], v[80:83], a[96:99], v[128:131]
s_add_u32 s81, s93, 256
v_rcp_f32 v22, v22
v_mfma_f32_16x16x32_bf16 v[132:135], v[80:83], a[100:103], v[132:135]
s_waitcnt lgkmcnt(1)
ds_read_b64_tr_b16 v[64:65], v58 offset:8192
v_mul_f32 v205, v205, v21
v_mfma_f32_16x16x32_bf16 v[136:139], v[80:83], a[104:107], v[136:139]
buffer_load_dwordx4 v12, s[52:55], s81 offen lds
v_rcp_f32 v23, v23
v_mfma_f32_16x16x32_bf16 v[140:143], v[80:83], a[108:111], v[140:143]
s_add_u32 m0, s90, 102400
ds_read_b64_tr_b16 v[66:67], v58 offset:10240
v_mul_f32 v206, v206, v22
v_mfma_f32_16x16x32_bf16 v[156:159], v[84:87], a[108:111], v[156:159]
s_add_u32 s81, s89, 256
v_mul_f32 v207, v207, v23
v_cvt_pk_bf16_f32 v28, v204, v205
v_mfma_f32_16x16x32_bf16 v[152:155], v[84:87], a[104:107], v[152:155]
ds_read_b64_tr_b16 v[68:69], v59 offset:8192
v_cvt_pk_bf16_f32 v29, v206, v207
v_mfma_f32_16x16x32_bf16 v[148:151], v[84:87], a[100:103], v[148:151]
buffer_load_dwordx4 v1, s[56:59], s81 offen lds
v_mfma_f32_16x16x32_bf16 v[144:147], v[84:87], a[96:99], v[144:147]
ds_read_b64_tr_b16 v[70:71], v59 offset:10240
ds_write_b64 v11, v[28:29] offset:3072
v_mfma_f32_16x16x32_bf16 v[128:131], v[88:91], a[112:115], v[128:131]
v_mfma_f32_16x16x32_bf16 v[132:135], v[88:91], a[116:119], v[132:135]
ds_read_b64_tr_b16 v[72:73], v58 offset:12288
v_mfma_f32_16x16x32_bf16 v[136:139], v[88:91], a[120:123], v[136:139]
v_mfma_f32_16x16x32_bf16 v[140:143], v[88:91], a[124:127], v[140:143]
s_waitcnt lgkmcnt(3)
ds_read_b64_tr_b16 v[74:75], v58 offset:14336
v_mfma_f32_16x16x32_bf16 v[156:159], v[92:95], a[124:127], v[156:159]
v_mfma_f32_16x16x32_bf16 v[152:155], v[92:95], a[120:123], v[152:155]
ds_read_b64_tr_b16 v[76:77], v59 offset:12288
v_mfma_f32_16x16x32_bf16 v[148:151], v[92:95], a[116:119], v[148:151]
v_mfma_f32_16x16x32_bf16 v[144:147], v[92:95], a[112:115], v[144:147]
s_waitcnt lgkmcnt(3) vmcnt(10)
ds_read_b64_tr_b16 v[78:79], v59 offset:14336
v_mfma_f32_16x16x32_bf16 v[160:163], v[64:67], a[96:99], v[160:163]
s_barrier
v_mfma_f32_16x16x32_bf16 v[164:167], v[64:67], a[100:103], v[164:167]
s_add_u32 m0, s90, 106496
ds_read_b64_tr_b16 v[80:81], v58 offset:16384
v_mfma_f32_16x16x32_bf16 v[168:171], v[64:67], a[104:107], v[168:171]
s_add_u32 s81, s89, 256
ds_read_b128 a[128:131], v3
v_mfma_f32_16x16x32_bf16 v[172:175], v[64:67], a[108:111], v[172:175]
ds_read_b64_tr_b16 v[82:83], v58 offset:18432
v_mfma_f32_16x16x32_bf16 v[188:191], v[68:71], a[108:111], v[188:191]
buffer_load_dwordx4 v13, s[56:59], s81 offen lds
v_mfma_f32_16x16x32_bf16 v[184:187], v[68:71], a[104:107], v[184:187]
s_add_u32 m0, s90, 110592
ds_read_b64_tr_b16 v[84:85], v59 offset:16384
v_mfma_f32_16x16x32_bf16 v[180:183], v[68:71], a[100:103], v[180:183]
s_add_u32 s81, s82, 384
ds_read_b128 a[132:135], v3 offset:1024
v_mfma_f32_16x16x32_bf16 v[176:179], v[68:71], a[96:99], v[176:179]
s_waitcnt lgkmcnt(4)
ds_read_b64_tr_b16 v[86:87], v59 offset:18432
v_mfma_f32_16x16x32_bf16 v[160:163], v[72:75], a[112:115], v[160:163]
buffer_load_dwordx4 v12, s[52:55], s81 offen lds
v_mfma_f32_16x16x32_bf16 v[164:167], v[72:75], a[116:119], v[164:167]
s_add_u32 m0, s90, 114688
ds_read_b64_tr_b16 v[88:89], v58 offset:20480
v_mfma_f32_16x16x32_bf16 v[168:171], v[72:75], a[120:123], v[168:171]
s_add_u32 s81, s82, 37248
ds_read_b128 a[136:139], v3 offset:2048
v_mfma_f32_16x16x32_bf16 v[172:175], v[72:75], a[124:127], v[172:175]
ds_read_b64_tr_b16 v[90:91], v58 offset:22528
v_mfma_f32_16x16x32_bf16 v[188:191], v[76:79], a[124:127], v[188:191]
buffer_load_dwordx4 v12, s[52:55], s81 offen lds
v_mfma_f32_16x16x32_bf16 v[184:187], v[76:79], a[120:123], v[184:187]
s_add_u32 m0, s90, 118784
ds_read_b64_tr_b16 v[92:93], v59 offset:20480
ds_read_b128 a[140:143], v3 offset:3072
ds_read_b64 a[144:145], v5
ds_read_b64 a[146:147], v5 offset:5120
ds_read_b64 a[148:149], v5 offset:512
ds_read_b64 a[150:151], v5 offset:5632
ds_read_b64 a[152:153], v5 offset:1024
ds_read_b64 a[154:155], v5 offset:6144
ds_read_b64 a[156:157], v5 offset:1536
ds_read_b64 a[158:159], v5 offset:6656
ds_read_b32 a160, v6 offset:2048
ds_read_b32 a161, v6 offset:7168
v_mfma_f32_16x16x32_bf16 v[180:183], v[76:79], a[116:119], v[180:183]
s_add_u32 s81, s82, 74112
v_mfma_f32_16x16x32_bf16 v[176:179], v[76:79], a[112:115], v[176:179]
s_waitcnt lgkmcnt(14)
ds_read_b64_tr_b16 v[94:95], v59 offset:22528
v_mfma_f32_16x16x32_bf16 v[128:131], v[80:83], a[128:131], v[128:131]
buffer_load_dwordx4 v12, s[52:55], s81 offen lds
v_mfma_f32_16x16x32_bf16 v[132:135], v[80:83], a[132:135], v[132:135]
s_add_u32 m0, s90, 122880
ds_read_b64_tr_b16 v[64:65], v62 offset:24576
v_add_u32 v112, 98304, v58
s_waitcnt lgkmcnt(14)
v_mfma_f32_16x16x32_bf16 v[136:139], v[80:83], a[136:139], v[136:139]
s_add_u32 s81, s82, 110976
v_add_u32 v114, 98304, v62
v_add_u32 v113, 98304, v59
s_waitcnt lgkmcnt(12)
v_mfma_f32_16x16x32_bf16 v[140:143], v[80:83], a[140:143], v[140:143]
buffer_load_dwordx4 v12, s[52:55], s81 offen lds
v_mfma_f32_16x16x32_bf16 v[156:159], v[84:87], a[140:143], v[156:159]
s_add_u32 m0, s90, 126976
v_add_u32 v115, 98304, v63
v_and_b32 v5, 15, v0
v_mfma_f32_16x16x32_bf16 v[152:155], v[84:87], a[136:139], v[152:155]
s_add_u32 s81, s82, 147840
ds_read_b64_tr_b16 v[68:69], v63 offset:24576
v_lshlrev_b32 v5, 6, v5
v_mfma_f32_16x16x32_bf16 v[148:151], v[84:87], a[132:135], v[148:151]
buffer_load_dwordx4 v12, s[52:55], s81 offen lds
v_mfma_f32_16x16x32_bf16 v[144:147], v[84:87], a[128:131], v[144:147]
s_add_u32 m0, s90, 49152
v_lshrrev_b32 v6, 4, v0
v_lshl_add_u32 v5, v6, 4, v5
s_waitcnt lgkmcnt(1)
v_mfma_f32_16x16x32_bf16 v[128:131], v[88:91], a[144:147], v[128:131]
s_add_u32 s81, s82, 184704
s_mul_i32 s85, s77, 144
s_lshl_b32 s86, s80, 3
s_add_u32 s85, s85, s86
s_lshl_b32 s86, s79, 2
s_add_u32 s85, s85, s86
s_lshl_b32 s85, s85, 4
s_add_u32 s85, s85, s76
s_lshl_b32 s85, s85, 10
v_add_u32 v116, s85, v5
v_mfma_f32_16x16x32_bf16 v[132:135], v[88:91], a[148:151], v[132:135]
s_bfe_u32 s85, s76, 0x20001
ds_read_b64_tr_b16 v[72:73], v58 offset:28672
v_add_u32 v117, 16384, v116
v_mfma_f32_16x16x32_bf16 v[136:139], v[88:91], a[152:155], v[136:139]
buffer_load_dwordx4 v12, s[52:55], s81 offen lds
v_add_u32 v118, 32768, v116
v_add_u32 v119, 49152, v116
v_mfma_f32_16x16x32_bf16 v[140:143], v[88:91], a[156:159], v[140:143]
s_add_u32 m0, s90, 53248
ds_read_b64_tr_b16 v[74:75], v58 offset:30720
v_and_b32 v5, 15, v0
v_mfma_f32_16x16x32_bf16 v[156:159], v[92:95], a[156:159], v[156:159]
s_add_u32 s81, s82, 221568
v_lshrrev_b32 v6, 1, v5
v_lshrrev_b32 v7, 4, v0
v_mfma_f32_16x16x32_bf16 v[152:155], v[92:95], a[152:155], v[152:155]
s_cmp_eq_u32 s85, 1
s_cselect_b64 s[32:33], -1, 0
ds_read_b64_tr_b16 v[76:77], v59 offset:28672
v_add_u32 v7, v6, v7
v_mfma_f32_16x16x32_bf16 v[148:151], v[92:95], a[148:151], v[148:151]
s_cmp_eq_u32 s85, 2
s_cselect_b64 s[34:35], -1, 0
s_cmp_eq_u32 s85, 3
s_cselect_b64 s[36:37], -1, 0
s_lshr_b32 s86, s76, 3
s_lshl_b32 s86, s86, 1
s_and_b32 s91, s76, 1
s_add_u32 s86, s86, s91
s_cmp_eq_u32 s86, s78
s_cselect_b32 s38, 1024, 0
s_cselect_b32 s86, 0, 9216
s_cselect_b32 s85, s85, 7
s_add_u32 s86, s86, 147456
buffer_load_dwordx4 v12, s[52:55], s81 offen lds
v_and_b32 v7, 3, v7
v_lshlrev_b32 v6, 6, v5
v_mfma_f32_16x16x32_bf16 v[144:147], v[92:95], a[144:147], v[144:147]
s_lshl_b32 s91, s78, 1
ds_read_b64_tr_b16 v[78:79], v59 offset:30720
v_lshl_add_u32 v6, v7, 4, v6
v_mfma_f32_16x16x4_4b_bf16 v[128:143], v[64:65], a[160:161], v[128:143]
s_waitcnt lgkmcnt(3)
v_add_u32 v28, s86, v6
v_lshrrev_b32 v6, 3, v5
s_lshl_b32 s86, s78, 8
ds_read_b64_tr_b16 v[80:81], v58 offset:32768
v_add3_u32 v6, v6, v5, s91
s_add_u32 s86, s86, 147456
v_and_b32 v6, 3, v6
v_and_b32 v5, 12, v5
ds_read_b64_tr_b16 v[82:83], v58 offset:34816
v_add_u32 v5, v5, v6
v_mfma_f32_16x16x4_4b_bf16 v[144:159], v[68:69], a[160:161], v[144:159]
s_waitcnt lgkmcnt(4)
v_lshlrev_b32 v5, 4, v5
v_add_u32 v29, s86, v5
s_mov_b32 s86, 2146435072
s_cmp_eq_u32 s85, 0
s_cselect_b32 s91, s86, 0
ds_read_b64_tr_b16 v[84:85], v59 offset:32768
v_max_u32 v116, s91, v116
s_cmp_eq_u32 s85, 1
s_cselect_b32 s91, s86, 0
v_max_u32 v117, s91, v117
s_cmp_eq_u32 s85, 2
s_cselect_b32 s91, s86, 0
ds_read_b64_tr_b16 v[86:87], v59 offset:34816
v_max_u32 v118, s91, v118
s_cmp_eq_u32 s85, 3
s_cselect_b32 s91, s86, 0
v_max_u32 v119, s91, v119
v_mfma_f32_16x16x32_bf16 v[160:163], v[72:75], a[128:131], v[160:163]
s_add_u32 s48, s22, 0
s_addc_u32 s49, s23, 0
v_bfe_u32 v5, v0, 2, 2
v_mfma_f32_16x16x32_bf16 v[164:167], v[72:75], a[132:135], v[164:167]
s_mov_b32 s50, 2359296
ds_read_b64_tr_b16 v[88:89], v62 offset:36864
v_mfma_f32_16x16x32_bf16 v[168:171], v[72:75], a[136:139], v[168:171]
s_mov_b32 s98, 0
s_mov_b32 s51, 0x20000
s_lshr_b32 s85, s76, 1
s_lshl_b32 s85, s85, 4
s_lshl_b32 s86, s78, 2
s_add_u32 s85, s85, s86
v_cvt_pk_bf16_f32 v192, v128, v129
v_cvt_pk_bf16_f32 v193, v130, v131
v_add_u32 v5, s85, v5
v_lshlrev_b32 v6, 2, v5
v_mfma_f32_16x16x32_bf16 v[172:175], v[72:75], a[140:143], v[172:175]
s_lshl_b32 s85, s77, 7
v_cvt_pk_bf16_f32 v194, v144, v145
v_cvt_pk_bf16_f32 v195, v146, v147
s_waitcnt lgkmcnt(5)
v_mfma_f32_16x16x32_bf16 v[188:191], v[76:79], a[140:143], v[188:191]
s_and_b32 s86, s76, 1
buffer_store_dwordx4 v[192:195], v116, s[60:63], s98 offen sc1
v_mfma_f32_16x16x32_bf16 v[184:187], v[76:79], a[136:139], v[184:187]
ds_read_b64_tr_b16 v[92:93], v63 offset:36864
v_cvt_pk_bf16_f32 v196, v132, v133
v_mfma_f32_16x16x32_bf16 v[180:183], v[76:79], a[132:135], v[180:183]
s_waitcnt lgkmcnt(1)
v_cvt_pk_bf16_f32 v197, v134, v135
v_cvt_pk_bf16_f32 v198, v148, v149
v_mfma_f32_16x16x32_bf16 v[176:179], v[76:79], a[128:131], v[176:179]
s_waitcnt vmcnt(13)
v_cvt_pk_bf16_f32 v199, v150, v151
v_cvt_pk_bf16_f32 v200, v136, v137
v_mfma_f32_16x16x32_bf16 v[160:163], v[80:83], a[144:147], v[160:163]
s_barrier
v_mfma_f32_16x16x32_bf16 v[164:167], v[80:83], a[148:151], v[164:167]
s_add_u32 m0, s90, 57344
s_add_u32 s81, s82, 258432
ds_read_b64_tr_b16 v[64:65], v58 offset:40960
v_cvt_pk_bf16_f32 v201, v138, v139
v_mfma_f32_16x16x32_bf16 v[168:171], v[80:83], a[152:155], v[168:171]
buffer_load_dwordx4 v12, s[52:55], s81 offen lds
v_add_u32 v6, 159744, v6
v_add_u32 v5, s85, v5
v_mfma_f32_16x16x32_bf16 v[172:175], v[80:83], a[156:159], v[172:175]
s_add_u32 m0, s90, 61440
ds_read_b64_tr_b16 v[66:67], v58 offset:43008
v_cvt_pk_bf16_f32 v202, v152, v153
v_mfma_f32_16x16x32_bf16 v[188:191], v[84:87], a[156:159], v[188:191]
s_add_u32 s81, s93, 384
buffer_store_dwordx4 v[196:199], v117, s[60:63], s98 offen sc1
v_mfma_f32_16x16x32_bf16 v[184:187], v[84:87], a[152:155], v[184:187]
s_lshl_b32 s85, s86, 6
ds_read_b64_tr_b16 v[68:69], v59 offset:40960
v_cvt_pk_bf16_f32 v203, v154, v155
v_mfma_f32_16x16x32_bf16 v[180:183], v[84:87], a[148:151], v[180:183]
s_lshl_b32 s86, s86, 3
buffer_load_dwordx4 v12, s[52:55], s81 offen lds
v_mul_u32_u24 v5, 1152, v5
v_mfma_f32_16x16x32_bf16 v[176:179], v[84:87], a[144:147], v[176:179]
s_add_u32 m0, s90, 131072
ds_read_b64_tr_b16 v[70:71], v59 offset:43008
v_cvt_pk_bf16_f32 v204, v140, v141
v_mfma_f32_16x16x4_4b_bf16 v[160:175], v[88:89], a[160:161], v[160:175]
s_add_u32 s81, s89, 384
ds_read_b32 v122, v6
v_cvt_pk_bf16_f32 v205, v142, v143
v_cvt_pk_bf16_f32 v206, v156, v157
ds_read_b64_tr_b16 v[72:73], v58 offset:45056
v_cvt_pk_bf16_f32 v207, v158, v159
buffer_load_dwordx4 v1, s[56:59], s81 offen lds
v_and_b32 v6, 3, v0
v_lshl_add_u32 v5, v6, 3, v5
s_add_u32 m0, s90, 135168
ds_read_b64_tr_b16 v[74:75], v58 offset:47104
v_lshrrev_b32 v6, 5, v0
s_waitcnt lgkmcnt(6)
v_mfma_f32_16x16x4_4b_bf16 v[176:191], v[92:93], a[160:161], v[176:191]
s_add_u32 s81, s89, 384
buffer_store_dwordx4 v[200:203], v118, s[60:63], s98 offen sc1
ds_read_b64_tr_b16 v[76:77], v59 offset:45056
v_lshl_add_u32 v5, v6, 5, v5
buffer_load_dwordx4 v13, s[56:59], s81 offen lds
v_bfe_u32 v6, v0, 4, 1
v_lshl_add_u32 v5, v6, 2, v5
buffer_store_dwordx4 v[204:207], v119, s[60:63], s98 offen sc1
s_add_u32 m0, s90, 0
ds_read_b64_tr_b16 v[78:79], v59 offset:47104
v_add_u32 v121, s85, v5
s_waitcnt lgkmcnt(7)
v_mfma_f32_16x16x32_bf16 v[128:131], v[64:67], a[0:3], 0
s_add_u32 s81, s82, 512
s_mul_i32 s85, s77, 144
s_add_u32 s85, s85, s86
s_lshr_b32 s86, s76, 1
s_add_u32 s85, s85, s86
s_lshl_b32 s85, s85, 14
s_lshl_b32 s86, s78, 8
s_add_u32 s85, s85, s86
s_mov_b32 s86, 2146435072
s_mov_b32 s91, 0x42700000
buffer_load_dwordx4 v12, s[52:55], s81 offen lds
v_cndmask_b32 v16, v192, v196, s[32:33]
v_cndmask_b32 v17, v193, v197, s[32:33]
v_lshrrev_b32 v5, 4, v0
v_lshlrev_b32 v5, 10, v5
v_and_b32 v6, 15, v0
v_lshl_add_u32 v5, v6, 4, v5
v_add_u32 v120, s85, v5
v_mov_b32 v5, s86
v_mov_b32 v7, s27
v_cmp_eq_u32 vcc, 0, v0
s_waitcnt lgkmcnt(4)
v_min_f32 v122, s91, v122
v_mul_f32 v122, s88, v122
v_exp_f32 v122, v122
v_add_u32 v11, 12288, v120
v_mfma_f32_16x16x32_bf16 v[132:135], v[64:67], a[4:7], 0
s_add_u32 m0, s90, 4096
s_andn2_b32 s85, s27, 255
ds_read_b64_tr_b16 v[80:81], v56
v_cndmask_b32 v18, v194, v198, s[32:33]
v_add_f32 v122, 1.0, v122
v_rcp_f32 v122, v122
v_mfma_f32_16x16x32_bf16 v[136:139], v[64:67], a[8:11], 0
s_add_u32 s81, s82, 37376
s_mov_b32 s98, 262144
v_cndmask_b32 v19, v195, v199, s[32:33]
v_cndmask_b32 v16, v16, v200, s[34:35]
v_cvt_pk_bf16_f32 v208, v160, v161
v_mfma_f32_16x16x32_bf16 v[140:143], v[64:67], a[12:15], 0
ds_read_b64_tr_b16 v[82:83], v56 offset:2048
v_cndmask_b32 v17, v17, v201, s[34:35]
v_cvt_pk_bf16_f32 v209, v162, v163
v_mfma_f32_16x16x32_bf16 v[156:159], v[68:71], a[12:15], 0
buffer_load_dwordx4 v12, s[52:55], s81 offen lds
v_cndmask_b32 v125, v5, v7, vcc
v_mfma_f32_16x16x32_bf16 v[152:155], v[68:71], a[8:11], 0
s_add_u32 m0, s90, 8192
ds_read_b64_tr_b16 v[84:85], v57
v_cndmask_b32 v18, v18, v202, s[34:35]
v_mfma_f32_16x16x32_bf16 v[148:151], v[68:71], a[4:7], 0
s_add_u32 s81, s82, 74240
v_cndmask_b32 v19, v19, v203, s[34:35]
v_cndmask_b32 v16, v16, v204, s[36:37]
v_mfma_f32_16x16x32_bf16 v[144:147], v[68:71], a[0:3], 0
s_waitcnt lgkmcnt(2)
ds_read_b64_tr_b16 v[86:87], v57 offset:2048
v_cndmask_b32 v17, v17, v205, s[36:37]
v_cvt_pk_bf16_f32 v210, v176, v177
v_mfma_f32_16x16x32_bf16 v[128:131], v[72:75], a[16:19], v[128:131]
buffer_load_dwordx4 v12, s[52:55], s81 offen lds
v_lshlrev_b32 v7, 2, v0
v_add_u32 v7, s85, v7
v_mfma_f32_16x16x32_bf16 v[132:135], v[72:75], a[20:23], v[132:135]
s_add_u32 m0, s90, 12288
ds_read_b64_tr_b16 v[88:89], v56 offset:4096
v_cndmask_b32 v18, v18, v206, s[36:37]
v_mfma_f32_16x16x32_bf16 v[136:139], v[72:75], a[24:27], v[136:139]
s_add_u32 s81, s82, 111104
v_cndmask_b32 v19, v19, v207, s[36:37]
v_cvt_pk_bf16_f32 v211, v178, v179
v_cmp_gt_u32 vcc, 16, v0
v_mfma_f32_16x16x32_bf16 v[140:143], v[72:75], a[28:31], v[140:143]
ds_read_b64_tr_b16 v[90:91], v56 offset:6144
v_cvt_pk_bf16_f32 v212, v164, v165
v_add_u32 v31, 8192, v120
v_mfma_f32_16x16x32_bf16 v[156:159], v[76:79], a[28:31], v[156:159]
buffer_load_dwordx4 v12, s[52:55], s81 offen lds
v_cndmask_b32 v123, v5, v7, vcc
v_lshrrev_b32 v7, 4, v0
v_mfma_f32_16x16x32_bf16 v[152:155], v[76:79], a[24:27], v[152:155]
ds_read_b64_tr_b16 v[92:93], v57 offset:4096
v_cvt_pk_bf16_f32 v213, v166, v167
v_mov_b32 v5, 2146435072
v_mfma_f32_16x16x32_bf16 v[148:151], v[76:79], a[20:23], v[148:151]
ds_write_b64 v28, v[16:17]
v_mfma_f32_16x16x32_bf16 v[144:147], v[76:79], a[16:19], v[144:147]
s_waitcnt lgkmcnt(3)
ds_read_b64_tr_b16 v[94:95], v57 offset:6144
v_cvt_pk_bf16_f32 v214, v180, v181
v_add_u32 v6, 12, v7
v_mfma_f32_16x16x32_bf16 v[128:131], v[80:83], a[32:35], v[128:131]
ds_write_b64 v28, v[18:19] offset:8
v_mfma_f32_16x16x32_bf16 v[132:135], v[80:83], a[36:39], v[132:135]
ds_read_b64_tr_b16 v[64:65], v56 offset:8192
v_add_u32 v28, s38, v28
v_mfma_f32_16x16x32_bf16 v[136:139], v[80:83], a[40:43], v[136:139]
buffer_store_dwordx4 v[208:211], v116, s[60:63], s98 offen sc1
v_cmp_eq_u32 vcc, s76, v6
v_add_u32 v6, 8, v7
v_mfma_f32_16x16x32_bf16 v[140:143], v[80:83], a[44:47], v[140:143]
ds_read_b64_tr_b16 v[66:67], v56 offset:10240
v_cvt_pk_bf16_f32 v215, v182, v183
v_add_u32 v30, 4096, v120
v_mfma_f32_16x16x32_bf16 v[156:159], v[84:87], a[44:47], v[156:159]
v_cvt_pk_bf16_f32 v216, v168, v169
v_cvt_pk_bf16_f32 v217, v170, v171
v_cndmask_b32 v11, v11, v5, vcc
v_cmp_eq_u32 vcc, s76, v6
v_mfma_f32_16x16x32_bf16 v[152:155], v[84:87], a[40:43], v[152:155]
ds_read_b64_tr_b16 v[68:69], v57 offset:8192
v_cvt_pk_bf16_f32 v218, v184, v185
v_add_u32 v6, 4, v7
v_mfma_f32_16x16x32_bf16 v[148:151], v[84:87], a[36:39], v[148:151]
v_cvt_pk_bf16_f32 v219, v186, v187
v_cvt_pk_bf16_f32 v220, v172, v173
v_cndmask_b32 v31, v31, v5, vcc
v_cmp_eq_u32 vcc, s76, v6
v_mfma_f32_16x16x32_bf16 v[144:147], v[84:87], a[32:35], v[144:147]
s_waitcnt lgkmcnt(2)
ds_read_b64_tr_b16 v[70:71], v57 offset:10240
v_cvt_pk_bf16_f32 v221, v174, v175
v_add_u32 v6, 0, v7
v_mfma_f32_16x16x32_bf16 v[128:131], v[88:91], a[48:51], v[128:131]
v_cvt_pk_bf16_f32 v222, v188, v189
v_cvt_pk_bf16_f32 v223, v190, v191
v_cndmask_b32 v30, v30, v5, vcc
v_cmp_eq_u32 vcc, s76, v6
v_mfma_f32_16x16x32_bf16 v[132:135], v[88:91], a[52:55], v[132:135]
ds_read_b64_tr_b16 v[72:73], v56 offset:12288
v_add_u32 v120, 0, v120
v_mfma_f32_16x16x32_bf16 v[136:139], v[88:91], a[56:59], v[136:139]
buffer_store_dwordx4 v[212:215], v117, s[60:63], s98 offen sc1
v_cndmask_b32 v120, v120, v5, vcc
v_cmp_gt_u32 vcc, 16, v0
v_mfma_f32_16x16x32_bf16 v[140:143], v[88:91], a[60:63], v[140:143]
ds_read_b64_tr_b16 v[74:75], v56 offset:14336
v_mfma_f32_16x16x32_bf16 v[156:159], v[92:95], a[60:63], v[156:159]
v_cndmask_b32 v20, 0, v228, vcc
v_cndmask_b32 v21, 0, v229, vcc
v_cndmask_b32 v22, 0, v230, vcc
v_mfma_f32_16x16x32_bf16 v[152:155], v[92:95], a[56:59], v[152:155]
ds_read_b64_tr_b16 v[76:77], v57 offset:12288
v_cndmask_b32 v23, 0, v231, vcc
v_mfma_f32_16x16x32_bf16 v[148:151], v[92:95], a[52:55], v[148:151]
s_waitcnt lgkmcnt(2)
v_mfma_f32_16x16x32_bf16 v[144:147], v[92:95], a[48:51], v[144:147]
s_waitcnt vmcnt(21)
ds_read_b64_tr_b16 v[78:79], v57 offset:14336
v_mfma_f32_16x16x32_bf16 v[128:131], v[64:67], a[64:67], v[128:131]
s_barrier
v_mfma_f32_16x16x32_bf16 v[132:135], v[64:67], a[68:71], v[132:135]
s_add_u32 m0, s90, 16384
ds_read_b64_tr_b16 v[80:81], v56 offset:16384
v_mfma_f32_16x16x32_bf16 v[136:139], v[64:67], a[72:75], v[136:139]
s_add_u32 s81, s82, 147968
buffer_store_dwordx4 v[216:219], v118, s[60:63], s98 offen sc1
v_mfma_f32_16x16x32_bf16 v[140:143], v[64:67], a[76:79], v[140:143]
ds_read_b64_tr_b16 v[82:83], v56 offset:18432
v_mfma_f32_16x16x32_bf16 v[156:159], v[68:71], a[76:79], v[156:159]
buffer_load_dwordx4 v12, s[52:55], s81 offen lds
v_mfma_f32_16x16x32_bf16 v[152:155], v[68:71], a[72:75], v[152:155]
s_add_u32 m0, s90, 20480
ds_read_b64_tr_b16 v[84:85], v57 offset:16384
buffer_store_dwordx4 v[220:223], v119, s[60:63], s98 offen sc1
v_mfma_f32_16x16x32_bf16 v[148:151], v[68:71], a[68:71], v[148:151]
s_add_u32 s81, s82, 184832
v_mfma_f32_16x16x32_bf16 v[144:147], v[68:71], a[64:67], v[144:147]
s_waitcnt lgkmcnt(2)
ds_read_b64_tr_b16 v[86:87], v57 offset:18432
v_mfma_f32_16x16x32_bf16 v[128:131], v[72:75], a[80:83], v[128:131]
buffer_load_dwordx4 v12, s[52:55], s81 offen lds
v_mfma_f32_16x16x32_bf16 v[132:135], v[72:75], a[84:87], v[132:135]
s_add_u32 m0, s90, 24576
ds_read_b64_tr_b16 v[88:89], v56 offset:20480
v_cndmask_b32 v16, v208, v212, s[32:33]
v_mfma_f32_16x16x32_bf16 v[136:139], v[72:75], a[88:91], v[136:139]
s_add_u32 s81, s82, 221696
v_cndmask_b32 v17, v209, v213, s[32:33]
v_cndmask_b32 v18, v210, v214, s[32:33]
v_mfma_f32_16x16x32_bf16 v[140:143], v[72:75], a[92:95], v[140:143]
ds_read_b64_tr_b16 v[90:91], v56 offset:22528
v_cndmask_b32 v19, v211, v215, s[32:33]
v_mfma_f32_16x16x32_bf16 v[156:159], v[76:79], a[92:95], v[156:159]
buffer_load_dwordx4 v12, s[52:55], s81 offen lds
v_mfma_f32_16x16x32_bf16 v[152:155], v[76:79], a[88:91], v[152:155]
s_add_u32 m0, s90, 28672
ds_read_b64_tr_b16 v[92:93], v57 offset:20480
v_cndmask_b32 v16, v16, v216, s[34:35]
v_mfma_f32_16x16x32_bf16 v[148:151], v[76:79], a[84:87], v[148:151]
s_add_u32 s81, s82, 258560
v_cndmask_b32 v17, v17, v217, s[34:35]
v_cndmask_b32 v18, v18, v218, s[34:35]
v_mfma_f32_16x16x32_bf16 v[144:147], v[76:79], a[80:83], v[144:147]
s_waitcnt lgkmcnt(2)
ds_read_b64_tr_b16 v[94:95], v57 offset:22528
v_cndmask_b32 v19, v19, v219, s[34:35]
v_mfma_f32_16x16x32_bf16 v[128:131], v[80:83], a[96:99], v[128:131]
buffer_load_dwordx4 v12, s[52:55], s81 offen lds
v_mfma_f32_16x16x32_bf16 v[132:135], v[80:83], a[100:103], v[132:135]
s_add_u32 m0, s90, 139264
ds_read_b64_tr_b16 v[64:65], v56 offset:24576
v_cndmask_b32 v16, v16, v220, s[36:37]
v_mfma_f32_16x16x32_bf16 v[136:139], v[80:83], a[104:107], v[136:139]
s_add_u32 s81, s93, 512
v_cndmask_b32 v17, v17, v221, s[36:37]
v_cndmask_b32 v18, v18, v222, s[36:37]
v_mfma_f32_16x16x32_bf16 v[140:143], v[80:83], a[108:111], v[140:143]
ds_read_b64_tr_b16 v[66:67], v56 offset:26624
v_cndmask_b32 v19, v19, v223, s[36:37]
v_mfma_f32_16x16x32_bf16 v[156:159], v[84:87], a[108:111], v[156:159]
buffer_load_dwordx4 v12, s[52:55], s81 offen lds
v_mfma_f32_16x16x32_bf16 v[152:155], v[84:87], a[104:107], v[152:155]
s_add_u32 m0, s90, 143360
ds_read_b64_tr_b16 v[68:69], v57 offset:24576
v_mfma_f32_16x16x32_bf16 v[148:151], v[84:87], a[100:103], v[148:151]
s_add_u32 s81, s89, 512
ds_write_b64 v28, v[16:17]
v_mfma_f32_16x16x32_bf16 v[144:147], v[84:87], a[96:99], v[144:147]
s_waitcnt lgkmcnt(3)
ds_read_b64_tr_b16 v[70:71], v57 offset:26624
v_mfma_f32_16x16x32_bf16 v[128:131], v[88:91], a[112:115], v[128:131]
buffer_load_dwordx4 v1, s[56:59], s81 offen lds
v_mfma_f32_16x16x32_bf16 v[132:135], v[88:91], a[116:119], v[132:135]
s_add_u32 m0, s90, 32768
ds_read_b64_tr_b16 v[72:73], v56 offset:28672
v_mfma_f32_16x16x32_bf16 v[136:139], v[88:91], a[120:123], v[136:139]
s_add_u32 s81, s89, 512
ds_write_b64 v28, v[18:19] offset:8
v_mfma_f32_16x16x32_bf16 v[140:143], v[88:91], a[124:127], v[140:143]
ds_read_b64_tr_b16 v[74:75], v56 offset:30720
v_add_u32 v28, s38, v28
v_mfma_f32_16x16x32_bf16 v[156:159], v[92:95], a[124:127], v[156:159]
buffer_load_dwordx4 v13, s[56:59], s81 offen lds
v_mfma_f32_16x16x32_bf16 v[152:155], v[92:95], a[120:123], v[152:155]
ds_read_b64_tr_b16 v[76:77], v57 offset:28672
v_mfma_f32_16x16x32_bf16 v[148:151], v[92:95], a[116:119], v[148:151]
v_mfma_f32_16x16x32_bf16 v[144:147], v[92:95], a[112:115], v[144:147]
s_waitcnt lgkmcnt(3)
ds_read_b64_tr_b16 v[78:79], v57 offset:30720
v_mfma_f32_16x16x32_bf16 v[128:131], v[64:67], a[128:131], v[128:131]
v_mfma_f32_16x16x32_bf16 v[132:135], v[64:67], a[132:135], v[132:135]
ds_read_b64_tr_b16 v[80:81], v60 offset:32768
v_mfma_f32_16x16x32_bf16 v[136:139], v[64:67], a[136:139], v[136:139]
v_mfma_f32_16x16x32_bf16 v[140:143], v[64:67], a[140:143], v[140:143]
v_mfma_f32_16x16x32_bf16 v[156:159], v[68:71], a[140:143], v[156:159]
v_mfma_f32_16x16x32_bf16 v[152:155], v[68:71], a[136:139], v[152:155]
ds_read_b64_tr_b16 v[84:85], v61 offset:32768
v_mfma_f32_16x16x32_bf16 v[148:151], v[68:71], a[132:135], v[148:151]
s_waitcnt lgkmcnt(1)
v_mfma_f32_16x16x32_bf16 v[144:147], v[68:71], a[128:131], v[144:147]
s_waitcnt vmcnt(24)
v_mfma_f32_16x16x32_bf16 v[128:131], v[72:75], a[144:147], v[128:131]
s_barrier
v_mfma_f32_16x16x32_bf16 v[132:135], v[72:75], a[148:151], v[132:135]
s_add_u32 m0, s90, 36864
ds_read_b64_tr_b16 v[88:89], v56 offset:36864
v_mfma_f32_16x16x32_bf16 v[136:139], v[72:75], a[152:155], v[136:139]
s_add_u32 s81, s82, 640
v_mfma_f32_16x16x32_bf16 v[140:143], v[72:75], a[156:159], v[140:143]
ds_read_b64_tr_b16 v[90:91], v56 offset:38912
v_mfma_f32_16x16x32_bf16 v[156:159], v[76:79], a[156:159], v[156:159]
buffer_load_dwordx4 v12, s[52:55], s81 offen lds
v_mfma_f32_16x16x32_bf16 v[152:155], v[76:79], a[152:155], v[152:155]
s_add_u32 m0, s90, 40960
ds_read_b64_tr_b16 v[92:93], v57 offset:36864
v_mfma_f32_16x16x32_bf16 v[148:151], v[76:79], a[148:151], v[148:151]
s_add_u32 s81, s82, 37504
v_mfma_f32_16x16x32_bf16 v[144:147], v[76:79], a[144:147], v[144:147]
s_waitcnt lgkmcnt(2)
ds_read_b64_tr_b16 v[94:95], v57 offset:38912
v_mfma_f32_16x16x4_4b_bf16 v[128:143], v[80:81], a[160:161], v[128:143]
buffer_load_dwordx4 v12, s[52:55], s81 offen lds
s_add_u32 m0, s90, 45056
ds_read_b64_tr_b16 v[64:65], v56 offset:40960
s_add_u32 s81, s82, 74368
ds_read_b64_tr_b16 v[66:67], v56 offset:43008
s_nop 0
v_mfma_f32_16x16x4_4b_bf16 v[144:159], v[84:85], a[160:161], v[144:159]
buffer_load_dwordx4 v12, s[52:55], s81 offen lds
s_add_u32 m0, s90, 73728
ds_read_b64_tr_b16 v[68:69], v57 offset:40960
s_add_u32 s81, s82, 111232
ds_read_b64_tr_b16 v[70:71], v57 offset:43008
s_waitcnt lgkmcnt(6)
v_mfma_f32_16x16x32_bf16 v[160:163], v[88:91], a[0:3], 0
buffer_load_dwordx4 v12, s[52:55], s81 offen lds
v_mfma_f32_16x16x32_bf16 v[164:167], v[88:91], a[4:7], 0
s_add_u32 m0, s90, 77824
ds_read_b64_tr_b16 v[72:73], v56 offset:45056
v_mfma_f32_16x16x32_bf16 v[168:171], v[88:91], a[8:11], 0
s_add_u32 s81, s82, 148096
v_cvt_pk_bf16_f32 v192, v128, v129
v_cvt_pk_bf16_f32 v193, v130, v131
v_mfma_f32_16x16x32_bf16 v[172:175], v[88:91], a[12:15], 0
s_mov_b32 s98, 524288
ds_read_b64_tr_b16 v[74:75], v56 offset:47104
v_cvt_pk_bf16_f32 v194, v144, v145
s_waitcnt lgkmcnt(6)
v_mfma_f32_16x16x32_bf16 v[188:191], v[92:95], a[12:15], 0
buffer_load_dwordx4 v12, s[52:55], s81 offen lds
v_mfma_f32_16x16x32_bf16 v[184:187], v[92:95], a[8:11], 0
s_add_u32 m0, s90, 81920
ds_read_b64_tr_b16 v[76:77], v57 offset:45056
v_cvt_pk_bf16_f32 v195, v146, v147
v_mfma_f32_16x16x32_bf16 v[180:183], v[92:95], a[4:7], 0
s_add_u32 s81, s82, 184960
buffer_store_dwordx4 v[192:195], v116, s[60:63], s98 offen sc1
v_mfma_f32_16x16x32_bf16 v[176:179], v[92:95], a[0:3], 0
s_waitcnt lgkmcnt(2)
ds_read_b64_tr_b16 v[78:79], v57 offset:47104
v_cvt_pk_bf16_f32 v196, v132, v133
v_mfma_f32_16x16x32_bf16 v[160:163], v[64:67], a[16:19], v[160:163]
buffer_load_dwordx4 v12, s[52:55], s81 offen lds
v_mfma_f32_16x16x32_bf16 v[164:167], v[64:67], a[20:23], v[164:167]
s_add_u32 m0, s90, 86016
ds_read_b64_tr_b16 v[80:81], v56 offset:49152
v_cvt_pk_bf16_f32 v197, v134, v135
v_mfma_f32_16x16x32_bf16 v[168:171], v[64:67], a[24:27], v[168:171]
s_add_u32 s81, s82, 221824
v_cvt_pk_bf16_f32 v198, v148, v149
v_cvt_pk_bf16_f32 v199, v150, v151
v_mfma_f32_16x16x32_bf16 v[172:175], v[64:67], a[28:31], v[172:175]
ds_read_b64_tr_b16 v[82:83], v56 offset:51200
v_cvt_pk_bf16_f32 v200, v136, v137
v_mfma_f32_16x16x32_bf16 v[188:191], v[68:71], a[28:31], v[188:191]
buffer_load_dwordx4 v12, s[52:55], s81 offen lds
v_mfma_f32_16x16x32_bf16 v[184:187], v[68:71], a[24:27], v[184:187]
s_add_u32 m0, s90, 90112
ds_read_b64_tr_b16 v[84:85], v57 offset:49152
v_cvt_pk_bf16_f32 v201, v138, v139
v_mfma_f32_16x16x32_bf16 v[180:183], v[68:71], a[20:23], v[180:183]
s_add_u32 s81, s82, 258688
buffer_store_dwordx4 v[196:199], v117, s[60:63], s98 offen sc1
v_mfma_f32_16x16x32_bf16 v[176:179], v[68:71], a[16:19], v[176:179]
s_waitcnt lgkmcnt(2)
ds_read_b64_tr_b16 v[86:87], v57 offset:51200
v_cvt_pk_bf16_f32 v202, v152, v153
v_mfma_f32_16x16x32_bf16 v[160:163], v[72:75], a[32:35], v[160:163]
buffer_load_dwordx4 v12, s[52:55], s81 offen lds
v_mfma_f32_16x16x32_bf16 v[164:167], v[72:75], a[36:39], v[164:167]
ds_read_b64_tr_b16 v[88:89], v56 offset:53248
v_cvt_pk_bf16_f32 v203, v154, v155
v_mfma_f32_16x16x32_bf16 v[168:171], v[72:75], a[40:43], v[168:171]
v_cvt_pk_bf16_f32 v204, v140, v141
v_cvt_pk_bf16_f32 v205, v142, v143
v_mfma_f32_16x16x32_bf16 v[172:175], v[72:75], a[44:47], v[172:175]
ds_read_b64_tr_b16 v[90:91], v56 offset:55296
v_cvt_pk_bf16_f32 v206, v156, v157
v_mfma_f32_16x16x32_bf16 v[188:191], v[76:79], a[44:47], v[188:191]
v_cvt_pk_bf16_f32 v207, v158, v159
v_mfma_f32_16x16x32_bf16 v[184:187], v[76:79], a[40:43], v[184:187]
ds_read_b64_tr_b16 v[92:93], v57 offset:53248
v_mfma_f32_16x16x32_bf16 v[180:183], v[76:79], a[36:39], v[180:183]
buffer_store_dwordx4 v[200:203], v118, s[60:63], s98 offen sc1
v_mfma_f32_16x16x32_bf16 v[176:179], v[76:79], a[32:35], v[176:179]
s_waitcnt lgkmcnt(2)
ds_read_b64_tr_b16 v[94:95], v57 offset:55296
v_mfma_f32_16x16x32_bf16 v[160:163], v[80:83], a[48:51], v[160:163]
v_mfma_f32_16x16x32_bf16 v[164:167], v[80:83], a[52:55], v[164:167]
ds_read_b64_tr_b16 v[64:65], v58 offset:49152
v_mfma_f32_16x16x32_bf16 v[168:171], v[80:83], a[56:59], v[168:171]
v_mfma_f32_16x16x32_bf16 v[172:175], v[80:83], a[60:63], v[172:175]
ds_read_b64_tr_b16 v[66:67], v58 offset:51200
v_mfma_f32_16x16x32_bf16 v[188:191], v[84:87], a[60:63], v[188:191]
v_mfma_f32_16x16x32_bf16 v[184:187], v[84:87], a[56:59], v[184:187]
ds_read_b64_tr_b16 v[68:69], v59 offset:49152
v_mfma_f32_16x16x32_bf16 v[180:183], v[84:87], a[52:55], v[180:183]
s_waitcnt lgkmcnt(2)
buffer_store_dwordx4 v[204:207], v119, s[60:63], s98 offen sc1
v_mfma_f32_16x16x32_bf16 v[176:179], v[84:87], a[48:51], v[176:179]
s_waitcnt vmcnt(28)
ds_read_b64_tr_b16 v[70:71], v59 offset:51200
v_mfma_f32_16x16x32_bf16 v[160:163], v[88:91], a[64:67], v[160:163]
s_barrier
v_mfma_f32_16x16x32_bf16 v[164:167], v[88:91], a[68:71], v[164:167]
s_add_u32 m0, s90, 94208
ds_read_b64_tr_b16 v[72:73], v58 offset:53248
v_mfma_f32_16x16x32_bf16 v[168:171], v[88:91], a[72:75], v[168:171]
s_add_u32 s81, s93, 640
v_mfma_f32_16x16x32_bf16 v[172:175], v[88:91], a[76:79], v[172:175]
ds_read_b64_tr_b16 v[74:75], v58 offset:55296
v_mfma_f32_16x16x32_bf16 v[188:191], v[92:95], a[76:79], v[188:191]
buffer_load_dwordx4 v12, s[52:55], s81 offen lds
v_mfma_f32_16x16x32_bf16 v[184:187], v[92:95], a[72:75], v[184:187]
s_add_u32 m0, s90, 98304
ds_read_b64_tr_b16 v[76:77], v59 offset:53248
v_mfma_f32_16x16x32_bf16 v[180:183], v[92:95], a[68:71], v[180:183]
s_add_u32 s81, s89, 640
v_mfma_f32_16x16x32_bf16 v[176:179], v[92:95], a[64:67], v[176:179]
s_waitcnt lgkmcnt(2)
ds_read_b64_tr_b16 v[78:79], v59 offset:55296
v_mfma_f32_16x16x32_bf16 v[160:163], v[64:67], a[80:83], v[160:163]
buffer_load_dwordx4 v1, s[56:59], s81 offen lds
v_mfma_f32_16x16x32_bf16 v[164:167], v[64:67], a[84:87], v[164:167]
s_add_u32 m0, s90, 102400
ds_read_b64_tr_b16 v[80:81], v58 offset:57344
v_cndmask_b32 v16, v192, v196, s[32:33]
v_mfma_f32_16x16x32_bf16 v[168:171], v[64:67], a[88:91], v[168:171]
s_add_u32 s81, s89, 640
v_cndmask_b32 v17, v193, v197, s[32:33]
v_cndmask_b32 v18, v194, v198, s[32:33]
v_mfma_f32_16x16x32_bf16 v[172:175], v[64:67], a[92:95], v[172:175]
ds_read_b64_tr_b16 v[82:83], v58 offset:59392
v_cndmask_b32 v19, v195, v199, s[32:33]
v_mfma_f32_16x16x32_bf16 v[188:191], v[68:71], a[92:95], v[188:191]
buffer_load_dwordx4 v13, s[56:59], s81 offen lds
v_mfma_f32_16x16x32_bf16 v[184:187], v[68:71], a[88:91], v[184:187]
s_add_u32 m0, s90, 106496
ds_read_b64_tr_b16 v[84:85], v59 offset:57344
v_cndmask_b32 v16, v16, v200, s[34:35]
v_mfma_f32_16x16x32_bf16 v[180:183], v[68:71], a[84:87], v[180:183]
s_add_u32 s81, s82, 768
v_cndmask_b32 v17, v17, v201, s[34:35]
v_cndmask_b32 v18, v18, v202, s[34:35]
v_mfma_f32_16x16x32_bf16 v[176:179], v[68:71], a[80:83], v[176:179]
s_waitcnt lgkmcnt(2)
ds_read_b64_tr_b16 v[86:87], v59 offset:59392
v_cndmask_b32 v19, v19, v203, s[34:35]
v_mfma_f32_16x16x32_bf16 v[160:163], v[72:75], a[96:99], v[160:163]
buffer_load_dwordx4 v12, s[52:55], s81 offen lds
v_mfma_f32_16x16x32_bf16 v[164:167], v[72:75], a[100:103], v[164:167]
s_add_u32 m0, s90, 110592
ds_read_b64_tr_b16 v[88:89], v58 offset:61440
v_cndmask_b32 v16, v16, v204, s[36:37]
v_mfma_f32_16x16x32_bf16 v[168:171], v[72:75], a[104:107], v[168:171]
s_add_u32 s81, s82, 37632
v_cndmask_b32 v17, v17, v205, s[36:37]
v_cndmask_b32 v18, v18, v206, s[36:37]
v_mfma_f32_16x16x32_bf16 v[172:175], v[72:75], a[108:111], v[172:175]
ds_read_b64_tr_b16 v[90:91], v58 offset:63488
v_cndmask_b32 v19, v19, v207, s[36:37]
v_mfma_f32_16x16x32_bf16 v[188:191], v[76:79], a[108:111], v[188:191]
buffer_load_dwordx4 v12, s[52:55], s81 offen lds
v_mfma_f32_16x16x32_bf16 v[184:187], v[76:79], a[104:107], v[184:187]
s_add_u32 m0, s90, 114688
ds_read_b64_tr_b16 v[92:93], v59 offset:61440
v_mfma_f32_16x16x32_bf16 v[180:183], v[76:79], a[100:103], v[180:183]
s_add_u32 s81, s82, 74496
ds_write_b64 v28, v[16:17]
v_mfma_f32_16x16x32_bf16 v[176:179], v[76:79], a[96:99], v[176:179]
s_waitcnt lgkmcnt(3)
ds_read_b64_tr_b16 v[94:95], v59 offset:63488
v_mfma_f32_16x16x32_bf16 v[160:163], v[80:83], a[112:115], v[160:163]
buffer_load_dwordx4 v12, s[52:55], s81 offen lds
v_mfma_f32_16x16x32_bf16 v[164:167], v[80:83], a[116:119], v[164:167]
s_add_u32 m0, s90, 118784
ds_read_b64_tr_b16 v[64:65], v56 offset:57344
v_mfma_f32_16x16x32_bf16 v[168:171], v[80:83], a[120:123], v[168:171]
s_add_u32 s81, s82, 111360
ds_write_b64 v28, v[18:19] offset:8
v_mfma_f32_16x16x32_bf16 v[172:175], v[80:83], a[124:127], v[172:175]
ds_read_b64_tr_b16 v[66:67], v56 offset:59392
v_add_u32 v28, s38, v28
v_mfma_f32_16x16x32_bf16 v[188:191], v[84:87], a[124:127], v[188:191]
buffer_load_dwordx4 v12, s[52:55], s81 offen lds
v_mfma_f32_16x16x32_bf16 v[184:187], v[84:87], a[120:123], v[184:187]
ds_read_b64_tr_b16 v[68:69], v57 offset:57344
v_mfma_f32_16x16x32_bf16 v[180:183], v[84:87], a[116:119], v[180:183]
v_mfma_f32_16x16x32_bf16 v[176:179], v[84:87], a[112:115], v[176:179]
s_waitcnt lgkmcnt(3)
ds_read_b64_tr_b16 v[70:71], v57 offset:59392
v_mfma_f32_16x16x32_bf16 v[160:163], v[88:91], a[128:131], v[160:163]
v_mfma_f32_16x16x32_bf16 v[164:167], v[88:91], a[132:135], v[164:167]
ds_read_b64_tr_b16 v[72:73], v60 offset:61440
v_mfma_f32_16x16x32_bf16 v[168:171], v[88:91], a[136:139], v[168:171]
v_mfma_f32_16x16x32_bf16 v[172:175], v[88:91], a[140:143], v[172:175]
v_mfma_f32_16x16x32_bf16 v[188:191], v[92:95], a[140:143], v[188:191]
v_mfma_f32_16x16x32_bf16 v[184:187], v[92:95], a[136:139], v[184:187]
ds_read_b64_tr_b16 v[76:77], v61 offset:61440
v_mfma_f32_16x16x32_bf16 v[180:183], v[92:95], a[132:135], v[180:183]
s_waitcnt lgkmcnt(1)
v_mfma_f32_16x16x32_bf16 v[176:179], v[92:95], a[128:131], v[176:179]
s_waitcnt vmcnt(24)
v_mfma_f32_16x16x32_bf16 v[160:163], v[64:67], a[144:147], v[160:163]
s_barrier
v_mfma_f32_16x16x32_bf16 v[164:167], v[64:67], a[148:151], v[164:167]
s_add_u32 m0, s90, 122880
ds_read_b64_tr_b16 v[80:81], v58
v_mfma_f32_16x16x32_bf16 v[168:171], v[64:67], a[152:155], v[168:171]
s_add_u32 s81, s82, 148224
v_mfma_f32_16x16x32_bf16 v[172:175], v[64:67], a[156:159], v[172:175]
ds_read_b64_tr_b16 v[82:83], v58 offset:2048
v_mfma_f32_16x16x32_bf16 v[188:191], v[68:71], a[156:159], v[188:191]
buffer_load_dwordx4 v12, s[52:55], s81 offen lds
v_mfma_f32_16x16x32_bf16 v[184:187], v[68:71], a[152:155], v[184:187]
s_add_u32 m0, s90, 126976
ds_read_b64_tr_b16 v[84:85], v59
v_mfma_f32_16x16x32_bf16 v[180:183], v[68:71], a[148:151], v[180:183]
s_add_u32 s81, s82, 185088
v_mfma_f32_16x16x32_bf16 v[176:179], v[68:71], a[144:147], v[176:179]
s_waitcnt lgkmcnt(2)
ds_read_b64_tr_b16 v[86:87], v59 offset:2048
v_mfma_f32_16x16x4_4b_bf16 v[160:175], v[72:73], a[160:161], v[160:175]
buffer_load_dwordx4 v12, s[52:55], s81 offen lds
s_add_u32 m0, s90, 49152
ds_read_b64_tr_b16 v[88:89], v58 offset:4096
s_add_u32 s81, s82, 221952
ds_read_b64_tr_b16 v[90:91], v58 offset:6144
s_nop 0
v_mfma_f32_16x16x4_4b_bf16 v[176:191], v[76:77], a[160:161], v[176:191]
buffer_load_dwordx4 v12, s[52:55], s81 offen lds
s_add_u32 m0, s90, 53248
ds_read_b64_tr_b16 v[92:93], v59 offset:4096
s_add_u32 s81, s82, 258816
ds_read_b64_tr_b16 v[94:95], v59 offset:6144
s_waitcnt lgkmcnt(6)
v_mfma_f32_16x16x32_bf16 v[128:131], v[80:83], a[0:3], 0
buffer_load_dwordx4 v12, s[52:55], s81 offen lds
v_mfma_f32_16x16x32_bf16 v[132:135], v[80:83], a[4:7], 0
s_add_u32 m0, s90, 57344
ds_read_b64_tr_b16 v[64:65], v58 offset:8192
v_mfma_f32_16x16x32_bf16 v[136:139], v[80:83], a[8:11], 0
s_add_u32 s81, s93, 768
v_cvt_pk_bf16_f32 v208, v160, v161
v_cvt_pk_bf16_f32 v209, v162, v163
v_mfma_f32_16x16x32_bf16 v[140:143], v[80:83], a[12:15], 0
s_mov_b32 s98, 786432
ds_read_b64_tr_b16 v[66:67], v58 offset:10240
v_cvt_pk_bf16_f32 v210, v176, v177
s_waitcnt lgkmcnt(6)
v_mfma_f32_16x16x32_bf16 v[156:159], v[84:87], a[12:15], 0
buffer_load_dwordx4 v12, s[52:55], s81 offen lds
v_mfma_f32_16x16x32_bf16 v[152:155], v[84:87], a[8:11], 0
s_add_u32 m0, s90, 61440
ds_read_b64_tr_b16 v[68:69], v59 offset:8192
v_cvt_pk_bf16_f32 v211, v178, v179
v_mfma_f32_16x16x32_bf16 v[148:151], v[84:87], a[4:7], 0
s_add_u32 s81, s89, 768
buffer_store_dwordx4 v[208:211], v116, s[60:63], s98 offen sc1
v_mfma_f32_16x16x32_bf16 v[144:147], v[84:87], a[0:3], 0
s_waitcnt lgkmcnt(2)
ds_read_b64_tr_b16 v[70:71], v59 offset:10240
v_cvt_pk_bf16_f32 v212, v164, v165
v_mfma_f32_16x16x32_bf16 v[128:131], v[88:91], a[16:19], v[128:131]
buffer_load_dwordx4 v1, s[56:59], s81 offen lds
v_mfma_f32_16x16x32_bf16 v[132:135], v[88:91], a[20:23], v[132:135]
ds_read_b64_tr_b16 v[72:73], v58 offset:12288
v_cvt_pk_bf16_f32 v213, v166, v167
v_mfma_f32_16x16x32_bf16 v[136:139], v[88:91], a[24:27], v[136:139]
v_cvt_pk_bf16_f32 v214, v180, v181
v_cvt_pk_bf16_f32 v215, v182, v183
v_mfma_f32_16x16x32_bf16 v[140:143], v[88:91], a[28:31], v[140:143]
ds_read_b64_tr_b16 v[74:75], v58 offset:14336
v_cvt_pk_bf16_f32 v216, v168, v169
v_mfma_f32_16x16x32_bf16 v[156:159], v[92:95], a[28:31], v[156:159]
v_cvt_pk_bf16_f32 v217, v170, v171
v_cvt_pk_bf16_f32 v218, v184, v185
v_mfma_f32_16x16x32_bf16 v[152:155], v[92:95], a[24:27], v[152:155]
ds_read_b64_tr_b16 v[76:77], v59 offset:12288
v_cvt_pk_bf16_f32 v219, v186, v187
v_mfma_f32_16x16x32_bf16 v[148:151], v[92:95], a[20:23], v[148:151]
buffer_store_dwordx4 v[212:215], v117, s[60:63], s98 offen sc1
v_mfma_f32_16x16x32_bf16 v[144:147], v[92:95], a[16:19], v[144:147]
s_waitcnt lgkmcnt(2)
ds_read_b64_tr_b16 v[78:79], v59 offset:14336
v_cvt_pk_bf16_f32 v220, v172, v173
v_mfma_f32_16x16x32_bf16 v[128:131], v[64:67], a[32:35], v[128:131]
v_cvt_pk_bf16_f32 v221, v174, v175
v_cvt_pk_bf16_f32 v222, v188, v189
v_mfma_f32_16x16x32_bf16 v[132:135], v[64:67], a[36:39], v[132:135]
ds_read_b64_tr_b16 v[80:81], v58 offset:16384
v_cvt_pk_bf16_f32 v223, v190, v191
v_mfma_f32_16x16x32_bf16 v[136:139], v[64:67], a[40:43], v[136:139]
v_mfma_f32_16x16x32_bf16 v[140:143], v[64:67], a[44:47], v[140:143]
ds_read_b64_tr_b16 v[82:83], v58 offset:18432
v_mfma_f32_16x16x32_bf16 v[156:159], v[68:71], a[44:47], v[156:159]
v_mfma_f32_16x16x32_bf16 v[152:155], v[68:71], a[40:43], v[152:155]
ds_read_b64_tr_b16 v[84:85], v59 offset:16384
v_mfma_f32_16x16x32_bf16 v[148:151], v[68:71], a[36:39], v[148:151]
buffer_store_dwordx4 v[216:219], v118, s[60:63], s98 offen sc1
v_mfma_f32_16x16x32_bf16 v[144:147], v[68:71], a[32:35], v[144:147]
s_waitcnt lgkmcnt(2)
ds_read_b64_tr_b16 v[86:87], v59 offset:18432
v_mfma_f32_16x16x32_bf16 v[128:131], v[72:75], a[48:51], v[128:131]
v_mfma_f32_16x16x32_bf16 v[132:135], v[72:75], a[52:55], v[132:135]
ds_read_b64_tr_b16 v[88:89], v58 offset:20480
v_mfma_f32_16x16x32_bf16 v[136:139], v[72:75], a[56:59], v[136:139]
v_mfma_f32_16x16x32_bf16 v[140:143], v[72:75], a[60:63], v[140:143]
ds_read_b64_tr_b16 v[90:91], v58 offset:22528
v_mfma_f32_16x16x32_bf16 v[156:159], v[76:79], a[60:63], v[156:159]
v_mfma_f32_16x16x32_bf16 v[152:155], v[76:79], a[56:59], v[152:155]
ds_read_b64_tr_b16 v[92:93], v59 offset:20480
v_mfma_f32_16x16x32_bf16 v[148:151], v[76:79], a[52:55], v[148:151]
s_waitcnt lgkmcnt(2)
buffer_store_dwordx4 v[220:223], v119, s[60:63], s98 offen sc1
v_mfma_f32_16x16x32_bf16 v[144:147], v[76:79], a[48:51], v[144:147]
s_waitcnt vmcnt(17)
ds_read_b64_tr_b16 v[94:95], v59 offset:22528
v_mfma_f32_16x16x32_bf16 v[128:131], v[80:83], a[64:67], v[128:131]
s_barrier
v_mfma_f32_16x16x32_bf16 v[132:135], v[80:83], a[68:71], v[132:135]
s_add_u32 m0, s90, 131072
ds_read_b64_tr_b16 v[64:65], v58 offset:24576
v_mov_b32 v126, 3
v_mfma_f32_16x16x32_bf16 v[136:139], v[80:83], a[72:75], v[136:139]
s_add_u32 s81, s89, 768
buffer_store_dword v126, v125, s[60:63], 0 offen sc1
v_mfma_f32_16x16x32_bf16 v[140:143], v[80:83], a[76:79], v[140:143]
ds_read_b64_tr_b16 v[66:67], v58 offset:26624
v_mfma_f32_16x16x32_bf16 v[156:159], v[84:87], a[76:79], v[156:159]
buffer_load_dwordx4 v13, s[56:59], s81 offen lds
v_mfma_f32_16x16x32_bf16 v[152:155], v[84:87], a[72:75], v[152:155]
s_add_u32 m0, s90, 135168
ds_read_b64_tr_b16 v[68:69], v59 offset:24576
v_mfma_f32_16x16x32_bf16 v[148:151], v[84:87], a[68:71], v[148:151]
s_add_u32 s81, s82, 896
v_mfma_f32_16x16x32_bf16 v[144:147], v[84:87], a[64:67], v[144:147]
s_waitcnt lgkmcnt(2)
ds_read_b64_tr_b16 v[70:71], v59 offset:26624
v_mfma_f32_16x16x32_bf16 v[128:131], v[88:91], a[80:83], v[128:131]
buffer_load_dwordx4 v12, s[52:55], s81 offen lds
v_mfma_f32_16x16x32_bf16 v[132:135], v[88:91], a[84:87], v[132:135]
s_add_u32 m0, s90, 0
ds_read_b64_tr_b16 v[72:73], v58 offset:28672
v_cndmask_b32 v16, v208, v212, s[32:33]
v_mfma_f32_16x16x32_bf16 v[136:139], v[88:91], a[88:91], v[136:139]
s_add_u32 s81, s82, 37760
v_cndmask_b32 v17, v209, v213, s[32:33]
v_cndmask_b32 v18, v210, v214, s[32:33]
v_mfma_f32_16x16x32_bf16 v[140:143], v[88:91], a[92:95], v[140:143]
ds_read_b64_tr_b16 v[74:75], v58 offset:30720
v_cndmask_b32 v19, v211, v215, s[32:33]
v_mfma_f32_16x16x32_bf16 v[156:159], v[92:95], a[92:95], v[156:159]
buffer_load_dwordx4 v12, s[52:55], s81 offen lds
v_mfma_f32_16x16x32_bf16 v[152:155], v[92:95], a[88:91], v[152:155]
s_add_u32 m0, s90, 4096
ds_read_b64_tr_b16 v[76:77], v59 offset:28672
v_cndmask_b32 v16, v16, v216, s[34:35]
v_mfma_f32_16x16x32_bf16 v[148:151], v[92:95], a[84:87], v[148:151]
s_add_u32 s81, s82, 74624
v_cndmask_b32 v17, v17, v217, s[34:35]
v_cndmask_b32 v18, v18, v218, s[34:35]
v_mfma_f32_16x16x32_bf16 v[144:147], v[92:95], a[80:83], v[144:147]
s_waitcnt lgkmcnt(2)
ds_read_b64_tr_b16 v[78:79], v59 offset:30720
v_cndmask_b32 v19, v19, v219, s[34:35]
v_mfma_f32_16x16x32_bf16 v[128:131], v[64:67], a[96:99], v[128:131]
buffer_load_dwordx4 v12, s[52:55], s81 offen lds
v_mfma_f32_16x16x32_bf16 v[132:135], v[64:67], a[100:103], v[132:135]
s_add_u32 m0, s90, 8192
ds_read_b64_tr_b16 v[80:81], v112 offset:40960
v_cndmask_b32 v16, v16, v220, s[36:37]
v_mfma_f32_16x16x32_bf16 v[136:139], v[64:67], a[104:107], v[136:139]
s_add_u32 s81, s82, 111488
v_cndmask_b32 v17, v17, v221, s[36:37]
v_cndmask_b32 v18, v18, v222, s[36:37]
v_mfma_f32_16x16x32_bf16 v[140:143], v[64:67], a[108:111], v[140:143]
ds_read_b64_tr_b16 v[82:83], v112 offset:43008
v_cndmask_b32 v19, v19, v223, s[36:37]
v_mfma_f32_16x16x32_bf16 v[156:159], v[68:71], a[108:111], v[156:159]
buffer_load_dwordx4 v12, s[52:55], s81 offen lds
v_mfma_f32_16x16x32_bf16 v[152:155], v[68:71], a[104:107], v[152:155]
s_add_u32 m0, s90, 12288
ds_read_b64_tr_b16 v[84:85], v113 offset:40960
v_mfma_f32_16x16x32_bf16 v[148:151], v[68:71], a[100:103], v[148:151]
s_add_u32 s81, s82, 148352
ds_write_b64 v28, v[16:17]
v_mfma_f32_16x16x32_bf16 v[144:147], v[68:71], a[96:99], v[144:147]
s_waitcnt lgkmcnt(3)
ds_read_b64_tr_b16 v[86:87], v113 offset:43008
v_mfma_f32_16x16x32_bf16 v[128:131], v[72:75], a[112:115], v[128:131]
buffer_load_dwordx4 v12, s[52:55], s81 offen lds
v_mfma_f32_16x16x32_bf16 v[132:135], v[72:75], a[116:119], v[132:135]
ds_read_b64_tr_b16 v[88:89], v112 offset:45056
v_mfma_f32_16x16x32_bf16 v[136:139], v[72:75], a[120:123], v[136:139]
ds_write_b64 v28, v[18:19] offset:8
v_mfma_f32_16x16x32_bf16 v[140:143], v[72:75], a[124:127], v[140:143]
ds_read_b64_tr_b16 v[90:91], v112 offset:47104
v_add_u32 v28, s38, v28
v_mfma_f32_16x16x32_bf16 v[156:159], v[76:79], a[124:127], v[156:159]
v_mfma_f32_16x16x32_bf16 v[152:155], v[76:79], a[120:123], v[152:155]
ds_read_b64_tr_b16 v[92:93], v113 offset:45056
v_mfma_f32_16x16x32_bf16 v[148:151], v[76:79], a[116:119], v[148:151]
v_mfma_f32_16x16x32_bf16 v[144:147], v[76:79], a[112:115], v[144:147]
s_waitcnt lgkmcnt(3)
ds_read_b64_tr_b16 v[94:95], v113 offset:47104
v_mfma_f32_16x16x32_bf16 v[128:131], v[80:83], a[128:131], v[128:131]
v_mfma_f32_16x16x32_bf16 v[132:135], v[80:83], a[132:135], v[132:135]
ds_read_b64_tr_b16 v[64:65], v62 offset:32768
v_mfma_f32_16x16x32_bf16 v[136:139], v[80:83], a[136:139], v[136:139]
v_mfma_f32_16x16x32_bf16 v[140:143], v[80:83], a[140:143], v[140:143]
v_mfma_f32_16x16x32_bf16 v[156:159], v[84:87], a[140:143], v[156:159]
v_mfma_f32_16x16x32_bf16 v[152:155], v[84:87], a[136:139], v[152:155]
ds_read_b64_tr_b16 v[68:69], v63 offset:32768
v_mfma_f32_16x16x32_bf16 v[148:151], v[84:87], a[132:135], v[148:151]
v_mfma_f32_16x16x32_bf16 v[144:147], v[84:87], a[128:131], v[144:147]
s_waitcnt lgkmcnt(1)
v_mfma_f32_16x16x32_bf16 v[128:131], v[88:91], a[144:147], v[128:131]
s_barrier
v_mfma_f32_16x16x32_bf16 v[132:135], v[88:91], a[148:151], v[132:135]
s_add_u32 m0, s90, 16384
ds_read_b64_tr_b16 v[72:73], v58 offset:36864
v_mfma_f32_16x16x32_bf16 v[136:139], v[88:91], a[152:155], v[136:139]
s_add_u32 s81, s82, 185216
v_mfma_f32_16x16x32_bf16 v[140:143], v[88:91], a[156:159], v[140:143]
ds_read_b64_tr_b16 v[74:75], v58 offset:38912
v_mfma_f32_16x16x32_bf16 v[156:159], v[92:95], a[156:159], v[156:159]
buffer_load_dwordx4 v12, s[52:55], s81 offen lds
v_mfma_f32_16x16x32_bf16 v[152:155], v[92:95], a[152:155], v[152:155]
s_add_u32 m0, s90, 20480
ds_read_b64_tr_b16 v[76:77], v59 offset:36864
v_mfma_f32_16x16x32_bf16 v[148:151], v[92:95], a[148:151], v[148:151]
s_add_u32 s81, s82, 222080
v_mfma_f32_16x16x32_bf16 v[144:147], v[92:95], a[144:147], v[144:147]
s_waitcnt lgkmcnt(2)
ds_read_b64_tr_b16 v[78:79], v59 offset:38912
v_mfma_f32_16x16x4_4b_bf16 v[128:143], v[64:65], a[160:161], v[128:143]
buffer_load_dwordx4 v12, s[52:55], s81 offen lds
s_add_u32 m0, s90, 24576
ds_read_b64_tr_b16 v[80:81], v58 offset:40960
s_add_u32 s81, s82, 258944
ds_read_b64_tr_b16 v[82:83], v58 offset:43008
s_nop 0
v_mfma_f32_16x16x4_4b_bf16 v[144:159], v[68:69], a[160:161], v[144:159]
buffer_load_dwordx4 v12, s[52:55], s81 offen lds
s_add_u32 m0, s90, 28672
ds_read_b64_tr_b16 v[84:85], v59 offset:40960
s_add_u32 s81, s93, 896
ds_read_b64_tr_b16 v[86:87], v59 offset:43008
s_waitcnt lgkmcnt(6)
v_mfma_f32_16x16x32_bf16 v[160:163], v[72:75], a[0:3], 0
buffer_load_dwordx4 v12, s[52:55], s81 offen lds
v_mfma_f32_16x16x32_bf16 v[164:167], v[72:75], a[4:7], 0
s_add_u32 m0, s90, 139264
ds_read_b64_tr_b16 v[88:89], v58 offset:45056
v_mfma_f32_16x16x32_bf16 v[168:171], v[72:75], a[8:11], 0
s_add_u32 s81, s89, 896
v_cvt_pk_bf16_f32 v192, v128, v129
v_cvt_pk_bf16_f32 v193, v130, v131
v_mfma_f32_16x16x32_bf16 v[172:175], v[72:75], a[12:15], 0
s_mov_b32 s98, 1048576
ds_read_b64_tr_b16 v[90:91], v58 offset:47104
v_cvt_pk_bf16_f32 v194, v144, v145
s_waitcnt lgkmcnt(6)
v_mfma_f32_16x16x32_bf16 v[188:191], v[76:79], a[12:15], 0
buffer_load_dwordx4 v1, s[56:59], s81 offen lds
v_mfma_f32_16x16x32_bf16 v[184:187], v[76:79], a[8:11], 0
ds_read_b64_tr_b16 v[92:93], v59 offset:45056
v_cvt_pk_bf16_f32 v195, v146, v147
v_mfma_f32_16x16x32_bf16 v[180:183], v[76:79], a[4:7], 0
buffer_store_dwordx4 v[192:195], v116, s[60:63], s98 offen sc1
v_mfma_f32_16x16x32_bf16 v[176:179], v[76:79], a[0:3], 0
s_waitcnt lgkmcnt(2)
ds_read_b64_tr_b16 v[94:95], v59 offset:47104
v_cvt_pk_bf16_f32 v196, v132, v133
v_mfma_f32_16x16x32_bf16 v[160:163], v[80:83], a[16:19], v[160:163]
v_cvt_pk_bf16_f32 v197, v134, v135
v_cvt_pk_bf16_f32 v198, v148, v149
v_mfma_f32_16x16x32_bf16 v[164:167], v[80:83], a[20:23], v[164:167]
ds_read_b64_tr_b16 v[64:65], v56
v_cvt_pk_bf16_f32 v199, v150, v151
v_mfma_f32_16x16x32_bf16 v[168:171], v[80:83], a[24:27], v[168:171]
v_cvt_pk_bf16_f32 v200, v136, v137
v_cvt_pk_bf16_f32 v201, v138, v139
v_mfma_f32_16x16x32_bf16 v[172:175], v[80:83], a[28:31], v[172:175]
ds_read_b64_tr_b16 v[66:67], v56 offset:2048
v_cvt_pk_bf16_f32 v202, v152, v153
v_mfma_f32_16x16x32_bf16 v[188:191], v[84:87], a[28:31], v[188:191]
v_cvt_pk_bf16_f32 v203, v154, v155
v_cvt_pk_bf16_f32 v204, v140, v141
v_mfma_f32_16x16x32_bf16 v[184:187], v[84:87], a[24:27], v[184:187]
ds_read_b64_tr_b16 v[68:69], v57
v_cvt_pk_bf16_f32 v205, v142, v143
v_mfma_f32_16x16x32_bf16 v[180:183], v[84:87], a[20:23], v[180:183]
buffer_store_dwordx4 v[196:199], v117, s[60:63], s98 offen sc1
v_mfma_f32_16x16x32_bf16 v[176:179], v[84:87], a[16:19], v[176:179]
s_waitcnt lgkmcnt(2)
ds_read_b64_tr_b16 v[70:71], v57 offset:2048
v_cvt_pk_bf16_f32 v206, v156, v157
v_mfma_f32_16x16x32_bf16 v[160:163], v[88:91], a[32:35], v[160:163]
v_cvt_pk_bf16_f32 v207, v158, v159
v_mfma_f32_16x16x32_bf16 v[164:167], v[88:91], a[36:39], v[164:167]
ds_read_b64_tr_b16 v[72:73], v56 offset:4096
v_mfma_f32_16x16x32_bf16 v[168:171], v[88:91], a[40:43], v[168:171]
v_mfma_f32_16x16x32_bf16 v[172:175], v[88:91], a[44:47], v[172:175]
ds_read_b64_tr_b16 v[74:75], v56 offset:6144
v_mfma_f32_16x16x32_bf16 v[188:191], v[92:95], a[44:47], v[188:191]
v_mfma_f32_16x16x32_bf16 v[184:187], v[92:95], a[40:43], v[184:187]
ds_read_b64_tr_b16 v[76:77], v57 offset:4096
v_mfma_f32_16x16x32_bf16 v[180:183], v[92:95], a[36:39], v[180:183]
buffer_store_dwordx4 v[200:203], v118, s[60:63], s98 offen sc1
v_mfma_f32_16x16x32_bf16 v[176:179], v[92:95], a[32:35], v[176:179]
s_waitcnt lgkmcnt(2)
ds_read_b64_tr_b16 v[78:79], v57 offset:6144
v_mfma_f32_16x16x32_bf16 v[160:163], v[64:67], a[48:51], v[160:163]
v_mfma_f32_16x16x32_bf16 v[164:167], v[64:67], a[52:55], v[164:167]
ds_read_b64_tr_b16 v[80:81], v56 offset:8192
v_mfma_f32_16x16x32_bf16 v[168:171], v[64:67], a[56:59], v[168:171]
v_mfma_f32_16x16x32_bf16 v[172:175], v[64:67], a[60:63], v[172:175]
ds_read_b64_tr_b16 v[82:83], v56 offset:10240
v_mfma_f32_16x16x32_bf16 v[188:191], v[68:71], a[60:63], v[188:191]
v_mfma_f32_16x16x32_bf16 v[184:187], v[68:71], a[56:59], v[184:187]
ds_read_b64_tr_b16 v[84:85], v57 offset:8192
v_mfma_f32_16x16x32_bf16 v[180:183], v[68:71], a[52:55], v[180:183]
s_waitcnt lgkmcnt(2)
buffer_store_dwordx4 v[204:207], v119, s[60:63], s98 offen sc1
v_mfma_f32_16x16x32_bf16 v[176:179], v[68:71], a[48:51], v[176:179]
s_waitcnt vmcnt(30)
ds_read_b64_tr_b16 v[86:87], v57 offset:10240
v_mfma_f32_16x16x32_bf16 v[160:163], v[72:75], a[64:67], v[160:163]
s_barrier
v_mfma_f32_16x16x32_bf16 v[164:167], v[72:75], a[68:71], v[164:167]
s_add_u32 m0, s90, 143360
ds_read_b64_tr_b16 v[88:89], v56 offset:12288
v_mfma_f32_16x16x32_bf16 v[168:171], v[72:75], a[72:75], v[168:171]
s_add_u32 s81, s89, 896
v_mfma_f32_16x16x32_bf16 v[172:175], v[72:75], a[76:79], v[172:175]
ds_read_b64_tr_b16 v[90:91], v56 offset:14336
v_mfma_f32_16x16x32_bf16 v[188:191], v[76:79], a[76:79], v[188:191]
buffer_load_dwordx4 v13, s[56:59], s81 offen lds
v_mfma_f32_16x16x32_bf16 v[184:187], v[76:79], a[72:75], v[184:187]
s_add_u32 m0, s90, 32768
ds_read_b64_tr_b16 v[92:93], v57 offset:12288
v_mfma_f32_16x16x32_bf16 v[180:183], v[76:79], a[68:71], v[180:183]
s_add_u32 s81, s82, 1024
v_mfma_f32_16x16x32_bf16 v[176:179], v[76:79], a[64:67], v[176:179]
s_waitcnt lgkmcnt(2)
ds_read_b64_tr_b16 v[94:95], v57 offset:14336
v_mfma_f32_16x16x32_bf16 v[160:163], v[80:83], a[80:83], v[160:163]
buffer_load_dwordx4 v12, s[52:55], s81 offen lds
v_mfma_f32_16x16x32_bf16 v[164:167], v[80:83], a[84:87], v[164:167]
s_add_u32 m0, s90, 36864
ds_read_b64_tr_b16 v[64:65], v56 offset:16384
v_cndmask_b32 v16, v192, v196, s[32:33]
v_mfma_f32_16x16x32_bf16 v[168:171], v[80:83], a[88:91], v[168:171]
s_add_u32 s81, s82, 37888
v_cndmask_b32 v17, v193, v197, s[32:33]
v_cndmask_b32 v18, v194, v198, s[32:33]
v_mfma_f32_16x16x32_bf16 v[172:175], v[80:83], a[92:95], v[172:175]
ds_read_b64_tr_b16 v[66:67], v56 offset:18432
v_cndmask_b32 v19, v195, v199, s[32:33]
v_mfma_f32_16x16x32_bf16 v[188:191], v[84:87], a[92:95], v[188:191]
buffer_load_dwordx4 v12, s[52:55], s81 offen lds
v_mfma_f32_16x16x32_bf16 v[184:187], v[84:87], a[88:91], v[184:187]
s_add_u32 m0, s90, 40960
ds_read_b64_tr_b16 v[68:69], v57 offset:16384
v_cndmask_b32 v16, v16, v200, s[34:35]
v_mfma_f32_16x16x32_bf16 v[180:183], v[84:87], a[84:87], v[180:183]
s_add_u32 s81, s82, 74752
buffer_load_dword v124, v123, s[60:63], 0 offen sc1
v_cndmask_b32 v17, v17, v201, s[34:35]
v_mfma_f32_16x16x32_bf16 v[176:179], v[84:87], a[80:83], v[176:179]
s_waitcnt lgkmcnt(2)
ds_read_b64_tr_b16 v[70:71], v57 offset:18432
v_cndmask_b32 v18, v18, v202, s[34:35]
v_mfma_f32_16x16x32_bf16 v[160:163], v[88:91], a[96:99], v[160:163]
buffer_load_dwordx4 v12, s[52:55], s81 offen lds
v_mfma_f32_16x16x32_bf16 v[164:167], v[88:91], a[100:103], v[164:167]
s_add_u32 m0, s90, 45056
ds_read_b64_tr_b16 v[72:73], v56 offset:20480
v_cndmask_b32 v19, v19, v203, s[34:35]
v_mfma_f32_16x16x32_bf16 v[168:171], v[88:91], a[104:107], v[168:171]
s_add_u32 s81, s82, 111616
v_cndmask_b32 v16, v16, v204, s[36:37]
v_cndmask_b32 v17, v17, v205, s[36:37]
v_mfma_f32_16x16x32_bf16 v[172:175], v[88:91], a[108:111], v[172:175]
ds_read_b64_tr_b16 v[74:75], v56 offset:22528
v_cndmask_b32 v18, v18, v206, s[36:37]
v_mfma_f32_16x16x32_bf16 v[188:191], v[92:95], a[108:111], v[188:191]
buffer_load_dwordx4 v12, s[52:55], s81 offen lds
v_mfma_f32_16x16x32_bf16 v[184:187], v[92:95], a[104:107], v[184:187]
s_add_u32 m0, s90, 73728
ds_read_b64_tr_b16 v[76:77], v57 offset:20480
v_cndmask_b32 v19, v19, v207, s[36:37]
v_mfma_f32_16x16x32_bf16 v[180:183], v[92:95], a[100:103], v[180:183]
s_add_u32 s81, s82, 148480
ds_write_b64 v28, v[16:17]
v_mfma_f32_16x16x32_bf16 v[176:179], v[92:95], a[96:99], v[176:179]
s_waitcnt lgkmcnt(3)
ds_read_b64_tr_b16 v[78:79], v57 offset:22528
v_mfma_f32_16x16x32_bf16 v[160:163], v[64:67], a[112:115], v[160:163]
buffer_load_dwordx4 v12, s[52:55], s81 offen lds
v_mfma_f32_16x16x32_bf16 v[164:167], v[64:67], a[116:119], v[164:167]
ds_read_b64_tr_b16 v[80:81], v56 offset:24576
v_mfma_f32_16x16x32_bf16 v[168:171], v[64:67], a[120:123], v[168:171]
ds_write_b64 v28, v[18:19] offset:8
v_mfma_f32_16x16x32_bf16 v[172:175], v[64:67], a[124:127], v[172:175]
ds_read_b64_tr_b16 v[82:83], v56 offset:26624
v_add_u32 v28, s38, v28
v_mfma_f32_16x16x32_bf16 v[188:191], v[68:71], a[124:127], v[188:191]
v_mfma_f32_16x16x32_bf16 v[184:187], v[68:71], a[120:123], v[184:187]
ds_read_b64_tr_b16 v[84:85], v57 offset:24576
v_mfma_f32_16x16x32_bf16 v[180:183], v[68:71], a[116:119], v[180:183]
v_mfma_f32_16x16x32_bf16 v[176:179], v[68:71], a[112:115], v[176:179]
s_waitcnt lgkmcnt(3)
ds_read_b64_tr_b16 v[86:87], v57 offset:26624
v_mfma_f32_16x16x32_bf16 v[160:163], v[72:75], a[128:131], v[160:163]
v_mfma_f32_16x16x32_bf16 v[164:167], v[72:75], a[132:135], v[164:167]
ds_read_b64_tr_b16 v[88:89], v60 offset:28672
v_mfma_f32_16x16x32_bf16 v[168:171], v[72:75], a[136:139], v[168:171]
v_mfma_f32_16x16x32_bf16 v[172:175], v[72:75], a[140:143], v[172:175]
v_mfma_f32_16x16x32_bf16 v[188:191], v[76:79], a[140:143], v[188:191]
v_mfma_f32_16x16x32_bf16 v[184:187], v[76:79], a[136:139], v[184:187]
ds_read_b64_tr_b16 v[92:93], v61 offset:28672
v_mfma_f32_16x16x32_bf16 v[180:183], v[76:79], a[132:135], v[180:183]
s_waitcnt vmcnt(3)
v_cmp_le_u32 vcc, 3, v124
s_nop 3
s_cmp_eq_u32 vcc_lo, s3
s_cbranch_scc0 L_r64_spin
L_r64_ok:
v_mfma_f32_16x16x32_bf16 v[176:179], v[76:79], a[128:131], v[176:179]
s_waitcnt lgkmcnt(1)
v_mfma_f32_16x16x32_bf16 v[160:163], v[80:83], a[144:147], v[160:163]
s_barrier
v_mfma_f32_16x16x32_bf16 v[164:167], v[80:83], a[148:151], v[164:167]
s_add_u32 m0, s90, 77824
ds_read_b64_tr_b16 v[64:65], v56 offset:32768
v_mfma_f32_16x16x32_bf16 v[168:171], v[80:83], a[152:155], v[168:171]
s_add_u32 s81, s82, 185344
v_mfma_f32_16x16x32_bf16 v[172:175], v[80:83], a[156:159], v[172:175]
ds_read_b64_tr_b16 v[66:67], v56 offset:34816
v_mfma_f32_16x16x32_bf16 v[188:191], v[84:87], a[156:159], v[188:191]
buffer_load_dwordx4 v12, s[52:55], s81 offen lds
v_mfma_f32_16x16x32_bf16 v[184:187], v[84:87], a[152:155], v[184:187]
s_add_u32 m0, s90, 81920
ds_read_b64_tr_b16 v[68:69], v57 offset:32768
v_mfma_f32_16x16x32_bf16 v[180:183], v[84:87], a[148:151], v[180:183]
s_add_u32 s81, s82, 222208
v_mfma_f32_16x16x32_bf16 v[176:179], v[84:87], a[144:147], v[176:179]
s_mov_b32 s91, 0
ds_read_b64_tr_b16 v[70:71], v57 offset:34816
v_mfma_f32_16x16x4_4b_bf16 v[160:175], v[88:89], a[160:161], v[160:175]
buffer_load_dwordx4 v12, s[52:55], s81 offen lds
s_add_u32 m0, s90, 86016
ds_read_b64_tr_b16 v[72:73], v56 offset:36864
s_add_u32 s81, s82, 259072
buffer_load_dwordx4 a[176:179], v120, s[60:63], s91 offen sc1
ds_read_b64_tr_b16 v[74:75], v56 offset:38912
s_waitcnt lgkmcnt(5)
v_mfma_f32_16x16x4_4b_bf16 v[176:191], v[92:93], a[160:161], v[176:191]
buffer_load_dwordx4 v12, s[52:55], s81 offen lds
s_add_u32 m0, s90, 90112
ds_read_b64_tr_b16 v[76:77], v57 offset:36864
s_add_u32 s81, s93, 1024
ds_read_b64_tr_b16 v[78:79], v57 offset:38912
s_waitcnt lgkmcnt(6)
v_mfma_f32_16x16x32_bf16 v[128:131], v[64:67], a[0:3], 0
buffer_load_dwordx4 v12, s[52:55], s81 offen lds
v_mfma_f32_16x16x32_bf16 v[132:135], v[64:67], a[4:7], 0
s_add_u32 m0, s90, 94208
ds_read_b64_tr_b16 v[80:81], v56 offset:40960
v_mfma_f32_16x16x32_bf16 v[136:139], v[64:67], a[8:11], 0
s_add_u32 s81, s89, 1024
buffer_load_dwordx4 a[180:183], v30, s[60:63], s91 offen sc1
v_cvt_pk_bf16_f32 v208, v160, v161
v_mfma_f32_16x16x32_bf16 v[140:143], v[64:67], a[12:15], 0
s_mov_b32 s98, 1310720
ds_read_b64_tr_b16 v[82:83], v56 offset:43008
v_cvt_pk_bf16_f32 v209, v162, v163
s_waitcnt lgkmcnt(6)
v_mfma_f32_16x16x32_bf16 v[156:159], v[68:71], a[12:15], 0
buffer_load_dwordx4 v1, s[56:59], s81 offen lds
v_mfma_f32_16x16x32_bf16 v[152:155], v[68:71], a[8:11], 0
ds_read_b64_tr_b16 v[84:85], v57 offset:40960
v_cvt_pk_bf16_f32 v210, v176, v177
v_mfma_f32_16x16x32_bf16 v[148:151], v[68:71], a[4:7], 0
v_cvt_pk_bf16_f32 v211, v178, v179
v_cvt_pk_bf16_f32 v212, v164, v165
v_mfma_f32_16x16x32_bf16 v[144:147], v[68:71], a[0:3], 0
s_waitcnt lgkmcnt(2)
ds_read_b64_tr_b16 v[86:87], v57 offset:43008
v_cvt_pk_bf16_f32 v213, v166, v167
v_mfma_f32_16x16x32_bf16 v[128:131], v[72:75], a[16:19], v[128:131]
buffer_load_dwordx4 a[184:187], v31, s[60:63], s91 offen sc1
v_cvt_pk_bf16_f32 v214, v180, v181
v_mfma_f32_16x16x32_bf16 v[132:135], v[72:75], a[20:23], v[132:135]
ds_read_b64_tr_b16 v[88:89], v56 offset:45056
v_cvt_pk_bf16_f32 v215, v182, v183
v_mfma_f32_16x16x32_bf16 v[136:139], v[72:75], a[24:27], v[136:139]
buffer_store_dwordx4 v[208:211], v116, s[60:63], s98 offen sc1
v_mfma_f32_16x16x32_bf16 v[140:143], v[72:75], a[28:31], v[140:143]
ds_read_b64_tr_b16 v[90:91], v56 offset:47104
v_cvt_pk_bf16_f32 v216, v168, v169
v_mfma_f32_16x16x32_bf16 v[156:159], v[76:79], a[28:31], v[156:159]
v_cvt_pk_bf16_f32 v217, v170, v171
v_cvt_pk_bf16_f32 v218, v184, v185
v_mfma_f32_16x16x32_bf16 v[152:155], v[76:79], a[24:27], v[152:155]
ds_read_b64_tr_b16 v[92:93], v57 offset:45056
v_cvt_pk_bf16_f32 v219, v186, v187
v_mfma_f32_16x16x32_bf16 v[148:151], v[76:79], a[20:23], v[148:151]
s_waitcnt lgkmcnt(2)
buffer_load_dwordx4 a[188:191], v11, s[60:63], s91 offen sc1
v_cvt_pk_bf16_f32 v220, v172, v173
v_mfma_f32_16x16x32_bf16 v[144:147], v[76:79], a[16:19], v[144:147]
s_mov_b32 s91, 262144
ds_read_b64_tr_b16 v[94:95], v57 offset:47104
v_cvt_pk_bf16_f32 v221, v174, v175
v_mfma_f32_16x16x32_bf16 v[128:131], v[80:83], a[32:35], v[128:131]
v_cvt_pk_bf16_f32 v222, v188, v189
v_cvt_pk_bf16_f32 v223, v190, v191
v_mfma_f32_16x16x32_bf16 v[132:135], v[80:83], a[36:39], v[132:135]
ds_read_b64_tr_b16 v[64:65], v56 offset:49152
v_mfma_f32_16x16x32_bf16 v[136:139], v[80:83], a[40:43], v[136:139]
buffer_store_dwordx4 v[212:215], v117, s[60:63], s98 offen sc1
v_mfma_f32_16x16x32_bf16 v[140:143], v[80:83], a[44:47], v[140:143]
ds_read_b64_tr_b16 v[66:67], v56 offset:51200
v_mfma_f32_16x16x32_bf16 v[156:159], v[84:87], a[44:47], v[156:159]
buffer_load_dwordx4 a[192:195], v120, s[60:63], s91 offen sc1
v_mfma_f32_16x16x32_bf16 v[152:155], v[84:87], a[40:43], v[152:155]
ds_read_b64_tr_b16 v[68:69], v57 offset:49152
v_mfma_f32_16x16x32_bf16 v[148:151], v[84:87], a[36:39], v[148:151]
v_mfma_f32_16x16x32_bf16 v[144:147], v[84:87], a[32:35], v[144:147]
s_waitcnt lgkmcnt(2)
ds_read_b64_tr_b16 v[70:71], v57 offset:51200
v_mfma_f32_16x16x32_bf16 v[128:131], v[88:91], a[48:51], v[128:131]
v_mfma_f32_16x16x32_bf16 v[132:135], v[88:91], a[52:55], v[132:135]
ds_read_b64_tr_b16 v[72:73], v56 offset:53248
v_mfma_f32_16x16x32_bf16 v[136:139], v[88:91], a[56:59], v[136:139]
buffer_load_dwordx4 a[196:199], v30, s[60:63], s91 offen sc1
v_mfma_f32_16x16x32_bf16 v[140:143], v[88:91], a[60:63], v[140:143]
ds_read_b64_tr_b16 v[74:75], v56 offset:55296
v_mfma_f32_16x16x32_bf16 v[156:159], v[92:95], a[60:63], v[156:159]
buffer_store_dwordx4 v[216:219], v118, s[60:63], s98 offen sc1
v_mfma_f32_16x16x32_bf16 v[152:155], v[92:95], a[56:59], v[152:155]
ds_read_b64_tr_b16 v[76:77], v57 offset:53248
v_mfma_f32_16x16x32_bf16 v[148:151], v[92:95], a[52:55], v[148:151]
v_mfma_f32_16x16x32_bf16 v[144:147], v[92:95], a[48:51], v[144:147]
s_waitcnt lgkmcnt(2)
ds_read_b64_tr_b16 v[78:79], v57 offset:55296
v_mfma_f32_16x16x32_bf16 v[128:131], v[64:67], a[64:67], v[128:131]
s_barrier
v_mfma_f32_16x16x32_bf16 v[132:135], v[64:67], a[68:71], v[132:135]
s_add_u32 m0, s90, 98304
ds_read_b64_tr_b16 v[80:81], v58 offset:49152
v_mfma_f32_16x16x32_bf16 v[136:139], v[64:67], a[72:75], v[136:139]
s_add_u32 s81, s89, 1024
buffer_load_dwordx4 a[200:203], v31, s[60:63], s91 offen sc1
v_mfma_f32_16x16x32_bf16 v[140:143], v[64:67], a[76:79], v[140:143]
ds_read_b64_tr_b16 v[82:83], v58 offset:51200
v_mfma_f32_16x16x32_bf16 v[156:159], v[68:71], a[76:79], v[156:159]
buffer_load_dwordx4 v13, s[56:59], s81 offen lds
v_mfma_f32_16x16x32_bf16 v[152:155], v[68:71], a[72:75], v[152:155]
ds_read_b64_tr_b16 v[84:85], v59 offset:49152
buffer_store_dwordx4 v[220:223], v119, s[60:63], s98 offen sc1
v_mfma_f32_16x16x32_bf16 v[148:151], v[68:71], a[68:71], v[148:151]
v_mfma_f32_16x16x32_bf16 v[144:147], v[68:71], a[64:67], v[144:147]
s_waitcnt lgkmcnt(2)
ds_read_b64_tr_b16 v[86:87], v59 offset:51200
v_mfma_f32_16x16x32_bf16 v[128:131], v[72:75], a[80:83], v[128:131]
buffer_load_dwordx4 a[204:207], v11, s[60:63], s91 offen sc1
v_cndmask_b32 v16, v208, v212, s[32:33]
v_mfma_f32_16x16x32_bf16 v[132:135], v[72:75], a[84:87], v[132:135]
s_mov_b32 s91, 524288
ds_read_b64_tr_b16 v[88:89], v58 offset:53248
v_cndmask_b32 v17, v209, v213, s[32:33]
v_mfma_f32_16x16x32_bf16 v[136:139], v[72:75], a[88:91], v[136:139]
v_cndmask_b32 v18, v210, v214, s[32:33]
v_cndmask_b32 v19, v211, v215, s[32:33]
v_mfma_f32_16x16x32_bf16 v[140:143], v[72:75], a[92:95], v[140:143]
ds_read_b64_tr_b16 v[90:91], v58 offset:55296
v_cndmask_b32 v16, v16, v216, s[34:35]
v_mfma_f32_16x16x32_bf16 v[156:159], v[76:79], a[92:95], v[156:159]
v_cndmask_b32 v17, v17, v217, s[34:35]
v_cndmask_b32 v18, v18, v218, s[34:35]
v_mfma_f32_16x16x32_bf16 v[152:155], v[76:79], a[88:91], v[152:155]
ds_read_b64_tr_b16 v[92:93], v59 offset:53248
v_cndmask_b32 v19, v19, v219, s[34:35]
v_mfma_f32_16x16x32_bf16 v[148:151], v[76:79], a[84:87], v[148:151]
buffer_load_dwordx4 a[208:211], v120, s[60:63], s91 offen sc1
v_cndmask_b32 v16, v16, v220, s[36:37]
v_mfma_f32_16x16x32_bf16 v[144:147], v[76:79], a[80:83], v[144:147]
s_waitcnt lgkmcnt(2)
ds_read_b64_tr_b16 v[94:95], v59 offset:55296
v_cndmask_b32 v17, v17, v221, s[36:37]
v_mfma_f32_16x16x32_bf16 v[128:131], v[80:83], a[96:99], v[128:131]
v_cndmask_b32 v18, v18, v222, s[36:37]
v_cndmask_b32 v19, v19, v223, s[36:37]
v_mfma_f32_16x16x32_bf16 v[132:135], v[80:83], a[100:103], v[132:135]
ds_read_b64_tr_b16 v[64:65], v58 offset:57344
v_mfma_f32_16x16x32_bf16 v[136:139], v[80:83], a[104:107], v[136:139]
ds_write_b64 v28, v[16:17]
v_mfma_f32_16x16x32_bf16 v[140:143], v[80:83], a[108:111], v[140:143]
ds_read_b64_tr_b16 v[66:67], v58 offset:59392
v_mfma_f32_16x16x32_bf16 v[156:159], v[84:87], a[108:111], v[156:159]
buffer_load_dwordx4 a[212:215], v30, s[60:63], s91 offen sc1
v_mfma_f32_16x16x32_bf16 v[152:155], v[84:87], a[104:107], v[152:155]
ds_read_b64_tr_b16 v[68:69], v59 offset:57344
v_mfma_f32_16x16x32_bf16 v[148:151], v[84:87], a[100:103], v[148:151]
ds_write_b64 v28, v[18:19] offset:8
v_mfma_f32_16x16x32_bf16 v[144:147], v[84:87], a[96:99], v[144:147]
s_waitcnt lgkmcnt(4)
ds_read_b64_tr_b16 v[70:71], v59 offset:59392
v_add_u32 v28, s38, v28
v_mfma_f32_16x16x32_bf16 v[128:131], v[88:91], a[112:115], v[128:131]
v_mfma_f32_16x16x32_bf16 v[132:135], v[88:91], a[116:119], v[132:135]
ds_read_b64_tr_b16 v[72:73], v58 offset:61440
v_mfma_f32_16x16x32_bf16 v[136:139], v[88:91], a[120:123], v[136:139]
buffer_load_dwordx4 a[216:219], v31, s[60:63], s91 offen sc1
v_mfma_f32_16x16x32_bf16 v[140:143], v[88:91], a[124:127], v[140:143]
ds_read_b64_tr_b16 v[74:75], v58 offset:63488
v_mfma_f32_16x16x32_bf16 v[156:159], v[92:95], a[124:127], v[156:159]
v_mfma_f32_16x16x32_bf16 v[152:155], v[92:95], a[120:123], v[152:155]
ds_read_b64_tr_b16 v[76:77], v59 offset:61440
v_mfma_f32_16x16x32_bf16 v[148:151], v[92:95], a[116:119], v[148:151]
v_mfma_f32_16x16x32_bf16 v[144:147], v[92:95], a[112:115], v[144:147]
s_waitcnt lgkmcnt(2)
ds_read_b64_tr_b16 v[78:79], v59 offset:63488
v_mfma_f32_16x16x32_bf16 v[128:131], v[64:67], a[128:131], v[128:131]
buffer_load_dwordx4 a[220:223], v11, s[60:63], s91 offen sc1
v_mfma_f32_16x16x32_bf16 v[132:135], v[64:67], a[132:135], v[132:135]
ds_read_b64_tr_b16 v[80:81], v60 offset:57344
v_mfma_f32_16x16x32_bf16 v[136:139], v[64:67], a[136:139], v[136:139]
v_mfma_f32_16x16x32_bf16 v[140:143], v[64:67], a[140:143], v[140:143]
v_mfma_f32_16x16x32_bf16 v[156:159], v[68:71], a[140:143], v[156:159]
v_mfma_f32_16x16x32_bf16 v[152:155], v[68:71], a[136:139], v[152:155]
ds_read_b64_tr_b16 v[84:85], v61 offset:57344
v_mfma_f32_16x16x32_bf16 v[148:151], v[68:71], a[132:135], v[148:151]
v_mfma_f32_16x16x32_bf16 v[144:147], v[68:71], a[128:131], v[144:147]
s_waitcnt lgkmcnt(1)
v_mfma_f32_16x16x32_bf16 v[128:131], v[72:75], a[144:147], v[128:131]
s_barrier
v_mfma_f32_16x16x32_bf16 v[132:135], v[72:75], a[148:151], v[132:135]
ds_read_b64_tr_b16 v[88:89], v56 offset:61440
v_mfma_f32_16x16x32_bf16 v[136:139], v[72:75], a[152:155], v[136:139]
v_mfma_f32_16x16x32_bf16 v[140:143], v[72:75], a[156:159], v[140:143]
ds_read_b64_tr_b16 v[90:91], v56 offset:63488
v_mfma_f32_16x16x32_bf16 v[156:159], v[76:79], a[156:159], v[156:159]
v_mfma_f32_16x16x32_bf16 v[152:155], v[76:79], a[152:155], v[152:155]
ds_read_b64_tr_b16 v[92:93], v57 offset:61440
v_mfma_f32_16x16x32_bf16 v[148:151], v[76:79], a[148:151], v[148:151]
v_mfma_f32_16x16x32_bf16 v[144:147], v[76:79], a[144:147], v[144:147]
ds_read_b64_tr_b16 v[94:95], v57 offset:63488
s_nop 0
v_mfma_f32_16x16x4_4b_bf16 v[128:143], v[80:81], a[160:161], v[128:143]
s_waitcnt lgkmcnt(3)
ds_read_b64_tr_b16 v[64:65], v58
ds_read_b64_tr_b16 v[66:67], v58 offset:2048
s_nop 2
v_mfma_f32_16x16x4_4b_bf16 v[144:159], v[84:85], a[160:161], v[144:159]
s_waitcnt lgkmcnt(4)
ds_read_b64_tr_b16 v[68:69], v59
ds_read_b64_tr_b16 v[70:71], v59 offset:2048
v_mfma_f32_16x16x32_bf16 v[160:163], v[88:91], a[0:3], 0
v_mfma_f32_16x16x32_bf16 v[164:167], v[88:91], a[4:7], 0
ds_read_b64_tr_b16 v[72:73], v58 offset:4096
v_mfma_f32_16x16x32_bf16 v[168:171], v[88:91], a[8:11], 0
s_mov_b32 s98, 1572864
v_cvt_pk_bf16_f32 v192, v128, v129
v_cvt_pk_bf16_f32 v193, v130, v131
v_mfma_f32_16x16x32_bf16 v[172:175], v[88:91], a[12:15], 0
s_waitcnt lgkmcnt(5)
ds_read_b64_tr_b16 v[74:75], v58 offset:6144
s_nop 0
v_cvt_pk_bf16_f32 v194, v144, v145
v_mfma_f32_16x16x32_bf16 v[188:191], v[92:95], a[12:15], 0
v_cvt_pk_bf16_f32 v195, v146, v147
v_cvt_pk_bf16_f32 v196, v132, v133
v_mfma_f32_16x16x32_bf16 v[184:187], v[92:95], a[8:11], 0
ds_read_b64_tr_b16 v[76:77], v59 offset:4096
v_cvt_pk_bf16_f32 v197, v134, v135
v_mfma_f32_16x16x32_bf16 v[180:183], v[92:95], a[4:7], 0
buffer_store_dwordx4 v[192:195], v116, s[60:63], s98 offen sc1
v_mfma_f32_16x16x32_bf16 v[176:179], v[92:95], a[0:3], 0
s_waitcnt lgkmcnt(2)
ds_read_b64_tr_b16 v[78:79], v59 offset:6144
v_cvt_pk_bf16_f32 v198, v148, v149
v_mfma_f32_16x16x32_bf16 v[160:163], v[64:67], a[16:19], v[160:163]
v_cvt_pk_bf16_f32 v199, v150, v151
v_cvt_pk_bf16_f32 v200, v136, v137
v_mfma_f32_16x16x32_bf16 v[164:167], v[64:67], a[20:23], v[164:167]
ds_read_b64_tr_b16 v[80:81], v58 offset:8192
v_cvt_pk_bf16_f32 v201, v138, v139
v_mfma_f32_16x16x32_bf16 v[168:171], v[64:67], a[24:27], v[168:171]
v_cvt_pk_bf16_f32 v202, v152, v153
v_cvt_pk_bf16_f32 v203, v154, v155
v_mfma_f32_16x16x32_bf16 v[172:175], v[64:67], a[28:31], v[172:175]
ds_read_b64_tr_b16 v[82:83], v58 offset:10240
v_cvt_pk_bf16_f32 v204, v140, v141
v_mfma_f32_16x16x32_bf16 v[188:191], v[68:71], a[28:31], v[188:191]
v_cvt_pk_bf16_f32 v205, v142, v143
v_cvt_pk_bf16_f32 v206, v156, v157
v_mfma_f32_16x16x32_bf16 v[184:187], v[68:71], a[24:27], v[184:187]
ds_read_b64_tr_b16 v[84:85], v59 offset:8192
v_cvt_pk_bf16_f32 v207, v158, v159
v_mfma_f32_16x16x32_bf16 v[180:183], v[68:71], a[20:23], v[180:183]
buffer_store_dwordx4 v[196:199], v117, s[60:63], s98 offen sc1
v_mfma_f32_16x16x32_bf16 v[176:179], v[68:71], a[16:19], v[176:179]
s_waitcnt lgkmcnt(2)
ds_read_b64_tr_b16 v[86:87], v59 offset:10240
v_mfma_f32_16x16x32_bf16 v[160:163], v[72:75], a[32:35], v[160:163]
v_mfma_f32_16x16x32_bf16 v[164:167], v[72:75], a[36:39], v[164:167]
ds_read_b64_tr_b16 v[88:89], v58 offset:12288
v_mfma_f32_16x16x32_bf16 v[168:171], v[72:75], a[40:43], v[168:171]
v_mfma_f32_16x16x32_bf16 v[172:175], v[72:75], a[44:47], v[172:175]
ds_read_b64_tr_b16 v[90:91], v58 offset:14336
v_mfma_f32_16x16x32_bf16 v[188:191], v[76:79], a[44:47], v[188:191]
v_mfma_f32_16x16x32_bf16 v[184:187], v[76:79], a[40:43], v[184:187]
ds_read_b64_tr_b16 v[92:93], v59 offset:12288
v_mfma_f32_16x16x32_bf16 v[180:183], v[76:79], a[36:39], v[180:183]
buffer_store_dwordx4 v[200:203], v118, s[60:63], s98 offen sc1
v_mfma_f32_16x16x32_bf16 v[176:179], v[76:79], a[32:35], v[176:179]
s_waitcnt lgkmcnt(2)
ds_read_b64_tr_b16 v[94:95], v59 offset:14336
v_mfma_f32_16x16x32_bf16 v[160:163], v[80:83], a[48:51], v[160:163]
v_mfma_f32_16x16x32_bf16 v[164:167], v[80:83], a[52:55], v[164:167]
ds_read_b64_tr_b16 v[64:65], v58 offset:16384
v_mfma_f32_16x16x32_bf16 v[168:171], v[80:83], a[56:59], v[168:171]
v_mfma_f32_16x16x32_bf16 v[172:175], v[80:83], a[60:63], v[172:175]
ds_read_b64_tr_b16 v[66:67], v58 offset:18432
v_mfma_f32_16x16x32_bf16 v[188:191], v[84:87], a[60:63], v[188:191]
v_mfma_f32_16x16x32_bf16 v[184:187], v[84:87], a[56:59], v[184:187]
ds_read_b64_tr_b16 v[68:69], v59 offset:16384
v_mfma_f32_16x16x32_bf16 v[180:183], v[84:87], a[52:55], v[180:183]
buffer_store_dwordx4 v[204:207], v119, s[60:63], s98 offen sc1
v_mfma_f32_16x16x32_bf16 v[176:179], v[84:87], a[48:51], v[176:179]
s_waitcnt lgkmcnt(2)
ds_read_b64_tr_b16 v[70:71], v59 offset:18432
v_mfma_f32_16x16x32_bf16 v[160:163], v[88:91], a[64:67], v[160:163]
s_barrier
v_mfma_f32_16x16x32_bf16 v[164:167], v[88:91], a[68:71], v[164:167]
ds_read_b64_tr_b16 v[72:73], v58 offset:20480
v_mfma_f32_16x16x32_bf16 v[168:171], v[88:91], a[72:75], v[168:171]
v_mfma_f32_16x16x32_bf16 v[172:175], v[88:91], a[76:79], v[172:175]
ds_read_b64_tr_b16 v[74:75], v58 offset:22528
v_mfma_f32_16x16x32_bf16 v[188:191], v[92:95], a[76:79], v[188:191]
v_mfma_f32_16x16x32_bf16 v[184:187], v[92:95], a[72:75], v[184:187]
ds_read_b64_tr_b16 v[76:77], v59 offset:20480
v_mfma_f32_16x16x32_bf16 v[180:183], v[92:95], a[68:71], v[180:183]
v_mfma_f32_16x16x32_bf16 v[176:179], v[92:95], a[64:67], v[176:179]
s_waitcnt lgkmcnt(2)
ds_read_b64_tr_b16 v[78:79], v59 offset:22528
v_mfma_f32_16x16x32_bf16 v[160:163], v[64:67], a[80:83], v[160:163]
v_cndmask_b32 v16, v192, v196, s[32:33]
v_cndmask_b32 v17, v193, v197, s[32:33]
v_mfma_f32_16x16x32_bf16 v[164:167], v[64:67], a[84:87], v[164:167]
ds_read_b64_tr_b16 v[80:81], v58 offset:24576
v_cndmask_b32 v18, v194, v198, s[32:33]
v_mfma_f32_16x16x32_bf16 v[168:171], v[64:67], a[88:91], v[168:171]
v_cndmask_b32 v19, v195, v199, s[32:33]
v_cndmask_b32 v16, v16, v200, s[34:35]
v_mfma_f32_16x16x32_bf16 v[172:175], v[64:67], a[92:95], v[172:175]
ds_read_b64_tr_b16 v[82:83], v58 offset:26624
v_cndmask_b32 v17, v17, v201, s[34:35]
v_mfma_f32_16x16x32_bf16 v[188:191], v[68:71], a[92:95], v[188:191]
v_cndmask_b32 v18, v18, v202, s[34:35]
v_cndmask_b32 v19, v19, v203, s[34:35]
v_mfma_f32_16x16x32_bf16 v[184:187], v[68:71], a[88:91], v[184:187]
ds_read_b64_tr_b16 v[84:85], v59 offset:24576
v_cndmask_b32 v16, v16, v204, s[36:37]
v_mfma_f32_16x16x32_bf16 v[180:183], v[68:71], a[84:87], v[180:183]
v_cndmask_b32 v17, v17, v205, s[36:37]
v_cndmask_b32 v18, v18, v206, s[36:37]
v_mfma_f32_16x16x32_bf16 v[176:179], v[68:71], a[80:83], v[176:179]
s_waitcnt lgkmcnt(2)
ds_read_b64_tr_b16 v[86:87], v59 offset:26624
v_cndmask_b32 v19, v19, v207, s[36:37]
v_mfma_f32_16x16x32_bf16 v[160:163], v[72:75], a[96:99], v[160:163]
ds_write_b64 v28, v[16:17]
v_mfma_f32_16x16x32_bf16 v[164:167], v[72:75], a[100:103], v[164:167]
ds_read_b64_tr_b16 v[88:89], v58 offset:28672
v_mfma_f32_16x16x32_bf16 v[168:171], v[72:75], a[104:107], v[168:171]
ds_write_b64 v28, v[18:19] offset:8
v_mfma_f32_16x16x32_bf16 v[172:175], v[72:75], a[108:111], v[172:175]
ds_read_b64_tr_b16 v[90:91], v58 offset:30720
v_add_u32 v28, s38, v28
v_mfma_f32_16x16x32_bf16 v[188:191], v[76:79], a[108:111], v[188:191]
v_mfma_f32_16x16x32_bf16 v[184:187], v[76:79], a[104:107], v[184:187]
ds_read_b64_tr_b16 v[92:93], v59 offset:28672
v_mfma_f32_16x16x32_bf16 v[180:183], v[76:79], a[100:103], v[180:183]
v_mfma_f32_16x16x32_bf16 v[176:179], v[76:79], a[96:99], v[176:179]
s_waitcnt lgkmcnt(3)
ds_read_b64_tr_b16 v[94:95], v59 offset:30720
v_mfma_f32_16x16x32_bf16 v[160:163], v[80:83], a[112:115], v[160:163]
v_mfma_f32_16x16x32_bf16 v[164:167], v[80:83], a[116:119], v[164:167]
ds_read_b64_tr_b16 v[64:65], v112 offset:40960
v_mfma_f32_16x16x32_bf16 v[168:171], v[80:83], a[120:123], v[168:171]
v_mfma_f32_16x16x32_bf16 v[172:175], v[80:83], a[124:127], v[172:175]
ds_read_b64_tr_b16 v[66:67], v112 offset:43008
v_mfma_f32_16x16x32_bf16 v[188:191], v[84:87], a[124:127], v[188:191]
v_mfma_f32_16x16x32_bf16 v[184:187], v[84:87], a[120:123], v[184:187]
ds_read_b64_tr_b16 v[68:69], v113 offset:40960
v_mfma_f32_16x16x32_bf16 v[180:183], v[84:87], a[116:119], v[180:183]
v_mfma_f32_16x16x32_bf16 v[176:179], v[84:87], a[112:115], v[176:179]
s_waitcnt lgkmcnt(2)
ds_read_b64_tr_b16 v[70:71], v113 offset:43008
v_mfma_f32_16x16x32_bf16 v[160:163], v[88:91], a[128:131], v[160:163]
v_mfma_f32_16x16x32_bf16 v[164:167], v[88:91], a[132:135], v[164:167]
ds_read_b64_tr_b16 v[72:73], v114 offset:45056
v_mfma_f32_16x16x32_bf16 v[168:171], v[88:91], a[136:139], v[168:171]
v_mfma_f32_16x16x32_bf16 v[172:175], v[88:91], a[140:143], v[172:175]
v_mfma_f32_16x16x32_bf16 v[188:191], v[92:95], a[140:143], v[188:191]
v_mfma_f32_16x16x32_bf16 v[184:187], v[92:95], a[136:139], v[184:187]
ds_read_b64_tr_b16 v[76:77], v115 offset:45056
v_mfma_f32_16x16x32_bf16 v[180:183], v[92:95], a[132:135], v[180:183]
s_waitcnt lgkmcnt(1)
v_mfma_f32_16x16x32_bf16 v[176:179], v[92:95], a[128:131], v[176:179]
s_waitcnt vmcnt(25)
v_mfma_f32_16x16x32_bf16 v[160:163], v[64:67], a[144:147], v[160:163]
s_barrier
v_mfma_f32_16x16x32_bf16 v[164:167], v[64:67], a[148:151], v[164:167]
ds_read_b64_tr_b16 v[80:81], v58 offset:32768
v_mfma_f32_16x16x32_bf16 v[168:171], v[64:67], a[152:155], v[168:171]
v_mfma_f32_16x16x32_bf16 v[172:175], v[64:67], a[156:159], v[172:175]
ds_read_b64_tr_b16 v[82:83], v58 offset:34816
v_mfma_f32_16x16x32_bf16 v[188:191], v[68:71], a[156:159], v[188:191]
v_mfma_f32_16x16x32_bf16 v[184:187], v[68:71], a[152:155], v[184:187]
ds_read_b64_tr_b16 v[84:85], v59 offset:32768
v_mfma_f32_16x16x32_bf16 v[180:183], v[68:71], a[148:151], v[180:183]
v_mfma_f32_16x16x32_bf16 v[176:179], v[68:71], a[144:147], v[176:179]
ds_read_b64_tr_b16 v[86:87], v59 offset:34816
s_nop 0
v_mfma_f32_16x16x4_4b_bf16 v[160:175], v[72:73], a[160:161], v[160:175]
s_waitcnt lgkmcnt(3)
ds_read_b64_tr_b16 v[88:89], v58 offset:36864
ds_read_b64_tr_b16 v[90:91], v58 offset:38912
s_nop 2
v_mfma_f32_16x16x4_4b_bf16 v[176:191], v[76:77], a[160:161], v[176:191]
s_waitcnt lgkmcnt(4)
ds_read_b64_tr_b16 v[92:93], v59 offset:36864
ds_read_b64_tr_b16 v[94:95], v59 offset:38912
v_mfma_f32_16x16x32_bf16 v[128:131], v[80:83], a[0:3], 0
v_mfma_f32_16x16x32_bf16 v[132:135], v[80:83], a[4:7], 0
ds_read_b64_tr_b16 v[64:65], v58 offset:40960
v_mfma_f32_16x16x32_bf16 v[136:139], v[80:83], a[8:11], 0
s_mov_b32 s98, 1835008
v_cvt_pk_bf16_f32 v208, v160, v161
v_cvt_pk_bf16_f32 v209, v162, v163
v_mfma_f32_16x16x32_bf16 v[140:143], v[80:83], a[12:15], 0
s_waitcnt lgkmcnt(5)
ds_read_b64_tr_b16 v[66:67], v58 offset:43008
s_nop 0
v_cvt_pk_bf16_f32 v210, v176, v177
v_mfma_f32_16x16x32_bf16 v[156:159], v[84:87], a[12:15], 0
v_cvt_pk_bf16_f32 v211, v178, v179
v_cvt_pk_bf16_f32 v212, v164, v165
v_mfma_f32_16x16x32_bf16 v[152:155], v[84:87], a[8:11], 0
ds_read_b64_tr_b16 v[68:69], v59 offset:40960
v_cvt_pk_bf16_f32 v213, v166, v167
v_mfma_f32_16x16x32_bf16 v[148:151], v[84:87], a[4:7], 0
buffer_store_dwordx4 v[208:211], v116, s[60:63], s98 offen sc1
v_mfma_f32_16x16x32_bf16 v[144:147], v[84:87], a[0:3], 0
s_waitcnt lgkmcnt(2)
ds_read_b64_tr_b16 v[70:71], v59 offset:43008
v_cvt_pk_bf16_f32 v214, v180, v181
v_mfma_f32_16x16x32_bf16 v[128:131], v[88:91], a[16:19], v[128:131]
v_cvt_pk_bf16_f32 v215, v182, v183
v_cvt_pk_bf16_f32 v216, v168, v169
v_mfma_f32_16x16x32_bf16 v[132:135], v[88:91], a[20:23], v[132:135]
ds_read_b64_tr_b16 v[72:73], v58 offset:45056
v_cvt_pk_bf16_f32 v217, v170, v171
v_mfma_f32_16x16x32_bf16 v[136:139], v[88:91], a[24:27], v[136:139]
v_cvt_pk_bf16_f32 v218, v184, v185
v_cvt_pk_bf16_f32 v219, v186, v187
v_mfma_f32_16x16x32_bf16 v[140:143], v[88:91], a[28:31], v[140:143]
ds_read_b64_tr_b16 v[74:75], v58 offset:47104
v_cvt_pk_bf16_f32 v220, v172, v173
v_mfma_f32_16x16x32_bf16 v[156:159], v[92:95], a[28:31], v[156:159]
v_cvt_pk_bf16_f32 v221, v174, v175
v_cvt_pk_bf16_f32 v222, v188, v189
v_mfma_f32_16x16x32_bf16 v[152:155], v[92:95], a[24:27], v[152:155]
ds_read_b64_tr_b16 v[76:77], v59 offset:45056
v_cvt_pk_bf16_f32 v223, v190, v191
v_mfma_f32_16x16x32_bf16 v[148:151], v[92:95], a[20:23], v[148:151]
buffer_store_dwordx4 v[212:215], v117, s[60:63], s98 offen sc1
v_mfma_f32_16x16x32_bf16 v[144:147], v[92:95], a[16:19], v[144:147]
s_waitcnt lgkmcnt(2)
ds_read_b64_tr_b16 v[78:79], v59 offset:47104
v_mfma_f32_16x16x32_bf16 v[128:131], v[64:67], a[32:35], v[128:131]
v_mfma_f32_16x16x32_bf16 v[132:135], v[64:67], a[36:39], v[132:135]
ds_read_b64_tr_b16 v[80:81], v56
v_mfma_f32_16x16x32_bf16 v[136:139], v[64:67], a[40:43], v[136:139]
v_mfma_f32_16x16x32_bf16 v[140:143], v[64:67], a[44:47], v[140:143]
ds_read_b64_tr_b16 v[82:83], v56 offset:2048
v_mfma_f32_16x16x32_bf16 v[156:159], v[68:71], a[44:47], v[156:159]
v_mfma_f32_16x16x32_bf16 v[152:155], v[68:71], a[40:43], v[152:155]
ds_read_b64_tr_b16 v[84:85], v57
v_mfma_f32_16x16x32_bf16 v[148:151], v[68:71], a[36:39], v[148:151]
buffer_store_dwordx4 v[216:219], v118, s[60:63], s98 offen sc1
v_mfma_f32_16x16x32_bf16 v[144:147], v[68:71], a[32:35], v[144:147]
s_waitcnt lgkmcnt(2)
ds_read_b64_tr_b16 v[86:87], v57 offset:2048
v_mfma_f32_16x16x32_bf16 v[128:131], v[72:75], a[48:51], v[128:131]
v_mfma_f32_16x16x32_bf16 v[132:135], v[72:75], a[52:55], v[132:135]
ds_read_b64_tr_b16 v[88:89], v56 offset:4096
v_mfma_f32_16x16x32_bf16 v[136:139], v[72:75], a[56:59], v[136:139]
v_mfma_f32_16x16x32_bf16 v[140:143], v[72:75], a[60:63], v[140:143]
ds_read_b64_tr_b16 v[90:91], v56 offset:6144
v_mfma_f32_16x16x32_bf16 v[156:159], v[76:79], a[60:63], v[156:159]
v_mfma_f32_16x16x32_bf16 v[152:155], v[76:79], a[56:59], v[152:155]
ds_read_b64_tr_b16 v[92:93], v57 offset:4096
v_mfma_f32_16x16x32_bf16 v[148:151], v[76:79], a[52:55], v[148:151]
s_waitcnt lgkmcnt(2)
buffer_store_dwordx4 v[220:223], v119, s[60:63], s98 offen sc1
v_mfma_f32_16x16x32_bf16 v[144:147], v[76:79], a[48:51], v[144:147]
s_waitcnt vmcnt(4)
ds_read_b64_tr_b16 v[94:95], v57 offset:6144
v_mfma_f32_16x16x32_bf16 v[128:131], v[80:83], a[64:67], v[128:131]
s_barrier
v_mfma_f32_16x16x32_bf16 v[132:135], v[80:83], a[68:71], v[132:135]
ds_read_b64_tr_b16 v[64:65], v56 offset:8192
v_mov_b32 v126, 7
v_mfma_f32_16x16x32_bf16 v[136:139], v[80:83], a[72:75], v[136:139]
buffer_store_dword v126, v125, s[60:63], 0 offen sc1
v_mfma_f32_16x16x32_bf16 v[140:143], v[80:83], a[76:79], v[140:143]
ds_read_b64_tr_b16 v[66:67], v56 offset:10240
v_mfma_f32_16x16x32_bf16 v[156:159], v[84:87], a[76:79], v[156:159]
v_mfma_f32_16x16x32_bf16 v[152:155], v[84:87], a[72:75], v[152:155]
ds_read_b64_tr_b16 v[68:69], v57 offset:8192
v_mfma_f32_16x16x32_bf16 v[148:151], v[84:87], a[68:71], v[148:151]
v_mfma_f32_16x16x32_bf16 v[144:147], v[84:87], a[64:67], v[144:147]
s_waitcnt lgkmcnt(2)
ds_read_b64_tr_b16 v[70:71], v57 offset:10240
v_mfma_f32_16x16x32_bf16 v[128:131], v[88:91], a[80:83], v[128:131]
v_cndmask_b32 v16, v208, v212, s[32:33]
v_cndmask_b32 v17, v209, v213, s[32:33]
v_mfma_f32_16x16x32_bf16 v[132:135], v[88:91], a[84:87], v[132:135]
ds_read_b64_tr_b16 v[72:73], v56 offset:12288
v_cndmask_b32 v18, v210, v214, s[32:33]
v_mfma_f32_16x16x32_bf16 v[136:139], v[88:91], a[88:91], v[136:139]
v_cndmask_b32 v19, v211, v215, s[32:33]
v_cndmask_b32 v16, v16, v216, s[34:35]
v_mfma_f32_16x16x32_bf16 v[140:143], v[88:91], a[92:95], v[140:143]
ds_read_b64_tr_b16 v[74:75], v56 offset:14336
v_cndmask_b32 v17, v17, v217, s[34:35]
v_mfma_f32_16x16x32_bf16 v[156:159], v[92:95], a[92:95], v[156:159]
v_cndmask_b32 v18, v18, v218, s[34:35]
v_cndmask_b32 v19, v19, v219, s[34:35]
v_mfma_f32_16x16x32_bf16 v[152:155], v[92:95], a[88:91], v[152:155]
ds_read_b64_tr_b16 v[76:77], v57 offset:12288
v_cndmask_b32 v16, v16, v220, s[36:37]
v_mfma_f32_16x16x32_bf16 v[148:151], v[92:95], a[84:87], v[148:151]
v_cndmask_b32 v17, v17, v221, s[36:37]
v_cndmask_b32 v18, v18, v222, s[36:37]
v_mfma_f32_16x16x32_bf16 v[144:147], v[92:95], a[80:83], v[144:147]
s_waitcnt lgkmcnt(2)
ds_read_b64_tr_b16 v[78:79], v57 offset:14336
v_cndmask_b32 v19, v19, v223, s[36:37]
v_mfma_f32_16x16x32_bf16 v[128:131], v[64:67], a[96:99], v[128:131]
ds_write_b64 v28, v[16:17]
v_mfma_f32_16x16x32_bf16 v[132:135], v[64:67], a[100:103], v[132:135]
ds_read_b64_tr_b16 v[80:81], v56 offset:16384
v_mfma_f32_16x16x32_bf16 v[136:139], v[64:67], a[104:107], v[136:139]
ds_write_b64 v28, v[18:19] offset:8
v_mfma_f32_16x16x32_bf16 v[140:143], v[64:67], a[108:111], v[140:143]
ds_read_b64_tr_b16 v[82:83], v56 offset:18432
v_add_u32 v28, s38, v28
v_mfma_f32_16x16x32_bf16 v[156:159], v[68:71], a[108:111], v[156:159]
v_mfma_f32_16x16x32_bf16 v[152:155], v[68:71], a[104:107], v[152:155]
ds_read_b64_tr_b16 v[84:85], v57 offset:16384
v_mfma_f32_16x16x32_bf16 v[148:151], v[68:71], a[100:103], v[148:151]
v_mfma_f32_16x16x32_bf16 v[144:147], v[68:71], a[96:99], v[144:147]
s_waitcnt lgkmcnt(3)
ds_read_b64_tr_b16 v[86:87], v57 offset:18432
v_mfma_f32_16x16x32_bf16 v[128:131], v[72:75], a[112:115], v[128:131]
v_mfma_f32_16x16x32_bf16 v[132:135], v[72:75], a[116:119], v[132:135]
ds_read_b64_tr_b16 v[88:89], v56 offset:20480
v_mfma_f32_16x16x32_bf16 v[136:139], v[72:75], a[120:123], v[136:139]
v_mfma_f32_16x16x32_bf16 v[140:143], v[72:75], a[124:127], v[140:143]
ds_read_b64_tr_b16 v[90:91], v56 offset:22528
v_mfma_f32_16x16x32_bf16 v[156:159], v[76:79], a[124:127], v[156:159]
v_mfma_f32_16x16x32_bf16 v[152:155], v[76:79], a[120:123], v[152:155]
ds_read_b64_tr_b16 v[92:93], v57 offset:20480
v_mfma_f32_16x16x32_bf16 v[148:151], v[76:79], a[116:119], v[148:151]
v_mfma_f32_16x16x32_bf16 v[144:147], v[76:79], a[112:115], v[144:147]
s_waitcnt lgkmcnt(2)
ds_read_b64_tr_b16 v[94:95], v57 offset:22528
v_mfma_f32_16x16x32_bf16 v[128:131], v[80:83], a[128:131], v[128:131]
v_mfma_f32_16x16x32_bf16 v[132:135], v[80:83], a[132:135], v[132:135]
ds_read_b64_tr_b16 v[64:65], v60 offset:24576
v_mfma_f32_16x16x32_bf16 v[136:139], v[80:83], a[136:139], v[136:139]
v_mfma_f32_16x16x32_bf16 v[140:143], v[80:83], a[140:143], v[140:143]
v_mfma_f32_16x16x32_bf16 v[156:159], v[84:87], a[140:143], v[156:159]
v_mfma_f32_16x16x32_bf16 v[152:155], v[84:87], a[136:139], v[152:155]
ds_read_b64_tr_b16 v[68:69], v61 offset:24576
v_mfma_f32_16x16x32_bf16 v[148:151], v[84:87], a[132:135], v[148:151]
v_mfma_f32_16x16x32_bf16 v[144:147], v[84:87], a[128:131], v[144:147]
s_waitcnt lgkmcnt(1)
v_mfma_f32_16x16x32_bf16 v[128:131], v[88:91], a[144:147], v[128:131]
s_barrier
v_mfma_f32_16x16x32_bf16 v[132:135], v[88:91], a[148:151], v[132:135]
v_mfma_f32_16x16x32_bf16 v[136:139], v[88:91], a[152:155], v[136:139]
v_mfma_f32_16x16x32_bf16 v[140:143], v[88:91], a[156:159], v[140:143]
v_mfma_f32_16x16x32_bf16 v[156:159], v[92:95], a[156:159], v[156:159]
v_mfma_f32_16x16x32_bf16 v[152:155], v[92:95], a[152:155], v[152:155]
v_mfma_f32_16x16x32_bf16 v[148:151], v[92:95], a[148:151], v[148:151]
v_mfma_f32_16x16x32_bf16 v[144:147], v[92:95], a[144:147], v[144:147]
s_nop 3
v_mfma_f32_16x16x4_4b_bf16 v[128:143], v[64:65], a[160:161], v[128:143]
s_waitcnt lgkmcnt(0)
s_nop 1
v_mfma_f32_16x16x4_4b_bf16 v[144:159], v[68:69], a[160:161], v[144:159]
buffer_load_dword v124, v123, s[60:63], 0 offen sc1
s_mov_b32 s98, 2097152
s_nop 5
v_cvt_pk_bf16_f32 v192, v128, v129
v_cvt_pk_bf16_f32 v193, v130, v131
s_nop 1
v_cvt_pk_bf16_f32 v194, v144, v145
v_cvt_pk_bf16_f32 v195, v146, v147
buffer_store_dwordx4 v[192:195], v116, s[60:63], s98 offen sc1
v_cvt_pk_bf16_f32 v196, v132, v133
v_cvt_pk_bf16_f32 v197, v134, v135
v_cvt_pk_bf16_f32 v198, v148, v149
v_cvt_pk_bf16_f32 v199, v150, v151
buffer_store_dwordx4 v[196:199], v117, s[60:63], s98 offen sc1
v_cvt_pk_bf16_f32 v200, v136, v137
v_cvt_pk_bf16_f32 v201, v138, v139
v_cvt_pk_bf16_f32 v202, v152, v153
v_cvt_pk_bf16_f32 v203, v154, v155
buffer_store_dwordx4 v[200:203], v118, s[60:63], s98 offen sc1
v_cvt_pk_bf16_f32 v204, v140, v141
v_cvt_pk_bf16_f32 v205, v142, v143
v_cvt_pk_bf16_f32 v206, v156, v157
v_cvt_pk_bf16_f32 v207, v158, v159
buffer_store_dwordx4 v[204:207], v119, s[60:63], s98 offen sc1
v_cndmask_b32 v16, v192, v196, s[32:33]
v_cndmask_b32 v17, v193, v197, s[32:33]
v_cndmask_b32 v18, v194, v198, s[32:33]
v_cndmask_b32 v19, v195, v199, s[32:33]
v_cndmask_b32 v16, v16, v200, s[34:35]
v_cndmask_b32 v17, v17, v201, s[34:35]
v_cndmask_b32 v18, v18, v202, s[34:35]
v_cndmask_b32 v19, v19, v203, s[34:35]
v_cndmask_b32 v16, v16, v204, s[36:37]
v_cndmask_b32 v17, v17, v205, s[36:37]
v_cndmask_b32 v18, v18, v206, s[36:37]
v_cndmask_b32 v19, v19, v207, s[36:37]
ds_write_b64 v28, v[16:17]
ds_write_b64 v28, v[18:19] offset:8
v_add_u32 v28, s38, v28
ds_read_b128 v[24:27], v29
s_waitcnt lgkmcnt(0)
v_mfma_f32_16x16x32_bf16 v[224:227], v[20:23], v[24:27], 0
v_mfma_f32_16x16x32_bf16 v[224:227], v[228:231], a[176:179], v[224:227]
v_mfma_f32_16x16x32_bf16 v[224:227], v[228:231], a[180:183], v[224:227]
v_mfma_f32_16x16x32_bf16 v[224:227], v[228:231], a[184:187], v[224:227]
v_mfma_f32_16x16x32_bf16 v[224:227], v[228:231], a[188:191], v[224:227]
s_nop 7
v_mul_f32 v224, v224, v122
v_mul_f32 v225, v225, v122
v_cvt_pk_bf16_f32 v224, v224, v225
buffer_store_dword v224, v121, s[48:51], 0 offen nt
ds_read_b128 v[24:27], v29 offset:1024
s_waitcnt lgkmcnt(0)
v_mfma_f32_16x16x32_bf16 v[224:227], v[20:23], v[24:27], 0
v_mfma_f32_16x16x32_bf16 v[224:227], v[228:231], a[192:195], v[224:227]
v_mfma_f32_16x16x32_bf16 v[224:227], v[228:231], a[196:199], v[224:227]
v_mfma_f32_16x16x32_bf16 v[224:227], v[228:231], a[200:203], v[224:227]
v_mfma_f32_16x16x32_bf16 v[224:227], v[228:231], a[204:207], v[224:227]
s_nop 7
v_mul_f32 v224, v224, v122
v_mul_f32 v225, v225, v122
v_cvt_pk_bf16_f32 v224, v224, v225
buffer_store_dword v224, v121, s[48:51], 0 offen offset:128 nt
ds_read_b128 v[24:27], v29 offset:2048
s_waitcnt lgkmcnt(0)
v_mfma_f32_16x16x32_bf16 v[224:227], v[20:23], v[24:27], 0
v_mfma_f32_16x16x32_bf16 v[224:227], v[228:231], a[208:211], v[224:227]
v_mfma_f32_16x16x32_bf16 v[224:227], v[228:231], a[212:215], v[224:227]
v_mfma_f32_16x16x32_bf16 v[224:227], v[228:231], a[216:219], v[224:227]
s_waitcnt vmcnt(6)
v_mfma_f32_16x16x32_bf16 v[224:227], v[228:231], a[220:223], v[224:227]
s_nop 7
v_mul_f32 v224, v224, v122
v_mul_f32 v225, v225, v122
v_cvt_pk_bf16_f32 v224, v224, v225
buffer_store_dword v224, v121, s[48:51], 0 offen offset:256 nt
v_cmp_le_u32 vcc, 7, v124
s_nop 3
s_cmp_eq_u32 vcc_lo, s3
s_cbranch_scc0 L_t0_spin
L_t0_ok:
s_barrier
s_mov_b32 s91, 786432
buffer_load_dwordx4 a[224:227], v120, s[60:63], s91 offen sc1
buffer_load_dwordx4 a[228:231], v30, s[60:63], s91 offen sc1
buffer_load_dwordx4 a[232:235], v31, s[60:63], s91 offen sc1
buffer_load_dwordx4 a[236:239], v11, s[60:63], s91 offen sc1
s_waitcnt vmcnt(7)
s_barrier
v_mov_b32 v126, 9
buffer_store_dword v126, v125, s[60:63], 0 offen sc1
s_mov_b32 s91, 1048576
buffer_load_dwordx4 a[240:243], v120, s[60:63], s91 offen sc1
buffer_load_dwordx4 a[244:247], v30, s[60:63], s91 offen sc1
buffer_load_dwordx4 a[248:251], v31, s[60:63], s91 offen sc1
buffer_load_dwordx4 a[252:255], v11, s[60:63], s91 offen sc1
s_mov_b32 s91, 1310720
buffer_load_dwordx4 a[0:3], v120, s[60:63], s91 offen sc1
buffer_load_dwordx4 a[4:7], v30, s[60:63], s91 offen sc1
buffer_load_dwordx4 a[8:11], v31, s[60:63], s91 offen sc1
buffer_load_dwordx4 a[12:15], v11, s[60:63], s91 offen sc1
buffer_load_dword v124, v123, s[60:63], 0 offen sc1
s_mov_b32 s91, 1572864
buffer_load_dwordx4 a[16:19], v120, s[60:63], s91 offen sc1
buffer_load_dwordx4 a[20:23], v30, s[60:63], s91 offen sc1
buffer_load_dwordx4 a[24:27], v31, s[60:63], s91 offen sc1
buffer_load_dwordx4 a[28:31], v11, s[60:63], s91 offen sc1
s_waitcnt vmcnt(4)
v_cmp_le_u32 vcc, 9, v124
s_nop 3
s_cmp_eq_u32 vcc_lo, s3
s_cbranch_scc0 L_t2_spin
L_t2_ok:
s_barrier
s_mov_b32 s91, 1835008
buffer_load_dwordx4 a[32:35], v120, s[60:63], s91 offen sc1
buffer_load_dwordx4 a[36:39], v30, s[60:63], s91 offen sc1
buffer_load_dwordx4 a[40:43], v31, s[60:63], s91 offen sc1
buffer_load_dwordx4 a[44:47], v11, s[60:63], s91 offen sc1
s_mov_b32 s91, 2097152
buffer_load_dwordx4 a[48:51], v120, s[60:63], s91 offen sc1
buffer_load_dwordx4 a[52:55], v30, s[60:63], s91 offen sc1
buffer_load_dwordx4 a[56:59], v31, s[60:63], s91 offen sc1
buffer_load_dwordx4 a[60:63], v11, s[60:63], s91 offen sc1
ds_read_b128 v[24:27], v29 offset:3072
s_waitcnt lgkmcnt(0)
v_mfma_f32_16x16x32_bf16 v[224:227], v[20:23], v[24:27], 0
v_mfma_f32_16x16x32_bf16 v[224:227], v[228:231], a[224:227], v[224:227]
v_mfma_f32_16x16x32_bf16 v[224:227], v[228:231], a[228:231], v[224:227]
v_mfma_f32_16x16x32_bf16 v[224:227], v[228:231], a[232:235], v[224:227]
v_mfma_f32_16x16x32_bf16 v[224:227], v[228:231], a[236:239], v[224:227]
s_nop 7
v_mul_f32 v224, v224, v122
v_mul_f32 v225, v225, v122
v_cvt_pk_bf16_f32 v224, v224, v225
buffer_store_dword v224, v121, s[48:51], 0 offen offset:384 nt
ds_read_b128 v[24:27], v29 offset:4096
s_waitcnt lgkmcnt(0)
v_mfma_f32_16x16x32_bf16 v[224:227], v[20:23], v[24:27], 0
v_mfma_f32_16x16x32_bf16 v[224:227], v[228:231], a[240:243], v[224:227]
v_mfma_f32_16x16x32_bf16 v[224:227], v[228:231], a[244:247], v[224:227]
v_mfma_f32_16x16x32_bf16 v[224:227], v[228:231], a[248:251], v[224:227]
v_mfma_f32_16x16x32_bf16 v[224:227], v[228:231], a[252:255], v[224:227]
s_nop 7
v_mul_f32 v224, v224, v122
v_mul_f32 v225, v225, v122
v_cvt_pk_bf16_f32 v224, v224, v225
buffer_store_dword v224, v121, s[48:51], 0 offen offset:512 nt
ds_read_b128 v[24:27], v29 offset:5120
s_waitcnt lgkmcnt(0)
v_mfma_f32_16x16x32_bf16 v[224:227], v[20:23], v[24:27], 0
v_mfma_f32_16x16x32_bf16 v[224:227], v[228:231], a[0:3], v[224:227]
v_mfma_f32_16x16x32_bf16 v[224:227], v[228:231], a[4:7], v[224:227]
v_mfma_f32_16x16x32_bf16 v[224:227], v[228:231], a[8:11], v[224:227]
v_mfma_f32_16x16x32_bf16 v[224:227], v[228:231], a[12:15], v[224:227]
s_nop 7
v_mul_f32 v224, v224, v122
v_mul_f32 v225, v225, v122
v_cvt_pk_bf16_f32 v224, v224, v225
buffer_store_dword v224, v121, s[48:51], 0 offen offset:640 nt
ds_read_b128 v[24:27], v29 offset:6144
s_waitcnt lgkmcnt(0)
v_mfma_f32_16x16x32_bf16 v[224:227], v[20:23], v[24:27], 0
s_waitcnt vmcnt(14)
v_mfma_f32_16x16x32_bf16 v[224:227], v[228:231], a[16:19], v[224:227]
s_waitcnt vmcnt(13)
v_mfma_f32_16x16x32_bf16 v[224:227], v[228:231], a[20:23], v[224:227]
s_waitcnt vmcnt(12)
v_mfma_f32_16x16x32_bf16 v[224:227], v[228:231], a[24:27], v[224:227]
s_waitcnt vmcnt(11)
v_mfma_f32_16x16x32_bf16 v[224:227], v[228:231], a[28:31], v[224:227]
s_nop 7
v_mul_f32 v224, v224, v122
v_mul_f32 v225, v225, v122
v_cvt_pk_bf16_f32 v224, v224, v225
buffer_store_dword v224, v121, s[48:51], 0 offen offset:768 nt
ds_read_b128 v[24:27], v29 offset:7168
s_waitcnt lgkmcnt(0)
v_mfma_f32_16x16x32_bf16 v[224:227], v[20:23], v[24:27], 0
s_waitcnt vmcnt(11)
v_mfma_f32_16x16x32_bf16 v[224:227], v[228:231], a[32:35], v[224:227]
s_waitcnt vmcnt(10)
v_mfma_f32_16x16x32_bf16 v[224:227], v[228:231], a[36:39], v[224:227]
s_waitcnt vmcnt(9)
v_mfma_f32_16x16x32_bf16 v[224:227], v[228:231], a[40:43], v[224:227]
s_waitcnt vmcnt(8)
v_mfma_f32_16x16x32_bf16 v[224:227], v[228:231], a[44:47], v[224:227]
s_nop 7
v_mul_f32 v224, v224, v122
v_mul_f32 v225, v225, v122
v_cvt_pk_bf16_f32 v224, v224, v225
buffer_store_dword v224, v121, s[48:51], 0 offen offset:896 nt
ds_read_b128 v[24:27], v29 offset:8192
s_waitcnt lgkmcnt(0)
v_mfma_f32_16x16x32_bf16 v[224:227], v[20:23], v[24:27], 0
s_waitcnt vmcnt(8)
v_mfma_f32_16x16x32_bf16 v[224:227], v[228:231], a[48:51], v[224:227]
s_waitcnt vmcnt(7)
v_mfma_f32_16x16x32_bf16 v[224:227], v[228:231], a[52:55], v[224:227]
s_waitcnt vmcnt(6)
v_mfma_f32_16x16x32_bf16 v[224:227], v[228:231], a[56:59], v[224:227]
s_waitcnt vmcnt(5)
v_mfma_f32_16x16x32_bf16 v[224:227], v[228:231], a[60:63], v[224:227]
s_nop 7
v_mul_f32 v224, v224, v122
v_mul_f32 v225, v225, v122
v_cvt_pk_bf16_f32 v224, v224, v225
buffer_store_dword v224, v121, s[48:51], 0 offen offset:1024 nt
s_endpgm
L_kv_spin:
s_mov_b32 s4, 0x40000
L_kv_s2:
buffer_load_dword v6, v5, s[68:71], 0 offen sc1
s_waitcnt vmcnt(0)
v_cmp_le_u32 vcc, 16, v6
s_sub_u32 s4, s4, 1
s_cmp_eq_u32 s4, 0
s_cbranch_scc1 L_kv_ok
s_nop 1
s_cmp_eq_u32 vcc_lo, s3
s_cbranch_scc0 L_kv_s2
s_branch L_kv_ok
L_r64_spin:
s_mov_b32 s4, 0x40000
L_r64_s2:
buffer_load_dword v124, v123, s[60:63], 0 offen sc1
s_waitcnt vmcnt(0)
v_cmp_le_u32 vcc, 3, v124
s_sub_u32 s4, s4, 1
s_cmp_eq_u32 s4, 0
s_cbranch_scc1 L_r64_ok
s_nop 1
s_cmp_eq_u32 vcc_lo, s3
s_cbranch_scc0 L_r64_s2
s_branch L_r64_ok
L_t0_spin:
s_mov_b32 s4, 0x40000
L_t0_s2:
buffer_load_dword v124, v123, s[60:63], 0 offen sc1
s_waitcnt vmcnt(0)
v_cmp_le_u32 vcc, 7, v124
s_sub_u32 s4, s4, 1
s_cmp_eq_u32 s4, 0
s_cbranch_scc1 L_t0_ok
s_nop 1
s_cmp_eq_u32 vcc_lo, s3
s_cbranch_scc0 L_t0_s2
s_branch L_t0_ok
L_t2_spin:
s_mov_b32 s4, 0x40000
L_t2_s2:
buffer_load_dword v124, v123, s[60:63], 0 offen sc1
s_waitcnt vmcnt(0)
v_cmp_le_u32 vcc, 9, v124
s_sub_u32 s4, s4, 1
s_cmp_eq_u32 s4, 0
s_cbranch_scc1 L_t2_ok
s_nop 1
s_cmp_eq_u32 vcc_lo, s3
s_cbranch_scc0 L_t2_s2
s_branch L_t2_ok
L_end:
s_endpgm
.section .rodata,"a"
.p2align 6
.amdhsa_kernel gated_mix__linear_kernel_hedgehog__glu_gated_swiglu__prompt_kernel
  .amdhsa_next_free_vgpr 512
  .amdhsa_next_free_sgpr 102
  .amdhsa_accum_offset 256
  .amdhsa_group_segment_fixed_size 0
  .amdhsa_kernarg_size 96
  .amdhsa_user_sgpr_count 2
  .amdhsa_user_sgpr_kernarg_segment_ptr 1
  .amdhsa_system_sgpr_workgroup_id_x 1
  .amdhsa_float_denorm_mode_32 3
.end_amdhsa_kernel
```
